```python
import torch

def _softmax(x, axis=-1):
    return torch.softmax(x, dim=axis)
def _gelu(x):
    return torch.nn.functional.gelu(x, approximate="tanh")
def _silu(x):
    return torch.nn.functional.silu(x)
def _sigmoid(x):
    return torch.sigmoid(x)
def _layernorm(x, axis=-1, eps=1e-5):
    m = x.mean(dim=axis, keepdim=True)
    v = x.var(dim=axis, keepdim=True, unbiased=False)
    return (x - m) / torch.sqrt(v + eps)
def _scatter_add(tgt, idx, src, axis=0):
    return tgt.clone().index_add_(axis, idx, src)
def _segment_sum(src, seg, n):
    out = torch.zeros((n,) + src.shape[1:], dtype=src.dtype)
    return out.index_add_(0, seg, src)
def _pad(x, pw):
    flat = tuple(v for pair in reversed(pw) for v in pair)
    return torch.nn.functional.pad(x, flat)

kernel_name = 'recurrent_scan__softmax_full_mha__glu_gated_glu__prompt'

def setup_inputs():

    _w = (lambda a: (lambda t: t.to(torch.bfloat16) if t.is_floating_point() else t)(torch.as_tensor(a)))
    def _A_setup():
        B, S, D = 1, 2048, 1024
        return {
            "x": _w((lambda *s: torch.randn(*s, dtype=torch.bfloat16) * 0.05)(B, S, D)),
            "wqkv": _w((lambda *s: torch.randn(*s, dtype=torch.bfloat16) * 0.05)(D, 3 * D)),
            "wo": _w((lambda *s: torch.randn(*s, dtype=torch.bfloat16) * 0.05)(D, D)),
        }
    _A_in = _A_setup()

    def _B_setup():
        B, S, D, F = 1, 2048, 1024, 3584
        return {
            "x": _w((lambda *s: torch.randn(*s, dtype=torch.bfloat16) * 0.05)(B, S, D)),
            "w_gate": _w((lambda *s: torch.randn(*s, dtype=torch.bfloat16) * 0.05)(D, F)),
            "w_up": _w((lambda *s: torch.randn(*s, dtype=torch.bfloat16) * 0.05)(D, F)),
            "w_down": _w((lambda *s: torch.randn(*s, dtype=torch.bfloat16) * 0.05)(F, D)),
        }
    _B_in = _B_setup()

    return {
        "A_x": _A_in["x"],
        "A_wqkv": _A_in["wqkv"],
        "A_wo": _A_in["wo"],
        "B_x": _B_in["x"],
        "B_w_gate": _B_in["w_gate"],
        "B_w_up": _B_in["w_up"],
        "B_w_down": _B_in["w_down"],
    }

def reference(A_x, A_wqkv, A_wo, B_x, B_w_gate, B_w_up, B_w_down):
    def _A_ref(x, wqkv, wo):
        B, S, D = x.shape
        H = 32; Dh = D // H
        qkv = (lambda x, *d: x.permute(*d))((x @ wqkv).reshape(B, S, 3, H, Dh), 2, 0, 3, 1, 4)
        q, k, v = qkv[0], qkv[1], qkv[2]
        scale = Dh ** -0.5
        scores = torch.einsum("bhqd,bhkd->bhqk", q, k) * scale
        p = _softmax(scores, axis=-1)
        o = torch.einsum("bhqk,bhkd->bhqd", p, v)
        return (lambda x, *d: x.permute(*d))(o, 0, 2, 1, 3).reshape(B, S, D) @ wo

    def _B_ref(x, w_gate, w_up, w_down):
        g = torch.einsum("bsd,df->bsf", x, w_gate)
        u = torch.einsum("bsd,df->bsf", x, w_up)
        h = _sigmoid(g) * u
        return torch.einsum("bsf,fd->bsd", h, w_down)

    x = A_x
    xn = _layernorm(x, axis=-1)
    s = _A_ref(xn, A_wqkv, A_wo)
    g = _silu(_B_ref(xn, B_w_gate, B_w_up, B_w_down))
    return x + s * g
```

```asm
; @launch grid=(256,1,1) block=(256,1,1) lds=163840
.amdgcn_target "amdgcn-amd-amdhsa--gfx950"
.text
.p2align 8
.globl recurrent_scan__softmax_full_mha__glu_gated_glu__prompt_kernel
.type recurrent_scan__softmax_full_mha__glu_gated_glu__prompt_kernel,@function
recurrent_scan__softmax_full_mha__glu_gated_glu__prompt_kernel:
    s_cmp_ge_u32 s2, 256
    s_cbranch_scc1 L_k2_end
    s_load_dwordx2 s[30:31], s[0:1], 0
    s_load_dwordx4 s[76:79], s[0:1], 64
    s_getpc_b64 s[62:63]
L_p0_pc:
    s_lshr_b32 s3, s2, 3
    s_and_b32 s3, s3, 7
    v_lshrrev_b32 v20, 2, v0
    v_lshlrev_b32 v20, 3, v20
    v_add_u32 v20, s3, v20
    v_lshlrev_b32 v20, 7, v20
    v_min_u32 v20, L_code_end-L_p0_pc, v20
    global_load_dword v46, v20, s[62:63]
    s_load_dwordx2 s[6:7], s[0:1], 8
    s_load_dwordx4 s[8:11], s[0:1], 32
    s_load_dwordx2 s[72:73], s[0:1], 48
    s_load_dwordx2 s[74:75], s[0:1], 16
    v_and_b32 v20, 7, v0
    v_lshrrev_b32 v21, 3, v0
    s_and_b32 s3, s2, 1
    s_lshl_b32 s3, s3, 1
    v_and_b32 v22, 3, v0
    v_xor_b32 v22, s3, v22
    v_lshlrev_b32 v48, 4, v22
    v_bfe_u32 v22, v0, 3, 3
    v_lshl_add_u32 v48, v22, 6, v48
    v_bfe_u32 v22, v0, 2, 1
    v_lshl_add_u32 v48, v22, 11, v48
    v_lshrrev_b32 v22, 6, v0
    v_lshl_add_u32 v48, v22, 12, v48
    v_lshrrev_b32 v11, 6, v0
    s_lshl_b32 s33, s2, 14
    v_readfirstlane_b32 s45, v11
    s_waitcnt lgkmcnt(0)
    s_mov_b64 s[4:5], s[78:79]
    s_or_b32 s3, s2, s45
    s_cmp_lg_u32 s3, 0
    s_cbranch_scc1 L_p0_nozero
    s_add_u32 s56, s4, 0x2800000
    s_addc_u32 s57, s5, 0
    s_and_b32 s57, s57, 0xffff
    s_mov_b32 s58, 0x8000
    s_mov_b32 s59, 0x20000
    v_lshlrev_b32 v24, 7, v0
    v_mov_b32 v25, 0
    s_movk_i32 s3, 0x0
    buffer_store_dword v25, v24, s[56:59], s3 offen sc1
    s_movk_i32 s3, 0x2000
    buffer_store_dword v25, v24, s[56:59], s3 offen sc1
    s_movk_i32 s3, 0x4000
    buffer_store_dword v25, v24, s[56:59], s3 offen sc1
    s_movk_i32 s3, 0x6000
    buffer_store_dword v25, v24, s[56:59], s3 offen sc1
L_p0_nozero:
    s_mov_b32 s28, s30
    s_and_b32 s29, s31, 0xffff
    s_mov_b32 s30, 0x400000
    s_mov_b32 s31, 0x20000
    buffer_load_dwordx4 v[56:59], v48, s[28:31], s33 offen offset:0
    buffer_load_dwordx4 v[60:63], v48, s[28:31], s33 offen offset:512
    buffer_load_dwordx4 v[64:67], v48, s[28:31], s33 offen offset:1024
    buffer_load_dwordx4 v[68:71], v48, s[28:31], s33 offen offset:1536
    v_and_b32 v0, 63, v0
    v_lshlrev_b32 v49, 4, v0
    s_and_b32 s3, s2, 7
    s_lshr_b32 s43, s2, 3
    s_lshr_b32 s61, s43, 3
    s_and_b32 s43, s43, 7
    s_mul_i32 s44, s3, 3
    s_add_u32 s44, s44, s61
    s_lshr_b32 s62, s43, 2
    s_xor_b32 s62, s62, s3
    s_and_b32 s62, s62, 1
    s_lshl_b32 s62, s62, 2
    s_lshr_b32 s63, s3, 1
    s_sub_u32 s63, s63, s62
    s_add_u32 s63, s63, 28
    s_cmp_eq_u32 s61, 3
    s_cselect_b32 s44, s63, s44
    s_lshr_b32 s46, s45, 1
    s_and_b32 s47, s45, 1
    s_cmp_ge_u32 s44, 28
    s_cselect_b32 s48, 1, 0
    s_mov_b32 s60, 0x1c00
    s_cmov_b32 s60, 0x1800
    s_lshl_b32 s39, s60, 5
    s_lshl_b32 s40, s45, 12
    v_lshlrev_b32 v1, 4, v0
    v_add_u32 v1, s40, v1
    s_lshl_b32 s41, s45, 10
    s_add_u32 s41, s41, 0x10000
    v_lshrrev_b32 v11, 3, v0
    s_lshl_b32 s3, s45, 3
    v_add_u32 v11, s3, v11
    v_bfe_u32 v12, v0, 4, 1
    s_and_b32 s3, s45, 1
    s_lshl_b32 s3, s3, 1
    v_or_b32 v12, s3, v12
    v_lshlrev_b32 v12, 1, v12
    v_and_b32 v13, 7, v0
    v_xor_b32 v12, v12, v13
    v_lshlrev_b32 v12, 4, v12
    v_mul_lo_u32 v2, v11, s60
    v_add_u32 v2, v2, v12
    v_mul_u32_u24 v3, 6144, v11
    v_add_u32 v3, v3, v12
    s_mul_i32 s3, s43, 540672
    s_add_u32 s3, s3, 0x2c00000
    s_add_u32 s12, s4, s3
    s_addc_u32 s13, s5, 0
    s_and_b32 s13, s13, 0xffff
    s_mov_b32 s14, 0x84000
    s_mov_b32 s15, 0x20000
    s_lshl_b32 s61, s44, 8
    s_lshl_b32 s62, s44, 9
    s_sub_u32 s62, s62, 10240
    s_add_u32 s63, s62, 256
    s_cmp_eq_u32 s48, 1
    s_cselect_b32 s64, s62, s61
    s_cselect_b32 s65, s63, s61
    s_cselect_b32 s66, s6, s8
    s_cselect_b32 s67, s7, s9
    s_cselect_b32 s68, s6, s10
    s_cselect_b32 s69, s7, s11
    s_mov_b32 s70, 0x700000
    s_cmov_b32 s70, 0x600000
    s_sub_u32 s71, s70, s64
    s_add_u32 s16, s66, s64
    s_addc_u32 s17, s67, 0
    s_and_b32 s17, s17, 0xffff
    s_mov_b32 s18, s71
    s_mov_b32 s19, 0x20000
    s_sub_u32 s71, s70, s65
    s_add_u32 s20, s68, s65
    s_addc_u32 s21, s69, 0
    s_and_b32 s21, s21, 0xffff
    s_mov_b32 s22, s71
    s_mov_b32 s23, 0x20000
    s_lshl_b32 s61, s44, 7
    s_sub_u32 s71, 0x600000, s61
    s_add_u32 s24, s6, s61
    s_addc_u32 s25, s7, 0
    s_and_b32 s25, s25, 0xffff
    s_mov_b32 s26, s71
    s_mov_b32 s27, 0x20000
    s_mov_b32 s36, 0
    s_mov_b32 s37, 0
    s_mov_b32 s38, 0
    s_add_u32 m0, s41, 0
    s_nop 0
    buffer_load_dwordx4 v2, s[16:19], s37 offen offset:0 lds
    s_add_u32 m0, s41, 16256
    s_nop 0
    buffer_load_dwordx4 v2, s[16:19], s37 offen offset:128 lds
    s_add_u32 m0, s41, 32768
    s_nop 0
    buffer_load_dwordx4 v2, s[20:23], s37 offen offset:0 lds
    s_add_u32 m0, s41, 49024
    s_nop 0
    buffer_load_dwordx4 v2, s[20:23], s37 offen offset:128 lds
    s_add_u32 m0, s41, 65536
    s_nop 0
    buffer_load_dwordx4 v3, s[24:27], s38 offen offset:0 lds
    s_add_u32 s37, s37, s39
    s_add_u32 s38, s38, 196608
    s_lshl_b32 s3, s2, 2
    s_add_u32 s3, s3, s45
    s_lshl_b32 s3, s3, 6
    v_add_u32 v45, s3, v0
    v_lshlrev_b32 v45, 3, v45
    s_mov_b32 s68, s74
    s_and_b32 s69, s75, 0xffff
    s_mov_b32 s70, 0x200000
    s_mov_b32 s71, 0x20000
    s_mov_b32 s51, 0
    s_mov_b64 s[62:63], s[6:7]
    s_mov_b32 s61, 6
    s_mov_b32 s60, 0x600000
    s_mov_b32 s49, 393216
    s_cmp_eq_u32 s45, 0
    s_cbranch_scc1 L_k1_pfsel
    s_mov_b64 s[62:63], s[8:9]
    s_mov_b32 s61, 7
    s_mov_b32 s60, 0x700000
    s_mov_b32 s49, 458752
    s_cmp_eq_u32 s45, 1
    s_cbranch_scc1 L_k1_pfsel
    s_mov_b64 s[62:63], s[10:11]
    s_cmp_eq_u32 s45, 2
    s_cbranch_scc1 L_k1_pfsel
    s_mov_b64 s[62:63], s[72:73]
    s_mov_b32 s61, 10
    s_mov_b32 s49, 0
L_k1_pfsel:
    s_mov_b32 s64, s62
    s_and_b32 s65, s63, 0xffff
    s_mov_b32 s66, s60
    s_mov_b32 s67, 0x20000
    s_lshl_b32 s72, s61, 15
    s_mul_i32 s3, s2, s61
    v_add_u32 v44, s3, v0
    v_lshlrev_b32 v44, 7, v44
    v_cmp_gt_u32 vcc, s61, v0
    v_bfrev_b32 v17, 1
    s_nop 0
    v_cndmask_b32 v44, v17, v44, vcc
    s_add_u32 m0, s41, 4096
    s_nop 0
    buffer_load_dwordx4 v2, s[16:19], s37 offen offset:0 lds
    s_add_u32 m0, s41, 20352
    s_nop 0
    buffer_load_dwordx4 v2, s[16:19], s37 offen offset:128 lds
    s_add_u32 m0, s41, 36864
    s_nop 0
    buffer_load_dwordx4 v2, s[20:23], s37 offen offset:0 lds
    s_add_u32 m0, s41, 53120
    s_nop 0
    buffer_load_dwordx4 v2, s[20:23], s37 offen offset:128 lds
    s_add_u32 m0, s41, 69632
    s_nop 0
    buffer_load_dwordx4 v3, s[24:27], s38 offen offset:0 lds
    s_add_u32 s37, s37, s39
    s_add_u32 s38, s38, 196608
    s_or_b32 s3, s2, s45
    s_cmp_lg_u32 s3, 0
    s_cbranch_scc1 L_p0_nogo
    v_mov_b32 v20, 1
    v_mov_b32 v21, 0
    s_waitcnt vmcnt(14)
    s_mov_b64 exec, 1
    global_store_dword v21, v20, s[76:77] sc1
    s_mov_b64 exec, -1
L_p0_nogo:
    buffer_load_dword v46, v44, s[64:67], s49 offen
    s_add_u32 s49, s49, s72
    buffer_load_dword v46, v44, s[64:67], s49 offen
    s_add_u32 s49, s49, s72
    buffer_load_dword v46, v44, s[64:67], s49 offen
    s_add_u32 s49, s49, s72
    buffer_load_dword v46, v44, s[64:67], s49 offen
    s_add_u32 s49, s49, s72
    s_lshl_b32 s3, s2, 2
    s_add_u32 s3, s3, s45
    s_mul_i32 s3, s3, 4224
    s_add_u32 s3, s3, 0x2c00000
    s_add_u32 s60, s4, s3
    s_addc_u32 s61, s5, 0
    s_and_b32 s61, s61, 0xffff
    s_mov_b32 s62, 0x1000
    s_mov_b32 s63, 0x20000
    s_mov_b32 s73, 0xffff0000
    s_waitcnt vmcnt(14)
    v_lshlrev_b32 v72, 16, v56
    v_and_b32 v73, s73, v56
    v_lshlrev_b32 v74, 16, v57
    v_and_b32 v75, s73, v57
    v_lshlrev_b32 v76, 16, v58
    v_and_b32 v77, s73, v58
    v_lshlrev_b32 v78, 16, v59
    v_and_b32 v79, s73, v59
    v_lshlrev_b32 v80, 16, v60
    v_and_b32 v81, s73, v60
    v_lshlrev_b32 v82, 16, v61
    v_and_b32 v83, s73, v61
    v_lshlrev_b32 v84, 16, v62
    v_and_b32 v85, s73, v62
    v_lshlrev_b32 v86, 16, v63
    v_and_b32 v87, s73, v63
    v_lshlrev_b32 v88, 16, v64
    v_and_b32 v89, s73, v64
    v_lshlrev_b32 v90, 16, v65
    v_and_b32 v91, s73, v65
    v_lshlrev_b32 v92, 16, v66
    v_and_b32 v93, s73, v66
    v_lshlrev_b32 v94, 16, v67
    v_and_b32 v95, s73, v67
    v_lshlrev_b32 v96, 16, v68
    v_and_b32 v97, s73, v68
    v_lshlrev_b32 v98, 16, v69
    v_and_b32 v99, s73, v69
    v_lshlrev_b32 v100, 16, v70
    v_and_b32 v101, s73, v70
    v_lshlrev_b32 v102, 16, v71
    v_and_b32 v103, s73, v71
    v_pk_add_f32 v[104:105], v[72:73], v[80:81]
    v_pk_add_f32 v[106:107], v[74:75], v[82:83]
    v_pk_add_f32 v[108:109], v[76:77], v[84:85]
    v_pk_add_f32 v[110:111], v[78:79], v[86:87]
    v_pk_add_f32 v[104:105], v[104:105], v[88:89]
    v_pk_add_f32 v[106:107], v[106:107], v[90:91]
    v_pk_add_f32 v[108:109], v[108:109], v[92:93]
    v_pk_add_f32 v[110:111], v[110:111], v[94:95]
    v_pk_add_f32 v[104:105], v[104:105], v[96:97]
    v_pk_add_f32 v[106:107], v[106:107], v[98:99]
    v_pk_add_f32 v[108:109], v[108:109], v[100:101]
    v_pk_add_f32 v[110:111], v[110:111], v[102:103]
    v_pk_add_f32 v[104:105], v[104:105], v[106:107]
    v_pk_add_f32 v[108:109], v[108:109], v[110:111]
    v_pk_add_f32 v[104:105], v[104:105], v[108:109]
    v_add_f32 v104, v104, v105
    s_nop 1
    v_add_f32_dpp v104, v104, v104 quad_perm:[1,0,3,2] row_mask:0xf bank_mask:0xf
    s_nop 1
    v_add_f32_dpp v104, v104, v104 quad_perm:[2,3,0,1] row_mask:0xf bank_mask:0xf
    s_nop 1
    v_add_f32_dpp v104, v104, v104 row_ror:8 row_mask:0xf bank_mask:0xf
    v_mov_b32 v105, v104
    s_nop 1
    v_permlane16_swap_b32 v104, v105
    v_add_f32 v104, v104, v105
    v_mov_b32 v105, v104
    s_nop 1
    v_permlane32_swap_b32 v104, v105
    v_add_f32 v104, v104, v105
    v_mul_f32 v128, 0x3a800000, v104
    v_pk_add_f32 v[132:133], v[72:73], v[128:129] op_sel_hi:[1,0] neg_lo:[0,1] neg_hi:[0,1]
    v_pk_add_f32 v[134:135], v[74:75], v[128:129] op_sel_hi:[1,0] neg_lo:[0,1] neg_hi:[0,1]
    v_pk_add_f32 v[136:137], v[76:77], v[128:129] op_sel_hi:[1,0] neg_lo:[0,1] neg_hi:[0,1]
    v_pk_add_f32 v[138:139], v[78:79], v[128:129] op_sel_hi:[1,0] neg_lo:[0,1] neg_hi:[0,1]
    v_pk_mul_f32 v[104:105], v[132:133], v[132:133]
    v_pk_add_f32 v[140:141], v[80:81], v[128:129] op_sel_hi:[1,0] neg_lo:[0,1] neg_hi:[0,1]
    v_pk_mul_f32 v[106:107], v[134:135], v[134:135]
    v_pk_add_f32 v[142:143], v[82:83], v[128:129] op_sel_hi:[1,0] neg_lo:[0,1] neg_hi:[0,1]
    v_pk_mul_f32 v[108:109], v[136:137], v[136:137]
    v_pk_add_f32 v[144:145], v[84:85], v[128:129] op_sel_hi:[1,0] neg_lo:[0,1] neg_hi:[0,1]
    v_pk_mul_f32 v[110:111], v[138:139], v[138:139]
    v_pk_add_f32 v[146:147], v[86:87], v[128:129] op_sel_hi:[1,0] neg_lo:[0,1] neg_hi:[0,1]
    v_pk_fma_f32 v[104:105], v[140:141], v[140:141], v[104:105]
    v_pk_add_f32 v[132:133], v[88:89], v[128:129] op_sel_hi:[1,0] neg_lo:[0,1] neg_hi:[0,1]
    v_pk_fma_f32 v[106:107], v[142:143], v[142:143], v[106:107]
    v_pk_add_f32 v[134:135], v[90:91], v[128:129] op_sel_hi:[1,0] neg_lo:[0,1] neg_hi:[0,1]
    v_pk_fma_f32 v[108:109], v[144:145], v[144:145], v[108:109]
    v_pk_add_f32 v[136:137], v[92:93], v[128:129] op_sel_hi:[1,0] neg_lo:[0,1] neg_hi:[0,1]
    v_pk_fma_f32 v[110:111], v[146:147], v[146:147], v[110:111]
    v_pk_add_f32 v[138:139], v[94:95], v[128:129] op_sel_hi:[1,0] neg_lo:[0,1] neg_hi:[0,1]
    v_pk_fma_f32 v[104:105], v[132:133], v[132:133], v[104:105]
    v_pk_add_f32 v[140:141], v[96:97], v[128:129] op_sel_hi:[1,0] neg_lo:[0,1] neg_hi:[0,1]
    v_pk_fma_f32 v[106:107], v[134:135], v[134:135], v[106:107]
    v_pk_add_f32 v[142:143], v[98:99], v[128:129] op_sel_hi:[1,0] neg_lo:[0,1] neg_hi:[0,1]
    v_pk_fma_f32 v[108:109], v[136:137], v[136:137], v[108:109]
    v_pk_add_f32 v[144:145], v[100:101], v[128:129] op_sel_hi:[1,0] neg_lo:[0,1] neg_hi:[0,1]
    v_pk_fma_f32 v[110:111], v[138:139], v[138:139], v[110:111]
    v_pk_add_f32 v[146:147], v[102:103], v[128:129] op_sel_hi:[1,0] neg_lo:[0,1] neg_hi:[0,1]
    v_pk_fma_f32 v[104:105], v[140:141], v[140:141], v[104:105]
    v_pk_fma_f32 v[106:107], v[142:143], v[142:143], v[106:107]
    v_pk_fma_f32 v[108:109], v[144:145], v[144:145], v[108:109]
    v_pk_fma_f32 v[110:111], v[146:147], v[146:147], v[110:111]
    v_cvt_pk_bf16_f32 v132, v128, v128
    v_and_b32 v128, s73, v132
    v_mov_b32 v21, 0
    global_load_dword v23, v21, s[76:77] sc1
    v_pk_add_f32 v[104:105], v[104:105], v[106:107]
    v_pk_add_f32 v[108:109], v[108:109], v[110:111]
    v_pk_add_f32 v[104:105], v[104:105], v[108:109]
    v_add_f32 v104, v104, v105
    s_nop 1
    v_add_f32_dpp v104, v104, v104 quad_perm:[1,0,3,2] row_mask:0xf bank_mask:0xf
    s_nop 1
    v_add_f32_dpp v104, v104, v104 quad_perm:[2,3,0,1] row_mask:0xf bank_mask:0xf
    s_nop 1
    v_add_f32_dpp v104, v104, v104 row_ror:8 row_mask:0xf bank_mask:0xf
    v_mov_b32 v105, v104
    s_nop 1
    v_permlane16_swap_b32 v104, v105
    v_add_f32 v104, v104, v105
    v_mov_b32 v105, v104
    s_nop 1
    v_permlane32_swap_b32 v104, v105
    v_add_f32 v104, v104, v105
    v_mul_f32 v130, 0x3a800000, v104
    v_cvt_pk_bf16_f32 v132, v130, v130
    v_and_b32 v130, s73, v132
    v_add_f32 v130, 0x3727c5ac, v130
    v_cvt_pk_bf16_f32 v132, v130, v130
    v_and_b32 v130, s73, v132
    v_sqrt_f32 v130, v130
    v_pk_add_f32 v[72:73], v[72:73], v[128:129] op_sel_hi:[1,0] neg_lo:[0,1] neg_hi:[0,1]
    v_cvt_pk_bf16_f32 v132, v130, v130
    v_and_b32 v130, s73, v132
    v_rcp_f32 v130, v130
    v_pk_add_f32 v[74:75], v[74:75], v[128:129] op_sel_hi:[1,0] neg_lo:[0,1] neg_hi:[0,1]
    v_pk_add_f32 v[76:77], v[76:77], v[128:129] op_sel_hi:[1,0] neg_lo:[0,1] neg_hi:[0,1]
    v_pk_add_f32 v[78:79], v[78:79], v[128:129] op_sel_hi:[1,0] neg_lo:[0,1] neg_hi:[0,1]
    v_pk_add_f32 v[80:81], v[80:81], v[128:129] op_sel_hi:[1,0] neg_lo:[0,1] neg_hi:[0,1]
    v_pk_add_f32 v[82:83], v[82:83], v[128:129] op_sel_hi:[1,0] neg_lo:[0,1] neg_hi:[0,1]
    v_pk_add_f32 v[84:85], v[84:85], v[128:129] op_sel_hi:[1,0] neg_lo:[0,1] neg_hi:[0,1]
    v_pk_add_f32 v[86:87], v[86:87], v[128:129] op_sel_hi:[1,0] neg_lo:[0,1] neg_hi:[0,1]
    v_pk_add_f32 v[88:89], v[88:89], v[128:129] op_sel_hi:[1,0] neg_lo:[0,1] neg_hi:[0,1]
    v_pk_add_f32 v[90:91], v[90:91], v[128:129] op_sel_hi:[1,0] neg_lo:[0,1] neg_hi:[0,1]
    v_pk_add_f32 v[92:93], v[92:93], v[128:129] op_sel_hi:[1,0] neg_lo:[0,1] neg_hi:[0,1]
    v_pk_add_f32 v[94:95], v[94:95], v[128:129] op_sel_hi:[1,0] neg_lo:[0,1] neg_hi:[0,1]
    v_pk_add_f32 v[96:97], v[96:97], v[128:129] op_sel_hi:[1,0] neg_lo:[0,1] neg_hi:[0,1]
    v_pk_add_f32 v[98:99], v[98:99], v[128:129] op_sel_hi:[1,0] neg_lo:[0,1] neg_hi:[0,1]
    v_pk_add_f32 v[100:101], v[100:101], v[128:129] op_sel_hi:[1,0] neg_lo:[0,1] neg_hi:[0,1]
    v_pk_add_f32 v[102:103], v[102:103], v[128:129] op_sel_hi:[1,0] neg_lo:[0,1] neg_hi:[0,1]
    v_cvt_pk_bf16_f32 v56, v72, v73
    v_cvt_pk_bf16_f32 v57, v74, v75
    v_cvt_pk_bf16_f32 v58, v76, v77
    v_cvt_pk_bf16_f32 v59, v78, v79
    v_cvt_pk_bf16_f32 v60, v80, v81
    v_cvt_pk_bf16_f32 v61, v82, v83
    v_cvt_pk_bf16_f32 v62, v84, v85
    v_cvt_pk_bf16_f32 v63, v86, v87
    v_cvt_pk_bf16_f32 v64, v88, v89
    v_cvt_pk_bf16_f32 v65, v90, v91
    v_cvt_pk_bf16_f32 v66, v92, v93
    v_cvt_pk_bf16_f32 v67, v94, v95
    v_cvt_pk_bf16_f32 v68, v96, v97
    v_cvt_pk_bf16_f32 v69, v98, v99
    v_cvt_pk_bf16_f32 v70, v100, v101
    v_cvt_pk_bf16_f32 v71, v102, v103
    v_lshlrev_b32 v72, 16, v56
    v_and_b32 v73, s73, v56
    v_lshlrev_b32 v74, 16, v57
    v_and_b32 v75, s73, v57
    v_lshlrev_b32 v76, 16, v58
    v_and_b32 v77, s73, v58
    v_lshlrev_b32 v78, 16, v59
    v_and_b32 v79, s73, v59
    v_lshlrev_b32 v80, 16, v60
    v_and_b32 v81, s73, v60
    v_lshlrev_b32 v82, 16, v61
    v_and_b32 v83, s73, v61
    v_lshlrev_b32 v84, 16, v62
    v_and_b32 v85, s73, v62
    v_lshlrev_b32 v86, 16, v63
    v_and_b32 v87, s73, v63
    v_lshlrev_b32 v88, 16, v64
    v_and_b32 v89, s73, v64
    v_lshlrev_b32 v90, 16, v65
    v_and_b32 v91, s73, v65
    v_lshlrev_b32 v92, 16, v66
    v_and_b32 v93, s73, v66
    v_lshlrev_b32 v94, 16, v67
    v_and_b32 v95, s73, v67
    v_lshlrev_b32 v96, 16, v68
    v_and_b32 v97, s73, v68
    v_lshlrev_b32 v98, 16, v69
    v_and_b32 v99, s73, v69
    v_lshlrev_b32 v100, 16, v70
    v_and_b32 v101, s73, v70
    v_lshlrev_b32 v102, 16, v71
    v_and_b32 v103, s73, v71
    v_pk_mul_f32 v[72:73], v[72:73], v[130:131] op_sel_hi:[1,0]
    v_pk_mul_f32 v[74:75], v[74:75], v[130:131] op_sel_hi:[1,0]
    v_pk_mul_f32 v[76:77], v[76:77], v[130:131] op_sel_hi:[1,0]
    v_pk_mul_f32 v[78:79], v[78:79], v[130:131] op_sel_hi:[1,0]
    v_pk_mul_f32 v[80:81], v[80:81], v[130:131] op_sel_hi:[1,0]
    v_pk_mul_f32 v[82:83], v[82:83], v[130:131] op_sel_hi:[1,0]
    v_pk_mul_f32 v[84:85], v[84:85], v[130:131] op_sel_hi:[1,0]
    v_pk_mul_f32 v[86:87], v[86:87], v[130:131] op_sel_hi:[1,0]
    v_pk_mul_f32 v[88:89], v[88:89], v[130:131] op_sel_hi:[1,0]
    v_pk_mul_f32 v[90:91], v[90:91], v[130:131] op_sel_hi:[1,0]
    v_pk_mul_f32 v[92:93], v[92:93], v[130:131] op_sel_hi:[1,0]
    v_pk_mul_f32 v[94:95], v[94:95], v[130:131] op_sel_hi:[1,0]
    v_pk_mul_f32 v[96:97], v[96:97], v[130:131] op_sel_hi:[1,0]
    v_pk_mul_f32 v[98:99], v[98:99], v[130:131] op_sel_hi:[1,0]
    v_pk_mul_f32 v[100:101], v[100:101], v[130:131] op_sel_hi:[1,0]
    v_pk_mul_f32 v[102:103], v[102:103], v[130:131] op_sel_hi:[1,0]
    v_cvt_pk_bf16_f32 v56, v72, v73
    v_cvt_pk_bf16_f32 v57, v74, v75
    v_cvt_pk_bf16_f32 v58, v76, v77
    v_cvt_pk_bf16_f32 v59, v78, v79
    buffer_store_dwordx4 v[56:59], v49, s[60:63], 0 offen offset:0 sc1
    v_cvt_pk_bf16_f32 v60, v80, v81
    v_cvt_pk_bf16_f32 v61, v82, v83
    v_cvt_pk_bf16_f32 v62, v84, v85
    v_cvt_pk_bf16_f32 v63, v86, v87
    buffer_store_dwordx4 v[60:63], v49, s[60:63], 0 offen offset:1024 sc1
    v_cvt_pk_bf16_f32 v64, v88, v89
    v_cvt_pk_bf16_f32 v65, v90, v91
    v_cvt_pk_bf16_f32 v66, v92, v93
    v_cvt_pk_bf16_f32 v67, v94, v95
    buffer_store_dwordx4 v[64:67], v49, s[60:63], 0 offen offset:2048 sc1
    v_cvt_pk_bf16_f32 v68, v96, v97
    v_cvt_pk_bf16_f32 v69, v98, v99
    v_cvt_pk_bf16_f32 v70, v100, v101
    v_cvt_pk_bf16_f32 v71, v102, v103
    buffer_store_dwordx4 v[68:71], v49, s[60:63], 0 offen offset:3072 sc1
    v_lshlrev_b32 v4, 4, v0
    s_lshl_b32 s3, s46, 13
    v_add_u32 v4, s3, v4
    v_lshrrev_b32 v11, 4, v0
    v_bfe_u32 v12, v0, 2, 2
    v_and_b32 v13, 3, v0
    v_lshlrev_b32 v14, 10, v11
    v_lshl_add_u32 v14, v12, 7, v14
    v_lshl_add_u32 v14, v13, 3, v14
    v_lshrrev_b32 v15, 1, v12
    v_and_b32 v16, 1, v11
    v_lshl_or_b32 v15, v16, 1, v15
    s_lshl_b32 s3, s47, 14
    s_add_u32 s3, s3, 0x10000
    v_xor_b32 v16, 0, v15
    v_lshl_add_u32 v16, v16, 5, v14
    v_add_u32 v5, s3, v16
    v_xor_b32 v16, 1, v15
    v_lshl_add_u32 v16, v16, 5, v14
    v_add_u32 v6, s3, v16
    v_xor_b32 v16, 2, v15
    v_lshl_add_u32 v16, v16, 5, v14
    v_add_u32 v7, s3, v16
    v_xor_b32 v16, 3, v15
    v_lshl_add_u32 v16, v16, 5, v14
    v_add_u32 v8, s3, v16
    s_lshl_b32 s3, s47, 1
    s_add_u32 s61, s3, 0
    v_xor_b32 v16, s61, v15
    v_lshl_add_u32 v16, v16, 5, v14
    v_add_u32 v9, 0x20000, v16
    s_add_u32 s61, s3, 1
    v_xor_b32 v16, s61, v15
    v_lshl_add_u32 v16, v16, 5, v14
    v_add_u32 v10, 0x20000, v16
    v_and_b32 v16, 15, v0
    v_lshrrev_b32 v17, 1, v11
    v_and_b32 v18, 1, v11
    v_lshlrev_b32 v19, 9, v18
    s_cmp_eq_u32 s48, 1
    s_cselect_b32 s61, 10, 12
    v_lshlrev_b32 v12, s61, v17
    v_add_u32 v12, v12, v19
    v_lshl_add_u32 v12, v16, 4, v12
    v_lshl_add_u32 v19, v17, 10, v19
    v_lshrrev_b32 v17, 3, v16
    v_and_b32 v18, 7, v16
    v_lshl_add_u32 v17, v17, 4, v18
    s_cmp_lt_u32 s44, 16
    s_cselect_b64 vcc, -1, 0
    s_mov_b32 s61, 0x80
    s_cmov_b32 s61, 0x100
    s_mov_b32 s62, 0x1000
    s_cmov_b32 s62, 0x800
    s_cselect_b32 s56, 0x3e8293ee, 1.0
    s_mov_b32 s57, s56
    s_mov_b32 s63, 0x800000
    s_cmov_b32 s63, 0x400000
    s_cselect_b32 s6, 17, 18
    v_cndmask_b32 v17, v17, v16, vcc
    v_lshl_add_u32 v13, v17, 4, v19
    v_add_u32 v14, s61, v13
    v_lshlrev_b32 v12, 4, v0
    v_mov_b32 v13, v12
    v_add_u32 v14, 0x400, v12
    s_mov_b32 s52, 0
    s_mov_b32 s53, s62
    s_lshl_b32 s54, s62, 1
    s_add_u32 s55, s54, s62
    s_and_b32 s7, s44, 15
    s_lshl_b32 s7, s7, 1
    s_add_u32 s7, s7, s47
    s_lshl_b32 s7, s7, s6
    s_add_u32 s63, s63, s7
    s_lshl_b32 s7, s43, 3
    s_lshl_b32 s8, s46, 2
    s_add_u32 s7, s7, s8
    s_mul_i32 s8, s7, s62
    s_add_u32 s63, s63, s8
    s_lshl_b32 s9, s62, 2
    s_add_u32 s32, s4, s63
    s_addc_u32 s33, s5, 0
    s_and_b32 s33, s33, 0xffff
    s_mov_b32 s34, s9
    s_mov_b32 s35, 0x20000
    s_lshl_b32 s8, s43, 1
    s_add_u32 s8, s8, s46
    s_mul_i32 s8, s8, 917504
    s_lshl_b32 s9, s44, 1
    s_add_u32 s9, s9, s47
    s_lshl_b32 s9, s9, 14
    s_add_u32 s8, s8, s9
    s_add_u32 s8, s8, 0x1000000
    s_sub_u32 s9, s44, 28
    s_lshl_b32 s9, s9, 2
    s_add_u32 s9, s9, s47
    s_lshl_b32 s9, s9, 19
    s_lshl_b32 s10, s7, 12
    s_add_u32 s9, s9, s10
    s_add_u32 s9, s9, 0x800800
    s_cmp_eq_u32 s48, 1
    s_cselect_b32 s8, s9, s8
    s_mov_b32 s9, 0x4000
    s_cmov_b32 s9, 0x143800
    s_add_u32 s28, s4, s8
    s_addc_u32 s29, s5, 0
    s_and_b32 s29, s29, 0xffff
    s_mov_b32 s30, s9
    s_mov_b32 s31, 0x20000
    s_mov_b32 s50, 0x2000
    s_mov_b32 s58, 0xbfb8aa3b
    s_mov_b32 s59, s58
    v_lshrrev_b32 v16, 3, v0
    s_lshl_b32 s3, s45, 5
    v_add_u32 v16, s3, v16
    v_mul_u32_u24 v1, 4224, v16
    v_and_b32 v16, 7, v0
    v_lshl_add_u32 v1, v16, 4, v1
    v_add_u32 v17, 0x8000, v1
    v_add_u32 v18, 0x10000, v1
    v_add_u32 v19, 0x18000, v1
    v_bfe_u32 v16, v0, 3, 1
    v_lshlrev_b32 v16, 1, v16
    v_lshrrev_b32 v4, 4, v0
    v_xor_b32 v4, v4, v16
    v_lshlrev_b32 v4, 4, v4
    v_and_b32 v16, 15, v0
    v_lshl_add_u32 v4, v16, 6, v4
    s_lshl_b32 s3, s46, 13
    v_add_u32 v4, s3, v4
    s_and_b32 s3, s2, 7
    s_lshl_b32 s3, s3, 2
    s_lshr_b32 s3, 0x04621753, s3
    s_and_b32 s3, s3, 7
    s_lshl_b32 s3, s3, 2
    s_lshr_b32 s6, s2, 6
    s_add_u32 s3, s3, s6
    s_lshr_b32 s6, s3, 1
    s_lshr_b32 s7, s3, 3
    s_add_u32 s7, s7, 28
    v_mov_b32 v24, s6
    v_mov_b32 v26, s7
    s_bfe_u32 s3, s2, 0x30003
    v_mov_b32 v25, s3
    v_and_b32 v27, 7, v0
    v_cmp_gt_u32 vcc, 16, v0
    s_add_u32 s6, s6, 16
    v_mov_b32 v28, s6
    v_cndmask_b32 v24, v24, v26, vcc
    v_cndmask_b32 v25, v25, v27, vcc
    v_cmp_gt_u32 vcc, 8, v0
    s_nop 1
    v_cndmask_b32 v24, v24, v28, vcc
    v_mul_u32_u24 v15, 43, v24
    v_lshrrev_b32 v15, 7, v15
    v_mul_u32_u24 v26, 3, v15
    v_sub_u32 v26, v24, v26
    v_lshl_add_u32 v15, v26, 6, v15
    v_and_b32 v26, 3, v24
    v_lshlrev_b32 v26, 1, v26
    v_lshrrev_b32 v27, 2, v25
    v_bfe_u32 v28, v24, 2, 1
    v_xor_b32 v27, v27, v28
    v_xor_b32 v27, 1, v27
    v_add3_u32 v26, v26, v27, 64
    v_add_u32 v26, 128, v26
    v_cmp_gt_u32 vcc, 24, v24
    s_nop 1
    v_cndmask_b32 v15, v26, v15, vcc
    v_lshl_add_u32 v15, v25, 3, v15
    v_lshlrev_b32 v15, 7, v15
    s_lshr_b32 s3, s2, 3
    s_lshl_b32 s3, s3, 2
    s_add_u32 s3, s3, s45
    v_and_b32 v11, 3, v0
    v_lshlrev_b32 v11, 5, v11
    v_add_u32 v11, s3, v11
    v_and_b32 v11, 127, v11
    v_lshlrev_b32 v11, 7, v11
    s_mov_b64 s[74:75], s[76:77]
    s_add_u32 s76, s4, 0x2800000
    s_addc_u32 s77, s5, 0
    s_and_b32 s77, s77, 0xffff
    s_mov_b32 s78, 0x8000
    s_mov_b32 s79, 0x20000
    s_lshl_b32 s73, s2, 7
    s_lshl_b32 s60, s43, 12
    v_and_b32 v20, 31, v0
    v_lshlrev_b32 v20, 7, v20
    v_mov_b32 v22, 1
    s_waitcnt vmcnt(0)
    s_barrier
    s_cmp_eq_u32 s45, 3
    s_cbranch_scc1 L_p0_sig
    s_mov_b64 exec, 0
    s_cmp_eq_u32 s45, 0
    s_cbranch_scc1 L_pw0
    s_cmp_eq_u32 s45, 1
    s_cbranch_scc1 L_pw1
    s_branch L_pw2
L_pw_back:
    s_mov_b64 exec, -1
    s_branch L_p0_polled
L_p0_sig:
    s_mov_b32 s61, 0x40000
L_p0_go:
    v_cmp_ne_u32 vcc, 1, v23
    s_sub_u32 s61, s61, 1
    s_cmp_eq_u32 s61, 0
    s_cbranch_scc1 L_p0_gone
    s_nop 1
    s_cbranch_vccz L_p0_gone
    global_load_dword v23, v21, s[74:75] sc1
    s_waitcnt vmcnt(0)
    s_branch L_p0_go
L_p0_gone:
    s_mov_b64 exec, 1
    buffer_store_dword v22, v21, s[76:79], s73 offen sc1
    s_mov_b64 exec, -1
    s_mov_b32 s61, 0x40000
L_p0_poll:
    buffer_load_dword v23, v20, s[76:79], s60 offen sc1
    s_sub_u32 s61, s61, 1
    s_waitcnt vmcnt(0)
    v_cmp_gt_u32 vcc, 1, v23
    s_cmp_eq_u32 s61, 0
    s_cbranch_scc1 L_p0_polled
    s_nop 2
    s_cbranch_vccnz L_p0_poll
L_p0_polled:
    s_barrier
    s_add_u32 m0, s40, 0
    s_nop 0
    buffer_load_dwordx4 v1, s[12:15], s36 offen offset:0 sc1 lds
    buffer_load_dwordx4 v17, s[12:15], s36 offen offset:1024 sc1 lds
    buffer_load_dwordx4 v18, s[12:15], s36 offen offset:2048 sc1 lds
    buffer_load_dwordx4 v19, s[12:15], s36 offen offset:3072 sc1 lds
    s_add_u32 s36, s36, 0x80
    s_add_u32 m0, s40, 16384
    s_nop 0
    buffer_load_dwordx4 v1, s[12:15], s36 offen offset:0 sc1 lds
    buffer_load_dwordx4 v17, s[12:15], s36 offen offset:1024 sc1 lds
    buffer_load_dwordx4 v18, s[12:15], s36 offen offset:2048 sc1 lds
    buffer_load_dwordx4 v19, s[12:15], s36 offen offset:3072 sc1 lds
    s_add_u32 s36, s36, 0x80
    s_load_dwordx4 s[60:63], s[0:1], 48
    s_load_dwordx2 s[8:9], s[0:1], 16
    s_load_dwordx2 s[10:11], s[0:1], 0
    s_add_u32 m0, s41, 8192
    s_nop 0
    buffer_load_dwordx4 v2, s[16:19], s37 offen offset:0 lds
    s_add_u32 m0, s41, 24448
    s_nop 0
    buffer_load_dwordx4 v2, s[16:19], s37 offen offset:128 lds
    s_add_u32 m0, s41, 40960
    s_nop 0
    buffer_load_dwordx4 v2, s[20:23], s37 offen offset:0 lds
    s_add_u32 m0, s41, 57216
    s_nop 0
    buffer_load_dwordx4 v2, s[20:23], s37 offen offset:128 lds
    s_add_u32 m0, s41, 73728
    s_nop 0
    buffer_load_dwordx4 v3, s[24:27], s38 offen offset:0 lds
    s_add_u32 s37, s37, s39
    s_add_u32 s38, s38, 196608
    s_waitcnt vmcnt(5)
    s_barrier
    ds_read_b128 a[0:3], v4 offset:0
    ds_read_b128 a[4:7], v4 offset:16384
    ds_read_b64_tr_b16 a[32:33], v5 offset:0
    ds_read_b64_tr_b16 a[34:35], v5 offset:512
    ds_read_b64_tr_b16 a[36:37], v5 offset:4096
    ds_read_b64_tr_b16 a[38:39], v5 offset:4608
    ds_read_b64_tr_b16 a[40:41], v6 offset:0
    ds_read_b64_tr_b16 a[42:43], v6 offset:512
    ds_read_b64_tr_b16 a[44:45], v6 offset:4096
    ds_read_b64_tr_b16 a[46:47], v6 offset:4608
    ds_read_b64_tr_b16 a[48:49], v7 offset:0
    ds_read_b64_tr_b16 a[50:51], v7 offset:512
    ds_read_b64_tr_b16 a[52:53], v7 offset:4096
    ds_read_b64_tr_b16 a[54:55], v7 offset:4608
    ds_read_b64_tr_b16 a[56:57], v8 offset:0
    ds_read_b64_tr_b16 a[58:59], v8 offset:512
    ds_read_b64_tr_b16 a[60:61], v8 offset:4096
    ds_read_b64_tr_b16 a[62:63], v8 offset:4608
    ds_read_b64_tr_b16 a[96:97], v5 offset:32768
    ds_read_b64_tr_b16 a[98:99], v5 offset:33280
    ds_read_b64_tr_b16 a[100:101], v5 offset:36864
    ds_read_b64_tr_b16 a[102:103], v5 offset:37376
    ds_read_b64_tr_b16 a[104:105], v6 offset:32768
    ds_read_b64_tr_b16 a[106:107], v6 offset:33280
    ds_read_b64_tr_b16 a[108:109], v6 offset:36864
    ds_read_b64_tr_b16 a[110:111], v6 offset:37376
    ds_read_b64_tr_b16 a[112:113], v7 offset:32768
    ds_read_b64_tr_b16 a[114:115], v7 offset:33280
    ds_read_b64_tr_b16 a[116:117], v7 offset:36864
    ds_read_b64_tr_b16 a[118:119], v7 offset:37376
    ds_read_b64_tr_b16 a[120:121], v8 offset:32768
    ds_read_b64_tr_b16 a[122:123], v8 offset:33280
    ds_read_b64_tr_b16 a[124:125], v8 offset:36864
    ds_read_b64_tr_b16 a[126:127], v8 offset:37376
    ds_read_b64_tr_b16 a[128:129], v9 offset:0
    ds_read_b64_tr_b16 a[130:131], v9 offset:512
    ds_read_b64_tr_b16 a[132:133], v9 offset:4096
    ds_read_b64_tr_b16 a[134:135], v9 offset:4608
    s_mov_b32 s42, 6
    s_cmp_eq_u32 s48, 1
    s_waitcnt lgkmcnt(0)
    s_cbranch_scc1 L_k1_v
    s_branch L_pg_base
.p2align 12
L_pg_base:
L_pw0:
    s_cbranch_execz L_pw3
    v_mfma_f32_16x16x32_bf16 v[48:51], a[32:35], a[0:3], 0
    v_mfma_f32_16x16x32_bf16 v[48:51], a[36:39], a[4:7], v[48:51]
    s_add_u32 m0, s40, 32768
    ds_read_b64_tr_b16 a[136:137], v10 offset:0
    v_mfma_f32_16x16x32_bf16 v[52:55], a[44:47], a[4:7], 0
    ds_read_b64_tr_b16 a[138:139], v10 offset:512
    buffer_load_dwordx4 v1, s[12:15], s36 offen offset:0 sc1 lds
    v_mfma_f32_16x16x32_bf16 v[52:55], a[40:43], a[0:3], v[52:55]
    ds_read_b64_tr_b16 a[140:141], v10 offset:4096
    v_mfma_f32_16x16x32_bf16 v[56:59], a[48:51], a[0:3], 0
    ds_read_b64_tr_b16 a[142:143], v10 offset:4608
    v_mfma_f32_16x16x32_bf16 v[56:59], a[52:55], a[4:7], v[56:59]
    ds_read_b128 a[8:11], v4 offset:1024
    v_mfma_f32_16x16x32_bf16 v[60:63], a[60:63], a[4:7], 0
    ds_read_b128 a[12:15], v4 offset:17408
    buffer_load_dwordx4 v17, s[12:15], s36 offen offset:1024 sc1 lds
    v_mfma_f32_16x16x32_bf16 v[60:63], a[56:59], a[0:3], v[60:63]
    v_mfma_f32_16x16x32_bf16 v[176:179], a[96:99], a[0:3], 0
    v_mfma_f32_16x16x32_bf16 v[176:179], a[100:103], a[4:7], v[176:179]
    ds_read_b128 a[16:19], v4 offset:2048
    v_mfma_f32_16x16x32_bf16 v[180:183], a[108:111], a[4:7], 0
    buffer_load_dwordx4 v18, s[12:15], s36 offen offset:2048 sc1 lds
    v_mfma_f32_16x16x32_bf16 v[180:183], a[104:107], a[0:3], v[180:183]
    v_mfma_f32_16x16x32_bf16 v[184:187], a[112:115], a[0:3], 0
    v_mfma_f32_16x16x32_bf16 v[184:187], a[116:119], a[4:7], v[184:187]
    ds_read_b128 a[20:23], v4 offset:18432
    v_mfma_f32_16x16x32_bf16 v[188:191], a[124:127], a[4:7], 0
    buffer_load_dwordx4 v19, s[12:15], s36 offen offset:3072 sc1 lds
    v_mfma_f32_16x16x32_bf16 v[188:191], a[120:123], a[0:3], v[188:191]
    s_add_u32 s36, s36, 0x80
    v_mfma_f32_16x16x32_bf16 a[192:195], a[128:131], a[0:3], 0
    v_mfma_f32_16x16x32_bf16 a[192:195], a[132:135], a[4:7], a[192:195]
    s_waitcnt lgkmcnt(4)
    s_add_u32 m0, s40, 49152
    v_mfma_f32_16x16x32_bf16 a[196:199], a[140:143], a[4:7], 0
    buffer_load_dwordx4 v1, s[12:15], s36 offen offset:0 sc1 lds
    v_mfma_f32_16x16x32_bf16 a[196:199], a[136:139], a[0:3], a[196:199]
    s_waitcnt lgkmcnt(2)
    v_mfma_f32_16x16x32_bf16 a[204:207], a[136:139], a[8:11], 0
    v_mfma_f32_16x16x32_bf16 a[204:207], a[140:143], a[12:15], a[204:207]
    s_barrier
    v_mfma_f32_16x16x32_bf16 a[200:203], a[132:135], a[12:15], 0
    buffer_load_dwordx4 v17, s[12:15], s36 offen offset:1024 sc1 lds
    v_mfma_f32_16x16x32_bf16 a[200:203], a[128:131], a[8:11], a[200:203]
    v_mfma_f32_16x16x32_bf16 v[204:207], a[120:123], a[8:11], 0
    v_mfma_f32_16x16x32_bf16 v[204:207], a[124:127], a[12:15], v[204:207]
    v_mfma_f32_16x16x32_bf16 v[200:203], a[116:119], a[12:15], 0
    buffer_load_dwordx4 v18, s[12:15], s36 offen offset:2048 sc1 lds
    v_mfma_f32_16x16x32_bf16 v[200:203], a[112:115], a[8:11], v[200:203]
    v_mfma_f32_16x16x32_bf16 v[196:199], a[104:107], a[8:11], 0
    v_mfma_f32_16x16x32_bf16 v[196:199], a[108:111], a[12:15], v[196:199]
    ds_read_b128 a[24:27], v4 offset:3072
    v_mfma_f32_16x16x32_bf16 v[192:195], a[100:103], a[12:15], 0
    buffer_load_dwordx4 v19, s[12:15], s36 offen offset:3072 sc1 lds
    v_mfma_f32_16x16x32_bf16 v[192:195], a[96:99], a[8:11], v[192:195]
    v_mfma_f32_16x16x32_bf16 v[76:79], a[56:59], a[8:11], 0
    v_mfma_f32_16x16x32_bf16 v[76:79], a[60:63], a[12:15], v[76:79]
    s_add_u32 m0, s41, 12288
    ds_read_b128 a[28:31], v4 offset:19456
    v_mfma_f32_16x16x32_bf16 v[72:75], a[52:55], a[12:15], 0
    buffer_load_dwordx4 v2, s[16:19], s37 offen offset:0 lds
    v_mfma_f32_16x16x32_bf16 v[72:75], a[48:51], a[8:11], v[72:75]
    v_mfma_f32_16x16x32_bf16 v[68:71], a[40:43], a[8:11], 0
    v_mfma_f32_16x16x32_bf16 v[68:71], a[44:47], a[12:15], v[68:71]
    s_add_u32 m0, s41, 28544
    v_mfma_f32_16x16x32_bf16 v[64:67], a[36:39], a[12:15], 0
    buffer_load_dwordx4 v2, s[16:19], s37 offen offset:128 lds
    v_mfma_f32_16x16x32_bf16 v[64:67], a[32:35], a[8:11], v[64:67]
    s_waitcnt lgkmcnt(2)
    v_mfma_f32_16x16x32_bf16 v[80:83], a[32:35], a[16:19], 0
    v_mfma_f32_16x16x32_bf16 v[80:83], a[36:39], a[20:23], v[80:83]
    s_add_u32 m0, s41, 45056
    v_mfma_f32_16x16x32_bf16 v[84:87], a[44:47], a[20:23], 0
    buffer_load_dwordx4 v2, s[20:23], s37 offen offset:0 lds
    v_mfma_f32_16x16x32_bf16 v[84:87], a[40:43], a[16:19], v[84:87]
    v_mfma_f32_16x16x32_bf16 v[88:91], a[48:51], a[16:19], 0
    v_mfma_f32_16x16x32_bf16 v[88:91], a[52:55], a[20:23], v[88:91]
    s_add_u32 m0, s41, 61312
    v_mfma_f32_16x16x32_bf16 v[92:95], a[60:63], a[20:23], 0
    buffer_load_dwordx4 v2, s[20:23], s37 offen offset:128 lds
    v_mfma_f32_16x16x32_bf16 v[92:95], a[56:59], a[16:19], v[92:95]
    v_mfma_f32_16x16x32_bf16 v[208:211], a[96:99], a[16:19], 0
    v_mfma_f32_16x16x32_bf16 v[208:211], a[100:103], a[20:23], v[208:211]
    s_add_u32 m0, s41, 77824
    ds_read_b128 a[0:3], v4 offset:4096
    v_mfma_f32_16x16x32_bf16 v[212:215], a[108:111], a[20:23], 0
    buffer_load_dwordx4 v3, s[24:27], s38 offen offset:0 lds
    v_mfma_f32_16x16x32_bf16 v[212:215], a[104:107], a[16:19], v[212:215]
    s_add_u32 s36, s36, 0x80
    v_mfma_f32_16x16x32_bf16 v[216:219], a[112:115], a[16:19], 0
    s_add_u32 s37, s37, s39
    v_mfma_f32_16x16x32_bf16 v[216:219], a[116:119], a[20:23], v[216:219]
    s_add_u32 s38, s38, 196608
    ds_read_b128 a[4:7], v4 offset:20480
    v_mfma_f32_16x16x32_bf16 v[220:223], a[124:127], a[20:23], 0
    v_mfma_f32_16x16x32_bf16 v[220:223], a[120:123], a[16:19], v[220:223]
    v_mfma_f32_16x16x32_bf16 a[208:211], a[128:131], a[16:19], 0
    s_add_u32 m0, s41, 0
    v_mfma_f32_16x16x32_bf16 a[208:211], a[132:135], a[20:23], a[208:211]
    buffer_load_dwordx4 v2, s[16:19], s37 offen offset:0 lds
    v_mfma_f32_16x16x32_bf16 a[212:215], a[140:143], a[20:23], 0
    v_mfma_f32_16x16x32_bf16 a[212:215], a[136:139], a[16:19], a[212:215]
    s_waitcnt lgkmcnt(2)
    v_mfma_f32_16x16x32_bf16 a[220:223], a[136:139], a[24:27], 0
    v_mfma_f32_16x16x32_bf16 a[220:223], a[140:143], a[28:31], a[220:223]
    s_add_u32 m0, s41, 16256
    v_mfma_f32_16x16x32_bf16 a[216:219], a[132:135], a[28:31], 0
    buffer_load_dwordx4 v2, s[16:19], s37 offen offset:128 lds
    v_mfma_f32_16x16x32_bf16 a[216:219], a[128:131], a[24:27], a[216:219]
    v_mfma_f32_16x16x32_bf16 v[236:239], a[120:123], a[24:27], 0
    v_mfma_f32_16x16x32_bf16 v[236:239], a[124:127], a[28:31], v[236:239]
    v_mfma_f32_16x16x32_bf16 v[232:235], a[116:119], a[28:31], 0
    v_mfma_f32_16x16x32_bf16 v[232:235], a[112:115], a[24:27], v[232:235]
    s_add_u32 m0, s41, 32768
    v_mfma_f32_16x16x32_bf16 v[228:231], a[104:107], a[24:27], 0
    buffer_load_dwordx4 v2, s[20:23], s37 offen offset:0 lds
    v_mfma_f32_16x16x32_bf16 v[228:231], a[108:111], a[28:31], v[228:231]
    ds_read_b128 a[8:11], v4 offset:5120
    v_mfma_f32_16x16x32_bf16 v[224:227], a[100:103], a[28:31], 0
    v_mfma_f32_16x16x32_bf16 v[224:227], a[96:99], a[24:27], v[224:227]
    v_mfma_f32_16x16x32_bf16 v[108:111], a[56:59], a[24:27], 0
    s_add_u32 m0, s41, 49024
    v_mfma_f32_16x16x32_bf16 v[108:111], a[60:63], a[28:31], v[108:111]
    ds_read_b128 a[12:15], v4 offset:21504
    buffer_load_dwordx4 v2, s[20:23], s37 offen offset:128 lds
    v_mfma_f32_16x16x32_bf16 v[104:107], a[52:55], a[28:31], 0
    v_mfma_f32_16x16x32_bf16 v[104:107], a[48:51], a[24:27], v[104:107]
    v_mfma_f32_16x16x32_bf16 v[100:103], a[40:43], a[24:27], 0
    v_mfma_f32_16x16x32_bf16 v[100:103], a[44:47], a[28:31], v[100:103]
    v_mfma_f32_16x16x32_bf16 v[96:99], a[36:39], a[28:31], 0
    s_add_u32 m0, s41, 65536
    v_mfma_f32_16x16x32_bf16 v[96:99], a[32:35], a[24:27], v[96:99]
    s_waitcnt lgkmcnt(2)
    buffer_load_dwordx4 v3, s[24:27], s38 offen offset:0 lds
    v_mfma_f32_16x16x32_bf16 v[112:115], a[32:35], a[0:3], 0
    s_add_u32 s37, s37, s39
    v_mfma_f32_16x16x32_bf16 v[112:115], a[36:39], a[4:7], v[112:115]
    s_add_u32 s38, s38, 196608
    v_mfma_f32_16x16x32_bf16 v[116:119], a[44:47], a[4:7], 0
    v_mfma_f32_16x16x32_bf16 v[116:119], a[40:43], a[0:3], v[116:119]
    s_add_u32 m0, s41, 4096
    v_mfma_f32_16x16x32_bf16 v[120:123], a[48:51], a[0:3], 0
    buffer_load_dwordx4 v2, s[16:19], s37 offen offset:0 lds
    v_mfma_f32_16x16x32_bf16 v[120:123], a[52:55], a[4:7], v[120:123]
    v_mfma_f32_16x16x32_bf16 v[124:127], a[60:63], a[4:7], 0
    v_mfma_f32_16x16x32_bf16 v[124:127], a[56:59], a[0:3], v[124:127]
    v_mfma_f32_16x16x32_bf16 v[240:243], a[96:99], a[0:3], 0
    v_mfma_f32_16x16x32_bf16 v[240:243], a[100:103], a[4:7], v[240:243]
    s_add_u32 m0, s41, 20352
    ds_read_b128 a[16:19], v4 offset:6144
    v_mfma_f32_16x16x32_bf16 v[244:247], a[108:111], a[4:7], 0
    buffer_load_dwordx4 v2, s[16:19], s37 offen offset:128 lds
    v_mfma_f32_16x16x32_bf16 v[244:247], a[104:107], a[0:3], v[244:247]
    v_mfma_f32_16x16x32_bf16 v[248:251], a[112:115], a[0:3], 0
    v_mfma_f32_16x16x32_bf16 v[248:251], a[116:119], a[4:7], v[248:251]
    ds_read_b128 a[20:23], v4 offset:22528
    v_mfma_f32_16x16x32_bf16 v[252:255], a[124:127], a[4:7], 0
    s_add_u32 m0, s41, 36864
    v_mfma_f32_16x16x32_bf16 v[252:255], a[120:123], a[0:3], v[252:255]
    buffer_load_dwordx4 v2, s[20:23], s37 offen offset:0 lds
    v_mfma_f32_16x16x32_bf16 a[224:227], a[128:131], a[0:3], 0
    v_mfma_f32_16x16x32_bf16 a[224:227], a[132:135], a[4:7], a[224:227]
    v_mfma_f32_16x16x32_bf16 a[228:231], a[140:143], a[4:7], 0
    v_mfma_f32_16x16x32_bf16 a[228:231], a[136:139], a[0:3], a[228:231]
    s_waitcnt lgkmcnt(2)
    v_mfma_f32_16x16x32_bf16 a[236:239], a[136:139], a[8:11], 0
    s_add_u32 m0, s41, 53120
    v_mfma_f32_16x16x32_bf16 a[236:239], a[140:143], a[12:15], a[236:239]
    buffer_load_dwordx4 v2, s[20:23], s37 offen offset:128 lds
    v_mfma_f32_16x16x32_bf16 a[232:235], a[132:135], a[12:15], 0
    v_mfma_f32_16x16x32_bf16 a[232:235], a[128:131], a[8:11], a[232:235]
    ds_read_b128 a[24:27], v4 offset:7168
    v_mfma_f32_16x16x32_bf16 a[156:159], a[120:123], a[8:11], 0
    v_mfma_f32_16x16x32_bf16 a[156:159], a[124:127], a[12:15], a[156:159]
    s_add_u32 m0, s41, 69632
    v_mfma_f32_16x16x32_bf16 a[152:155], a[116:119], a[12:15], 0
    buffer_load_dwordx4 v3, s[24:27], s38 offen offset:0 lds
    v_mfma_f32_16x16x32_bf16 a[152:155], a[112:115], a[8:11], a[152:155]
    s_add_u32 s37, s37, s39
    ds_read_b128 a[28:31], v4 offset:23552
    v_mfma_f32_16x16x32_bf16 a[148:151], a[104:107], a[8:11], 0
    s_add_u32 s38, s38, 196608
    v_mfma_f32_16x16x32_bf16 a[148:151], a[108:111], a[12:15], a[148:151]
    v_mfma_f32_16x16x32_bf16 a[144:147], a[100:103], a[12:15], 0
    v_mfma_f32_16x16x32_bf16 a[144:147], a[96:99], a[8:11], a[144:147]
    v_mfma_f32_16x16x32_bf16 v[140:143], a[56:59], a[8:11], 0
    v_mfma_f32_16x16x32_bf16 v[140:143], a[60:63], a[12:15], v[140:143]
    v_mfma_f32_16x16x32_bf16 v[136:139], a[52:55], a[12:15], 0
    buffer_load_dword v46, v44, s[64:67], s49 offen
    v_mfma_f32_16x16x32_bf16 v[136:139], a[48:51], a[8:11], v[136:139]
    s_add_u32 s49, s49, s72
    v_mfma_f32_16x16x32_bf16 v[132:135], a[40:43], a[8:11], 0
    v_mfma_f32_16x16x32_bf16 v[132:135], a[44:47], a[12:15], v[132:135]
    v_mfma_f32_16x16x32_bf16 v[128:131], a[36:39], a[12:15], 0
    buffer_load_dword v46, v44, s[64:67], s49 offen
    v_mfma_f32_16x16x32_bf16 v[128:131], a[32:35], a[8:11], v[128:131]
    s_waitcnt lgkmcnt(2)
    s_add_u32 s49, s49, s72
    v_mfma_f32_16x16x32_bf16 v[144:147], a[32:35], a[16:19], 0
    v_mfma_f32_16x16x32_bf16 v[144:147], a[36:39], a[20:23], v[144:147]
    s_waitcnt vmcnt(12) lgkmcnt(0)
    v_mfma_f32_16x16x32_bf16 v[148:151], a[44:47], a[20:23], 0
    s_barrier
    v_mfma_f32_16x16x32_bf16 v[148:151], a[40:43], a[16:19], v[148:151]
    ds_read_b64_tr_b16 a[64:65], v5 offset:8192
    v_mfma_f32_16x16x32_bf16 v[152:155], a[48:51], a[16:19], 0
    ds_read_b64_tr_b16 a[66:67], v5 offset:8704
    v_mfma_f32_16x16x32_bf16 v[152:155], a[52:55], a[20:23], v[152:155]
    ds_read_b64_tr_b16 a[68:69], v5 offset:12288
    v_mfma_f32_16x16x32_bf16 v[156:159], a[60:63], a[20:23], 0
    ds_read_b64_tr_b16 a[70:71], v5 offset:12800
    v_mfma_f32_16x16x32_bf16 v[156:159], a[56:59], a[16:19], v[156:159]
    ds_read_b64_tr_b16 a[72:73], v6 offset:8192
    v_mfma_f32_16x16x32_bf16 a[160:163], a[96:99], a[16:19], 0
    ds_read_b64_tr_b16 a[74:75], v6 offset:8704
    v_mfma_f32_16x16x32_bf16 a[160:163], a[100:103], a[20:23], a[160:163]
    ds_read_b64_tr_b16 a[76:77], v6 offset:12288
    v_mfma_f32_16x16x32_bf16 a[164:167], a[108:111], a[20:23], 0
    ds_read_b64_tr_b16 a[78:79], v6 offset:12800
    v_mfma_f32_16x16x32_bf16 a[164:167], a[104:107], a[16:19], a[164:167]
    ds_read_b64_tr_b16 a[80:81], v7 offset:8192
    v_mfma_f32_16x16x32_bf16 a[168:171], a[112:115], a[16:19], 0
    ds_read_b64_tr_b16 a[82:83], v7 offset:8704
    v_mfma_f32_16x16x32_bf16 a[168:171], a[116:119], a[20:23], a[168:171]
    ds_read_b64_tr_b16 a[84:85], v7 offset:12288
    v_mfma_f32_16x16x32_bf16 a[172:175], a[124:127], a[20:23], 0
    ds_read_b64_tr_b16 a[86:87], v7 offset:12800
    v_mfma_f32_16x16x32_bf16 a[172:175], a[120:123], a[16:19], a[172:175]
    ds_read_b64_tr_b16 a[88:89], v8 offset:8192
    v_mfma_f32_16x16x32_bf16 a[240:243], a[128:131], a[16:19], 0
    ds_read_b64_tr_b16 a[90:91], v8 offset:8704
    v_mfma_f32_16x16x32_bf16 a[240:243], a[132:135], a[20:23], a[240:243]
    ds_read_b64_tr_b16 a[92:93], v8 offset:12288
    v_mfma_f32_16x16x32_bf16 a[244:247], a[140:143], a[20:23], 0
    ds_read_b64_tr_b16 a[94:95], v8 offset:12800
    v_mfma_f32_16x16x32_bf16 a[244:247], a[136:139], a[16:19], a[244:247]
    ds_read_b128 a[0:3], v4 offset:32768
    v_mfma_f32_16x16x32_bf16 a[176:179], a[96:99], a[24:27], 0
    ds_read_b128 a[4:7], v4 offset:49152
    v_mfma_f32_16x16x32_bf16 a[176:179], a[100:103], a[28:31], a[176:179]
    ds_read_b64_tr_b16 a[96:97], v5 offset:40960
    v_mfma_f32_16x16x32_bf16 a[180:183], a[108:111], a[28:31], 0
    ds_read_b64_tr_b16 a[98:99], v5 offset:41472
    v_mfma_f32_16x16x32_bf16 a[180:183], a[104:107], a[24:27], a[180:183]
    ds_read_b64_tr_b16 a[100:101], v5 offset:45056
    v_mfma_f32_16x16x32_bf16 a[184:187], a[112:115], a[24:27], 0
    ds_read_b64_tr_b16 a[102:103], v5 offset:45568
    v_mfma_f32_16x16x32_bf16 a[184:187], a[116:119], a[28:31], a[184:187]
    ds_read_b64_tr_b16 a[104:105], v6 offset:40960
    v_mfma_f32_16x16x32_bf16 a[188:191], a[124:127], a[28:31], 0
    ds_read_b64_tr_b16 a[106:107], v6 offset:41472
    v_mfma_f32_16x16x32_bf16 a[188:191], a[120:123], a[24:27], a[188:191]
    ds_read_b64_tr_b16 a[108:109], v6 offset:45056
    v_mfma_f32_16x16x32_bf16 a[248:251], a[128:131], a[24:27], 0
    ds_read_b64_tr_b16 a[110:111], v6 offset:45568
    v_mfma_f32_16x16x32_bf16 a[248:251], a[132:135], a[28:31], a[248:251]
    ds_read_b64_tr_b16 a[112:113], v7 offset:40960
    v_mfma_f32_16x16x32_bf16 a[252:255], a[140:143], a[28:31], 0
    ds_read_b64_tr_b16 a[114:115], v7 offset:41472
    v_mfma_f32_16x16x32_bf16 a[252:255], a[136:139], a[24:27], a[252:255]
    ds_read_b64_tr_b16 a[116:117], v7 offset:45056
    v_mfma_f32_16x16x32_bf16 v[160:163], a[32:35], a[24:27], 0
    ds_read_b64_tr_b16 a[118:119], v7 offset:45568
    v_mfma_f32_16x16x32_bf16 v[160:163], a[36:39], a[28:31], v[160:163]
    ds_read_b64_tr_b16 a[120:121], v8 offset:40960
    v_mfma_f32_16x16x32_bf16 v[164:167], a[44:47], a[28:31], 0
    ds_read_b64_tr_b16 a[122:123], v8 offset:41472
    v_mfma_f32_16x16x32_bf16 v[164:167], a[40:43], a[24:27], v[164:167]
    ds_read_b64_tr_b16 a[124:125], v8 offset:45056
    v_mfma_f32_16x16x32_bf16 v[168:171], a[48:51], a[24:27], 0
    ds_read_b64_tr_b16 a[126:127], v8 offset:45568
    v_mfma_f32_16x16x32_bf16 v[168:171], a[52:55], a[28:31], v[168:171]
    ds_read_b64_tr_b16 a[128:129], v9 offset:8192
    v_mfma_f32_16x16x32_bf16 v[172:175], a[60:63], a[28:31], 0
    ds_read_b64_tr_b16 a[130:131], v9 offset:8704
    v_mfma_f32_16x16x32_bf16 v[172:175], a[56:59], a[24:27], v[172:175]
    s_waitcnt lgkmcnt(15)
    ds_read_b64_tr_b16 a[132:133], v9 offset:12288
.p2align 6
L_k1_loop_f:
    v_mfma_f32_16x16x32_bf16 v[48:51], a[64:67], a[0:3], v[48:51]
    ds_read_b64_tr_b16 a[134:135], v9 offset:12800
    v_mfma_f32_16x16x32_bf16 v[48:51], a[68:71], a[4:7], v[48:51]
    ds_read_b64_tr_b16 a[136:137], v10 offset:8192
    v_mfma_f32_16x16x32_bf16 v[52:55], a[76:79], a[4:7], v[52:55]
    ds_read_b64_tr_b16 a[138:139], v10 offset:8704
    v_mfma_f32_16x16x32_bf16 v[52:55], a[72:75], a[0:3], v[52:55]
    ds_read_b64_tr_b16 a[140:141], v10 offset:12288
    v_mfma_f32_16x16x32_bf16 v[56:59], a[80:83], a[0:3], v[56:59]
    ds_read_b64_tr_b16 a[142:143], v10 offset:12800
    v_mfma_f32_16x16x32_bf16 v[56:59], a[84:87], a[4:7], v[56:59]
    ds_read_b128 a[8:11], v4 offset:33792
    v_mfma_f32_16x16x32_bf16 v[60:63], a[92:95], a[4:7], v[60:63]
    s_add_u32 m0, s40, 0
    ds_read_b128 a[12:15], v4 offset:50176
    v_mfma_f32_16x16x32_bf16 v[60:63], a[88:91], a[0:3], v[60:63]
    s_waitcnt lgkmcnt(15)
    buffer_load_dwordx4 v1, s[12:15], s36 offen offset:0 sc1 lds
    v_mfma_f32_16x16x32_bf16 v[176:179], a[96:99], a[0:3], v[176:179]
    v_mfma_f32_16x16x32_bf16 v[176:179], a[100:103], a[4:7], v[176:179]
    ds_read_b128 a[16:19], v4 offset:34816
    v_mfma_f32_16x16x32_bf16 v[180:183], a[108:111], a[4:7], v[180:183]
    v_mfma_f32_16x16x32_bf16 v[180:183], a[104:107], a[0:3], v[180:183]
    s_waitcnt lgkmcnt(15)
    v_mfma_f32_16x16x32_bf16 v[184:187], a[112:115], a[0:3], v[184:187]
    buffer_load_dwordx4 v17, s[12:15], s36 offen offset:1024 sc1 lds
    v_mfma_f32_16x16x32_bf16 v[184:187], a[116:119], a[4:7], v[184:187]
    s_waitcnt lgkmcnt(11)
    ds_read_b128 a[20:23], v4 offset:51200
    v_mfma_f32_16x16x32_bf16 v[188:191], a[124:127], a[4:7], v[188:191]
    v_mfma_f32_16x16x32_bf16 v[188:191], a[120:123], a[0:3], v[188:191]
    s_waitcnt lgkmcnt(8)
    v_mfma_f32_16x16x32_bf16 a[192:195], a[128:131], a[0:3], a[192:195]
    v_mfma_f32_16x16x32_bf16 a[192:195], a[132:135], a[4:7], a[192:195]
    s_waitcnt lgkmcnt(4)
    buffer_load_dwordx4 v18, s[12:15], s36 offen offset:2048 sc1 lds
    v_mfma_f32_16x16x32_bf16 a[196:199], a[140:143], a[4:7], a[196:199]
    v_mfma_f32_16x16x32_bf16 a[196:199], a[136:139], a[0:3], a[196:199]
    s_waitcnt lgkmcnt(2)
    v_mfma_f32_16x16x32_bf16 a[204:207], a[136:139], a[8:11], a[204:207]
    v_mfma_f32_16x16x32_bf16 a[204:207], a[140:143], a[12:15], a[204:207]
    s_barrier
    v_mfma_f32_16x16x32_bf16 a[200:203], a[132:135], a[12:15], a[200:203]
    buffer_load_dwordx4 v19, s[12:15], s36 offen offset:3072 sc1 lds
    v_mfma_f32_16x16x32_bf16 a[200:203], a[128:131], a[8:11], a[200:203]
    s_add_u32 s36, s36, 0x80
    v_mfma_f32_16x16x32_bf16 v[204:207], a[120:123], a[8:11], v[204:207]
    v_mfma_f32_16x16x32_bf16 v[204:207], a[124:127], a[12:15], v[204:207]
    v_mfma_f32_16x16x32_bf16 v[200:203], a[116:119], a[12:15], v[200:203]
    s_add_u32 m0, s40, 16384
    v_mfma_f32_16x16x32_bf16 v[200:203], a[112:115], a[8:11], v[200:203]
    buffer_load_dwordx4 v1, s[12:15], s36 offen offset:0 sc1 lds
    v_mfma_f32_16x16x32_bf16 v[196:199], a[104:107], a[8:11], v[196:199]
    v_mfma_f32_16x16x32_bf16 v[196:199], a[108:111], a[12:15], v[196:199]
    ds_read_b128 a[24:27], v4 offset:35840
    v_mfma_f32_16x16x32_bf16 v[192:195], a[100:103], a[12:15], v[192:195]
    v_mfma_f32_16x16x32_bf16 v[192:195], a[96:99], a[8:11], v[192:195]
    v_mfma_f32_16x16x32_bf16 v[76:79], a[88:91], a[8:11], v[76:79]
    buffer_load_dwordx4 v17, s[12:15], s36 offen offset:1024 sc1 lds
    v_mfma_f32_16x16x32_bf16 v[76:79], a[92:95], a[12:15], v[76:79]
    ds_read_b128 a[28:31], v4 offset:52224
    v_mfma_f32_16x16x32_bf16 v[72:75], a[84:87], a[12:15], v[72:75]
    v_mfma_f32_16x16x32_bf16 v[72:75], a[80:83], a[8:11], v[72:75]
    v_mfma_f32_16x16x32_bf16 v[68:71], a[72:75], a[8:11], v[68:71]
    v_mfma_f32_16x16x32_bf16 v[68:71], a[76:79], a[12:15], v[68:71]
    buffer_load_dwordx4 v18, s[12:15], s36 offen offset:2048 sc1 lds
    v_mfma_f32_16x16x32_bf16 v[64:67], a[68:71], a[12:15], v[64:67]
    v_mfma_f32_16x16x32_bf16 v[64:67], a[64:67], a[8:11], v[64:67]
    s_waitcnt lgkmcnt(2)
    v_mfma_f32_16x16x32_bf16 v[80:83], a[64:67], a[16:19], v[80:83]
    v_mfma_f32_16x16x32_bf16 v[80:83], a[68:71], a[20:23], v[80:83]
    v_mfma_f32_16x16x32_bf16 v[84:87], a[76:79], a[20:23], v[84:87]
    buffer_load_dwordx4 v19, s[12:15], s36 offen offset:3072 sc1 lds
    v_mfma_f32_16x16x32_bf16 v[84:87], a[72:75], a[16:19], v[84:87]
    s_add_u32 s36, s36, 0x80
    v_mfma_f32_16x16x32_bf16 v[88:91], a[80:83], a[16:19], v[88:91]
    v_mfma_f32_16x16x32_bf16 v[88:91], a[84:87], a[20:23], v[88:91]
    v_mfma_f32_16x16x32_bf16 v[92:95], a[92:95], a[20:23], v[92:95]
    v_mfma_f32_16x16x32_bf16 v[92:95], a[88:91], a[16:19], v[92:95]
    s_add_u32 m0, s41, 8192
    v_mfma_f32_16x16x32_bf16 v[208:211], a[96:99], a[16:19], v[208:211]
    buffer_load_dwordx4 v2, s[16:19], s37 offen offset:0 lds
    v_mfma_f32_16x16x32_bf16 v[208:211], a[100:103], a[20:23], v[208:211]
    ds_read_b128 a[0:3], v4 offset:36864
    v_mfma_f32_16x16x32_bf16 v[212:215], a[108:111], a[20:23], v[212:215]
    v_mfma_f32_16x16x32_bf16 v[212:215], a[104:107], a[16:19], v[212:215]
    v_mfma_f32_16x16x32_bf16 v[216:219], a[112:115], a[16:19], v[216:219]
    v_mfma_f32_16x16x32_bf16 v[216:219], a[116:119], a[20:23], v[216:219]
    ds_read_b128 a[4:7], v4 offset:53248
    v_mfma_f32_16x16x32_bf16 v[220:223], a[124:127], a[20:23], v[220:223]
    s_add_u32 m0, s41, 24448
    v_mfma_f32_16x16x32_bf16 v[220:223], a[120:123], a[16:19], v[220:223]
    buffer_load_dwordx4 v2, s[16:19], s37 offen offset:128 lds
    v_mfma_f32_16x16x32_bf16 a[208:211], a[128:131], a[16:19], a[208:211]
    v_mfma_f32_16x16x32_bf16 a[208:211], a[132:135], a[20:23], a[208:211]
    v_mfma_f32_16x16x32_bf16 a[212:215], a[140:143], a[20:23], a[212:215]
    v_mfma_f32_16x16x32_bf16 a[212:215], a[136:139], a[16:19], a[212:215]
    s_waitcnt lgkmcnt(2)
    v_mfma_f32_16x16x32_bf16 a[220:223], a[136:139], a[24:27], a[220:223]
    s_add_u32 m0, s41, 40960
    v_mfma_f32_16x16x32_bf16 a[220:223], a[140:143], a[28:31], a[220:223]
    buffer_load_dwordx4 v2, s[20:23], s37 offen offset:0 lds
    v_mfma_f32_16x16x32_bf16 a[216:219], a[132:135], a[28:31], a[216:219]
    v_mfma_f32_16x16x32_bf16 a[216:219], a[128:131], a[24:27], a[216:219]
    v_mfma_f32_16x16x32_bf16 v[236:239], a[120:123], a[24:27], v[236:239]
    v_mfma_f32_16x16x32_bf16 v[236:239], a[124:127], a[28:31], v[236:239]
    v_mfma_f32_16x16x32_bf16 v[232:235], a[116:119], a[28:31], v[232:235]
    s_add_u32 m0, s41, 57216
    v_mfma_f32_16x16x32_bf16 v[232:235], a[112:115], a[24:27], v[232:235]
    buffer_load_dwordx4 v2, s[20:23], s37 offen offset:128 lds
    v_mfma_f32_16x16x32_bf16 v[228:231], a[104:107], a[24:27], v[228:231]
    v_mfma_f32_16x16x32_bf16 v[228:231], a[108:111], a[28:31], v[228:231]
    ds_read_b128 a[8:11], v4 offset:37888
    v_mfma_f32_16x16x32_bf16 v[224:227], a[100:103], a[28:31], v[224:227]
    v_mfma_f32_16x16x32_bf16 v[224:227], a[96:99], a[24:27], v[224:227]
    v_mfma_f32_16x16x32_bf16 v[108:111], a[88:91], a[24:27], v[108:111]
    v_mfma_f32_16x16x32_bf16 v[108:111], a[92:95], a[28:31], v[108:111]
    s_add_u32 m0, s41, 73728
    ds_read_b128 a[12:15], v4 offset:54272
    v_mfma_f32_16x16x32_bf16 v[104:107], a[84:87], a[28:31], v[104:107]
    buffer_load_dwordx4 v3, s[24:27], s38 offen offset:0 lds
    v_mfma_f32_16x16x32_bf16 v[104:107], a[80:83], a[24:27], v[104:107]
    s_add_u32 s37, s37, s39
    v_mfma_f32_16x16x32_bf16 v[100:103], a[72:75], a[24:27], v[100:103]
    s_add_u32 s38, s38, 196608
    v_mfma_f32_16x16x32_bf16 v[100:103], a[76:79], a[28:31], v[100:103]
    v_mfma_f32_16x16x32_bf16 v[96:99], a[68:71], a[28:31], v[96:99]
    v_mfma_f32_16x16x32_bf16 v[96:99], a[64:67], a[24:27], v[96:99]
    s_waitcnt lgkmcnt(2)
    s_add_u32 m0, s41, 12288
    v_mfma_f32_16x16x32_bf16 v[112:115], a[64:67], a[0:3], v[112:115]
    buffer_load_dwordx4 v2, s[16:19], s37 offen offset:0 lds
    v_mfma_f32_16x16x32_bf16 v[112:115], a[68:71], a[4:7], v[112:115]
    v_mfma_f32_16x16x32_bf16 v[116:119], a[76:79], a[4:7], v[116:119]
    v_mfma_f32_16x16x32_bf16 v[116:119], a[72:75], a[0:3], v[116:119]
    v_mfma_f32_16x16x32_bf16 v[120:123], a[80:83], a[0:3], v[120:123]
    v_mfma_f32_16x16x32_bf16 v[120:123], a[84:87], a[4:7], v[120:123]
    s_add_u32 m0, s41, 28544
    v_mfma_f32_16x16x32_bf16 v[124:127], a[92:95], a[4:7], v[124:127]
    buffer_load_dwordx4 v2, s[16:19], s37 offen offset:128 lds
    v_mfma_f32_16x16x32_bf16 v[124:127], a[88:91], a[0:3], v[124:127]
    v_mfma_f32_16x16x32_bf16 v[240:243], a[96:99], a[0:3], v[240:243]
    v_mfma_f32_16x16x32_bf16 v[240:243], a[100:103], a[4:7], v[240:243]
    ds_read_b128 a[16:19], v4 offset:38912
    v_mfma_f32_16x16x32_bf16 v[244:247], a[108:111], a[4:7], v[244:247]
    v_mfma_f32_16x16x32_bf16 v[244:247], a[104:107], a[0:3], v[244:247]
    s_add_u32 m0, s41, 45056
    v_mfma_f32_16x16x32_bf16 v[248:251], a[112:115], a[0:3], v[248:251]
    buffer_load_dwordx4 v2, s[20:23], s37 offen offset:0 lds
    v_mfma_f32_16x16x32_bf16 v[248:251], a[116:119], a[4:7], v[248:251]
    ds_read_b128 a[20:23], v4 offset:55296
    v_mfma_f32_16x16x32_bf16 v[252:255], a[124:127], a[4:7], v[252:255]
    v_mfma_f32_16x16x32_bf16 v[252:255], a[120:123], a[0:3], v[252:255]
    v_mfma_f32_16x16x32_bf16 a[224:227], a[128:131], a[0:3], a[224:227]
    v_mfma_f32_16x16x32_bf16 a[224:227], a[132:135], a[4:7], a[224:227]
    s_add_u32 m0, s41, 61312
    v_mfma_f32_16x16x32_bf16 a[228:231], a[140:143], a[4:7], a[228:231]
    buffer_load_dwordx4 v2, s[20:23], s37 offen offset:128 lds
    v_mfma_f32_16x16x32_bf16 a[228:231], a[136:139], a[0:3], a[228:231]
    s_waitcnt lgkmcnt(2)
    v_mfma_f32_16x16x32_bf16 a[236:239], a[136:139], a[8:11], a[236:239]
    v_mfma_f32_16x16x32_bf16 a[236:239], a[140:143], a[12:15], a[236:239]
    v_mfma_f32_16x16x32_bf16 a[232:235], a[132:135], a[12:15], a[232:235]
    v_mfma_f32_16x16x32_bf16 a[232:235], a[128:131], a[8:11], a[232:235]
    ds_read_b128 a[24:27], v4 offset:39936
    v_mfma_f32_16x16x32_bf16 a[156:159], a[120:123], a[8:11], a[156:159]
    s_add_u32 m0, s41, 77824
    v_mfma_f32_16x16x32_bf16 a[156:159], a[124:127], a[12:15], a[156:159]
    buffer_load_dwordx4 v3, s[24:27], s38 offen offset:0 lds
    v_mfma_f32_16x16x32_bf16 a[152:155], a[116:119], a[12:15], a[152:155]
    s_add_u32 s37, s37, s39
    v_mfma_f32_16x16x32_bf16 a[152:155], a[112:115], a[8:11], a[152:155]
    s_add_u32 s38, s38, 196608
    ds_read_b128 a[28:31], v4 offset:56320
    v_mfma_f32_16x16x32_bf16 a[148:151], a[104:107], a[8:11], a[148:151]
    v_mfma_f32_16x16x32_bf16 a[148:151], a[108:111], a[12:15], a[148:151]
    v_mfma_f32_16x16x32_bf16 a[144:147], a[100:103], a[12:15], a[144:147]
    buffer_load_dword v46, v44, s[64:67], s49 offen
    v_mfma_f32_16x16x32_bf16 a[144:147], a[96:99], a[8:11], a[144:147]
    s_add_u32 s49, s49, s72
    v_mfma_f32_16x16x32_bf16 v[140:143], a[88:91], a[8:11], v[140:143]
    v_mfma_f32_16x16x32_bf16 v[140:143], a[92:95], a[12:15], v[140:143]
    v_mfma_f32_16x16x32_bf16 v[136:139], a[84:87], a[12:15], v[136:139]
    v_mfma_f32_16x16x32_bf16 v[136:139], a[80:83], a[8:11], v[136:139]
    buffer_load_dword v46, v44, s[64:67], s49 offen
    v_mfma_f32_16x16x32_bf16 v[132:135], a[72:75], a[8:11], v[132:135]
    s_add_u32 s49, s49, s72
    v_mfma_f32_16x16x32_bf16 v[132:135], a[76:79], a[12:15], v[132:135]
    v_mfma_f32_16x16x32_bf16 v[128:131], a[68:71], a[12:15], v[128:131]
    v_mfma_f32_16x16x32_bf16 v[128:131], a[64:67], a[8:11], v[128:131]
    s_waitcnt lgkmcnt(2)
    buffer_load_dword v46, v45, s[68:71], s51 offen
    v_mfma_f32_16x16x32_bf16 v[144:147], a[64:67], a[16:19], v[144:147]
    s_add_u32 s51, s51, 0x80000
    v_mfma_f32_16x16x32_bf16 v[144:147], a[68:71], a[20:23], v[144:147]
    s_waitcnt vmcnt(13) lgkmcnt(0)
    v_mfma_f32_16x16x32_bf16 v[148:151], a[76:79], a[20:23], v[148:151]
    s_barrier
    v_mfma_f32_16x16x32_bf16 v[148:151], a[72:75], a[16:19], v[148:151]
    ds_read_b64_tr_b16 a[32:33], v5 offset:0
    v_mfma_f32_16x16x32_bf16 v[152:155], a[80:83], a[16:19], v[152:155]
    ds_read_b64_tr_b16 a[34:35], v5 offset:512
    v_mfma_f32_16x16x32_bf16 v[152:155], a[84:87], a[20:23], v[152:155]
    ds_read_b64_tr_b16 a[36:37], v5 offset:4096
    v_mfma_f32_16x16x32_bf16 v[156:159], a[92:95], a[20:23], v[156:159]
    ds_read_b64_tr_b16 a[38:39], v5 offset:4608
    v_mfma_f32_16x16x32_bf16 v[156:159], a[88:91], a[16:19], v[156:159]
    ds_read_b64_tr_b16 a[40:41], v6 offset:0
    v_mfma_f32_16x16x32_bf16 a[160:163], a[96:99], a[16:19], a[160:163]
    ds_read_b64_tr_b16 a[42:43], v6 offset:512
    v_mfma_f32_16x16x32_bf16 a[160:163], a[100:103], a[20:23], a[160:163]
    ds_read_b64_tr_b16 a[44:45], v6 offset:4096
    v_mfma_f32_16x16x32_bf16 a[164:167], a[108:111], a[20:23], a[164:167]
    ds_read_b64_tr_b16 a[46:47], v6 offset:4608
    v_mfma_f32_16x16x32_bf16 a[164:167], a[104:107], a[16:19], a[164:167]
    ds_read_b64_tr_b16 a[48:49], v7 offset:0
    v_mfma_f32_16x16x32_bf16 a[168:171], a[112:115], a[16:19], a[168:171]
    ds_read_b64_tr_b16 a[50:51], v7 offset:512
    v_mfma_f32_16x16x32_bf16 a[168:171], a[116:119], a[20:23], a[168:171]
    ds_read_b64_tr_b16 a[52:53], v7 offset:4096
    v_mfma_f32_16x16x32_bf16 a[172:175], a[124:127], a[20:23], a[172:175]
    ds_read_b64_tr_b16 a[54:55], v7 offset:4608
    v_mfma_f32_16x16x32_bf16 a[172:175], a[120:123], a[16:19], a[172:175]
    ds_read_b64_tr_b16 a[56:57], v8 offset:0
    v_mfma_f32_16x16x32_bf16 a[240:243], a[128:131], a[16:19], a[240:243]
    ds_read_b64_tr_b16 a[58:59], v8 offset:512
    v_mfma_f32_16x16x32_bf16 a[240:243], a[132:135], a[20:23], a[240:243]
    ds_read_b64_tr_b16 a[60:61], v8 offset:4096
    v_mfma_f32_16x16x32_bf16 a[244:247], a[140:143], a[20:23], a[244:247]
    ds_read_b64_tr_b16 a[62:63], v8 offset:4608
    v_mfma_f32_16x16x32_bf16 a[244:247], a[136:139], a[16:19], a[244:247]
    ds_read_b128 a[0:3], v4 offset:0
    v_mfma_f32_16x16x32_bf16 a[176:179], a[96:99], a[24:27], a[176:179]
    ds_read_b128 a[4:7], v4 offset:16384
    v_mfma_f32_16x16x32_bf16 a[176:179], a[100:103], a[28:31], a[176:179]
    ds_read_b64_tr_b16 a[96:97], v5 offset:32768
    v_mfma_f32_16x16x32_bf16 a[180:183], a[108:111], a[28:31], a[180:183]
    ds_read_b64_tr_b16 a[98:99], v5 offset:33280
    v_mfma_f32_16x16x32_bf16 a[180:183], a[104:107], a[24:27], a[180:183]
    ds_read_b64_tr_b16 a[100:101], v5 offset:36864
    v_mfma_f32_16x16x32_bf16 a[184:187], a[112:115], a[24:27], a[184:187]
    ds_read_b64_tr_b16 a[102:103], v5 offset:37376
    v_mfma_f32_16x16x32_bf16 a[184:187], a[116:119], a[28:31], a[184:187]
    ds_read_b64_tr_b16 a[104:105], v6 offset:32768
    v_mfma_f32_16x16x32_bf16 a[188:191], a[124:127], a[28:31], a[188:191]
    ds_read_b64_tr_b16 a[106:107], v6 offset:33280
    v_mfma_f32_16x16x32_bf16 a[188:191], a[120:123], a[24:27], a[188:191]
    ds_read_b64_tr_b16 a[108:109], v6 offset:36864
    v_mfma_f32_16x16x32_bf16 a[248:251], a[128:131], a[24:27], a[248:251]
    ds_read_b64_tr_b16 a[110:111], v6 offset:37376
L_pw1:
    s_cbranch_execz L_pw4
    v_mfma_f32_16x16x32_bf16 a[248:251], a[132:135], a[28:31], a[248:251]
    ds_read_b64_tr_b16 a[112:113], v7 offset:32768
    v_mfma_f32_16x16x32_bf16 a[252:255], a[140:143], a[28:31], a[252:255]
    ds_read_b64_tr_b16 a[114:115], v7 offset:33280
    v_mfma_f32_16x16x32_bf16 a[252:255], a[136:139], a[24:27], a[252:255]
    ds_read_b64_tr_b16 a[116:117], v7 offset:36864
    v_mfma_f32_16x16x32_bf16 v[160:163], a[64:67], a[24:27], v[160:163]
    ds_read_b64_tr_b16 a[118:119], v7 offset:37376
    v_mfma_f32_16x16x32_bf16 v[160:163], a[68:71], a[28:31], v[160:163]
    ds_read_b64_tr_b16 a[120:121], v8 offset:32768
    v_mfma_f32_16x16x32_bf16 v[164:167], a[76:79], a[28:31], v[164:167]
    ds_read_b64_tr_b16 a[122:123], v8 offset:33280
    v_mfma_f32_16x16x32_bf16 v[164:167], a[72:75], a[24:27], v[164:167]
    ds_read_b64_tr_b16 a[124:125], v8 offset:36864
    v_mfma_f32_16x16x32_bf16 v[168:171], a[80:83], a[24:27], v[168:171]
    ds_read_b64_tr_b16 a[126:127], v8 offset:37376
    v_mfma_f32_16x16x32_bf16 v[168:171], a[84:87], a[28:31], v[168:171]
    ds_read_b64_tr_b16 a[128:129], v9 offset:0
    v_mfma_f32_16x16x32_bf16 v[172:175], a[92:95], a[28:31], v[172:175]
    ds_read_b64_tr_b16 a[130:131], v9 offset:512
    v_mfma_f32_16x16x32_bf16 v[172:175], a[88:91], a[24:27], v[172:175]
    s_waitcnt lgkmcnt(15)
    ds_read_b64_tr_b16 a[132:133], v9 offset:4096
    v_mfma_f32_16x16x32_bf16 v[48:51], a[32:35], a[0:3], v[48:51]
    ds_read_b64_tr_b16 a[134:135], v9 offset:4608
    v_mfma_f32_16x16x32_bf16 v[48:51], a[36:39], a[4:7], v[48:51]
    ds_read_b64_tr_b16 a[136:137], v10 offset:0
    v_mfma_f32_16x16x32_bf16 v[52:55], a[44:47], a[4:7], v[52:55]
    ds_read_b64_tr_b16 a[138:139], v10 offset:512
    v_mfma_f32_16x16x32_bf16 v[52:55], a[40:43], a[0:3], v[52:55]
    ds_read_b64_tr_b16 a[140:141], v10 offset:4096
    v_mfma_f32_16x16x32_bf16 v[56:59], a[48:51], a[0:3], v[56:59]
    ds_read_b64_tr_b16 a[142:143], v10 offset:4608
    v_mfma_f32_16x16x32_bf16 v[56:59], a[52:55], a[4:7], v[56:59]
    ds_read_b128 a[8:11], v4 offset:1024
    v_mfma_f32_16x16x32_bf16 v[60:63], a[60:63], a[4:7], v[60:63]
    s_add_u32 m0, s40, 32768
    ds_read_b128 a[12:15], v4 offset:17408
    v_mfma_f32_16x16x32_bf16 v[60:63], a[56:59], a[0:3], v[60:63]
    s_waitcnt lgkmcnt(15)
    buffer_load_dwordx4 v1, s[12:15], s36 offen offset:0 sc1 lds
    v_mfma_f32_16x16x32_bf16 v[176:179], a[96:99], a[0:3], v[176:179]
    v_mfma_f32_16x16x32_bf16 v[176:179], a[100:103], a[4:7], v[176:179]
    ds_read_b128 a[16:19], v4 offset:2048
    v_mfma_f32_16x16x32_bf16 v[180:183], a[108:111], a[4:7], v[180:183]
    v_mfma_f32_16x16x32_bf16 v[180:183], a[104:107], a[0:3], v[180:183]
    s_waitcnt lgkmcnt(15)
    v_mfma_f32_16x16x32_bf16 v[184:187], a[112:115], a[0:3], v[184:187]
    buffer_load_dwordx4 v17, s[12:15], s36 offen offset:1024 sc1 lds
    v_mfma_f32_16x16x32_bf16 v[184:187], a[116:119], a[4:7], v[184:187]
    s_waitcnt lgkmcnt(11)
    ds_read_b128 a[20:23], v4 offset:18432
    v_mfma_f32_16x16x32_bf16 v[188:191], a[124:127], a[4:7], v[188:191]
    v_mfma_f32_16x16x32_bf16 v[188:191], a[120:123], a[0:3], v[188:191]
    s_waitcnt lgkmcnt(8)
    v_mfma_f32_16x16x32_bf16 a[192:195], a[128:131], a[0:3], a[192:195]
    v_mfma_f32_16x16x32_bf16 a[192:195], a[132:135], a[4:7], a[192:195]
    s_waitcnt lgkmcnt(4)
    buffer_load_dwordx4 v18, s[12:15], s36 offen offset:2048 sc1 lds
    v_mfma_f32_16x16x32_bf16 a[196:199], a[140:143], a[4:7], a[196:199]
    v_mfma_f32_16x16x32_bf16 a[196:199], a[136:139], a[0:3], a[196:199]
    s_waitcnt lgkmcnt(2)
    v_mfma_f32_16x16x32_bf16 a[204:207], a[136:139], a[8:11], a[204:207]
    v_mfma_f32_16x16x32_bf16 a[204:207], a[140:143], a[12:15], a[204:207]
    s_barrier
    v_mfma_f32_16x16x32_bf16 a[200:203], a[132:135], a[12:15], a[200:203]
    buffer_load_dwordx4 v19, s[12:15], s36 offen offset:3072 sc1 lds
    v_mfma_f32_16x16x32_bf16 a[200:203], a[128:131], a[8:11], a[200:203]
    s_add_u32 s36, s36, 0x80
    v_mfma_f32_16x16x32_bf16 v[204:207], a[120:123], a[8:11], v[204:207]
    v_mfma_f32_16x16x32_bf16 v[204:207], a[124:127], a[12:15], v[204:207]
    v_mfma_f32_16x16x32_bf16 v[200:203], a[116:119], a[12:15], v[200:203]
    s_add_u32 m0, s40, 49152
    v_mfma_f32_16x16x32_bf16 v[200:203], a[112:115], a[8:11], v[200:203]
    buffer_load_dwordx4 v1, s[12:15], s36 offen offset:0 sc1 lds
    v_mfma_f32_16x16x32_bf16 v[196:199], a[104:107], a[8:11], v[196:199]
    v_mfma_f32_16x16x32_bf16 v[196:199], a[108:111], a[12:15], v[196:199]
    ds_read_b128 a[24:27], v4 offset:3072
    v_mfma_f32_16x16x32_bf16 v[192:195], a[100:103], a[12:15], v[192:195]
    v_mfma_f32_16x16x32_bf16 v[192:195], a[96:99], a[8:11], v[192:195]
    v_mfma_f32_16x16x32_bf16 v[76:79], a[56:59], a[8:11], v[76:79]
    buffer_load_dwordx4 v17, s[12:15], s36 offen offset:1024 sc1 lds
    v_mfma_f32_16x16x32_bf16 v[76:79], a[60:63], a[12:15], v[76:79]
    ds_read_b128 a[28:31], v4 offset:19456
    v_mfma_f32_16x16x32_bf16 v[72:75], a[52:55], a[12:15], v[72:75]
    v_mfma_f32_16x16x32_bf16 v[72:75], a[48:51], a[8:11], v[72:75]
    v_mfma_f32_16x16x32_bf16 v[68:71], a[40:43], a[8:11], v[68:71]
    v_mfma_f32_16x16x32_bf16 v[68:71], a[44:47], a[12:15], v[68:71]
    buffer_load_dwordx4 v18, s[12:15], s36 offen offset:2048 sc1 lds
    v_mfma_f32_16x16x32_bf16 v[64:67], a[36:39], a[12:15], v[64:67]
    v_mfma_f32_16x16x32_bf16 v[64:67], a[32:35], a[8:11], v[64:67]
    s_waitcnt lgkmcnt(2)
    v_mfma_f32_16x16x32_bf16 v[80:83], a[32:35], a[16:19], v[80:83]
    v_mfma_f32_16x16x32_bf16 v[80:83], a[36:39], a[20:23], v[80:83]
    v_mfma_f32_16x16x32_bf16 v[84:87], a[44:47], a[20:23], v[84:87]
    buffer_load_dwordx4 v19, s[12:15], s36 offen offset:3072 sc1 lds
    v_mfma_f32_16x16x32_bf16 v[84:87], a[40:43], a[16:19], v[84:87]
    s_add_u32 s36, s36, 0x80
    v_mfma_f32_16x16x32_bf16 v[88:91], a[48:51], a[16:19], v[88:91]
    v_mfma_f32_16x16x32_bf16 v[88:91], a[52:55], a[20:23], v[88:91]
    v_mfma_f32_16x16x32_bf16 v[92:95], a[60:63], a[20:23], v[92:95]
    v_mfma_f32_16x16x32_bf16 v[92:95], a[56:59], a[16:19], v[92:95]
    s_add_u32 m0, s41, 0
    v_mfma_f32_16x16x32_bf16 v[208:211], a[96:99], a[16:19], v[208:211]
    buffer_load_dwordx4 v2, s[16:19], s37 offen offset:0 lds
    v_mfma_f32_16x16x32_bf16 v[208:211], a[100:103], a[20:23], v[208:211]
    ds_read_b128 a[0:3], v4 offset:4096
    v_mfma_f32_16x16x32_bf16 v[212:215], a[108:111], a[20:23], v[212:215]
    v_mfma_f32_16x16x32_bf16 v[212:215], a[104:107], a[16:19], v[212:215]
    v_mfma_f32_16x16x32_bf16 v[216:219], a[112:115], a[16:19], v[216:219]
    v_mfma_f32_16x16x32_bf16 v[216:219], a[116:119], a[20:23], v[216:219]
    ds_read_b128 a[4:7], v4 offset:20480
    v_mfma_f32_16x16x32_bf16 v[220:223], a[124:127], a[20:23], v[220:223]
    s_add_u32 m0, s41, 16256
    v_mfma_f32_16x16x32_bf16 v[220:223], a[120:123], a[16:19], v[220:223]
    buffer_load_dwordx4 v2, s[16:19], s37 offen offset:128 lds
    v_mfma_f32_16x16x32_bf16 a[208:211], a[128:131], a[16:19], a[208:211]
    v_mfma_f32_16x16x32_bf16 a[208:211], a[132:135], a[20:23], a[208:211]
    v_mfma_f32_16x16x32_bf16 a[212:215], a[140:143], a[20:23], a[212:215]
    v_mfma_f32_16x16x32_bf16 a[212:215], a[136:139], a[16:19], a[212:215]
    s_waitcnt lgkmcnt(2)
    v_mfma_f32_16x16x32_bf16 a[220:223], a[136:139], a[24:27], a[220:223]
    s_add_u32 m0, s41, 32768
    v_mfma_f32_16x16x32_bf16 a[220:223], a[140:143], a[28:31], a[220:223]
    buffer_load_dwordx4 v2, s[20:23], s37 offen offset:0 lds
    v_mfma_f32_16x16x32_bf16 a[216:219], a[132:135], a[28:31], a[216:219]
    v_mfma_f32_16x16x32_bf16 a[216:219], a[128:131], a[24:27], a[216:219]
    v_mfma_f32_16x16x32_bf16 v[236:239], a[120:123], a[24:27], v[236:239]
    v_mfma_f32_16x16x32_bf16 v[236:239], a[124:127], a[28:31], v[236:239]
    v_mfma_f32_16x16x32_bf16 v[232:235], a[116:119], a[28:31], v[232:235]
    s_add_u32 m0, s41, 49024
    v_mfma_f32_16x16x32_bf16 v[232:235], a[112:115], a[24:27], v[232:235]
    buffer_load_dwordx4 v2, s[20:23], s37 offen offset:128 lds
    v_mfma_f32_16x16x32_bf16 v[228:231], a[104:107], a[24:27], v[228:231]
    v_mfma_f32_16x16x32_bf16 v[228:231], a[108:111], a[28:31], v[228:231]
    ds_read_b128 a[8:11], v4 offset:5120
    v_mfma_f32_16x16x32_bf16 v[224:227], a[100:103], a[28:31], v[224:227]
    v_mfma_f32_16x16x32_bf16 v[224:227], a[96:99], a[24:27], v[224:227]
    v_mfma_f32_16x16x32_bf16 v[108:111], a[56:59], a[24:27], v[108:111]
    v_mfma_f32_16x16x32_bf16 v[108:111], a[60:63], a[28:31], v[108:111]
    s_add_u32 m0, s41, 65536
    ds_read_b128 a[12:15], v4 offset:21504
    v_mfma_f32_16x16x32_bf16 v[104:107], a[52:55], a[28:31], v[104:107]
    buffer_load_dwordx4 v3, s[24:27], s38 offen offset:0 lds
    v_mfma_f32_16x16x32_bf16 v[104:107], a[48:51], a[24:27], v[104:107]
    s_add_u32 s37, s37, s39
    v_mfma_f32_16x16x32_bf16 v[100:103], a[40:43], a[24:27], v[100:103]
    s_add_u32 s38, s38, 196608
    v_mfma_f32_16x16x32_bf16 v[100:103], a[44:47], a[28:31], v[100:103]
    v_mfma_f32_16x16x32_bf16 v[96:99], a[36:39], a[28:31], v[96:99]
    v_mfma_f32_16x16x32_bf16 v[96:99], a[32:35], a[24:27], v[96:99]
    s_waitcnt lgkmcnt(2)
    s_add_u32 m0, s41, 4096
    v_mfma_f32_16x16x32_bf16 v[112:115], a[32:35], a[0:3], v[112:115]
    buffer_load_dwordx4 v2, s[16:19], s37 offen offset:0 lds
    v_mfma_f32_16x16x32_bf16 v[112:115], a[36:39], a[4:7], v[112:115]
    v_mfma_f32_16x16x32_bf16 v[116:119], a[44:47], a[4:7], v[116:119]
    v_mfma_f32_16x16x32_bf16 v[116:119], a[40:43], a[0:3], v[116:119]
    v_mfma_f32_16x16x32_bf16 v[120:123], a[48:51], a[0:3], v[120:123]
    v_mfma_f32_16x16x32_bf16 v[120:123], a[52:55], a[4:7], v[120:123]
    s_add_u32 m0, s41, 20352
    v_mfma_f32_16x16x32_bf16 v[124:127], a[60:63], a[4:7], v[124:127]
    buffer_load_dwordx4 v2, s[16:19], s37 offen offset:128 lds
    v_mfma_f32_16x16x32_bf16 v[124:127], a[56:59], a[0:3], v[124:127]
    v_mfma_f32_16x16x32_bf16 v[240:243], a[96:99], a[0:3], v[240:243]
    v_mfma_f32_16x16x32_bf16 v[240:243], a[100:103], a[4:7], v[240:243]
    ds_read_b128 a[16:19], v4 offset:6144
    v_mfma_f32_16x16x32_bf16 v[244:247], a[108:111], a[4:7], v[244:247]
    v_mfma_f32_16x16x32_bf16 v[244:247], a[104:107], a[0:3], v[244:247]
    s_add_u32 m0, s41, 36864
    v_mfma_f32_16x16x32_bf16 v[248:251], a[112:115], a[0:3], v[248:251]
    buffer_load_dwordx4 v2, s[20:23], s37 offen offset:0 lds
    v_mfma_f32_16x16x32_bf16 v[248:251], a[116:119], a[4:7], v[248:251]
    ds_read_b128 a[20:23], v4 offset:22528
    v_mfma_f32_16x16x32_bf16 v[252:255], a[124:127], a[4:7], v[252:255]
    v_mfma_f32_16x16x32_bf16 v[252:255], a[120:123], a[0:3], v[252:255]
    v_mfma_f32_16x16x32_bf16 a[224:227], a[128:131], a[0:3], a[224:227]
    v_mfma_f32_16x16x32_bf16 a[224:227], a[132:135], a[4:7], a[224:227]
    s_add_u32 m0, s41, 53120
    v_mfma_f32_16x16x32_bf16 a[228:231], a[140:143], a[4:7], a[228:231]
    buffer_load_dwordx4 v2, s[20:23], s37 offen offset:128 lds
    v_mfma_f32_16x16x32_bf16 a[228:231], a[136:139], a[0:3], a[228:231]
    s_waitcnt lgkmcnt(2)
    v_mfma_f32_16x16x32_bf16 a[236:239], a[136:139], a[8:11], a[236:239]
    v_mfma_f32_16x16x32_bf16 a[236:239], a[140:143], a[12:15], a[236:239]
    v_mfma_f32_16x16x32_bf16 a[232:235], a[132:135], a[12:15], a[232:235]
    v_mfma_f32_16x16x32_bf16 a[232:235], a[128:131], a[8:11], a[232:235]
    ds_read_b128 a[24:27], v4 offset:7168
    v_mfma_f32_16x16x32_bf16 a[156:159], a[120:123], a[8:11], a[156:159]
    s_add_u32 m0, s41, 69632
    v_mfma_f32_16x16x32_bf16 a[156:159], a[124:127], a[12:15], a[156:159]
    buffer_load_dwordx4 v3, s[24:27], s38 offen offset:0 lds
    v_mfma_f32_16x16x32_bf16 a[152:155], a[116:119], a[12:15], a[152:155]
    s_add_u32 s37, s37, s39
    v_mfma_f32_16x16x32_bf16 a[152:155], a[112:115], a[8:11], a[152:155]
    s_add_u32 s38, s38, 196608
    ds_read_b128 a[28:31], v4 offset:23552
    v_mfma_f32_16x16x32_bf16 a[148:151], a[104:107], a[8:11], a[148:151]
    v_mfma_f32_16x16x32_bf16 a[148:151], a[108:111], a[12:15], a[148:151]
    v_mfma_f32_16x16x32_bf16 a[144:147], a[100:103], a[12:15], a[144:147]
    buffer_load_dword v46, v44, s[64:67], s49 offen
    v_mfma_f32_16x16x32_bf16 a[144:147], a[96:99], a[8:11], a[144:147]
    s_add_u32 s49, s49, s72
    v_mfma_f32_16x16x32_bf16 v[140:143], a[56:59], a[8:11], v[140:143]
    v_mfma_f32_16x16x32_bf16 v[140:143], a[60:63], a[12:15], v[140:143]
    v_mfma_f32_16x16x32_bf16 v[136:139], a[52:55], a[12:15], v[136:139]
    v_mfma_f32_16x16x32_bf16 v[136:139], a[48:51], a[8:11], v[136:139]
    buffer_load_dword v46, v44, s[64:67], s49 offen
    v_mfma_f32_16x16x32_bf16 v[132:135], a[40:43], a[8:11], v[132:135]
    s_add_u32 s49, s49, s72
    v_mfma_f32_16x16x32_bf16 v[132:135], a[44:47], a[12:15], v[132:135]
    v_mfma_f32_16x16x32_bf16 v[128:131], a[36:39], a[12:15], v[128:131]
    v_mfma_f32_16x16x32_bf16 v[128:131], a[32:35], a[8:11], v[128:131]
    s_waitcnt lgkmcnt(2)
    v_mfma_f32_16x16x32_bf16 v[144:147], a[32:35], a[16:19], v[144:147]
    v_mfma_f32_16x16x32_bf16 v[144:147], a[36:39], a[20:23], v[144:147]
    s_waitcnt vmcnt(12) lgkmcnt(0)
    v_mfma_f32_16x16x32_bf16 v[148:151], a[44:47], a[20:23], v[148:151]
    s_barrier
    v_mfma_f32_16x16x32_bf16 v[148:151], a[40:43], a[16:19], v[148:151]
    ds_read_b64_tr_b16 a[64:65], v5 offset:8192
    v_mfma_f32_16x16x32_bf16 v[152:155], a[48:51], a[16:19], v[152:155]
    ds_read_b64_tr_b16 a[66:67], v5 offset:8704
    v_mfma_f32_16x16x32_bf16 v[152:155], a[52:55], a[20:23], v[152:155]
    ds_read_b64_tr_b16 a[68:69], v5 offset:12288
    v_mfma_f32_16x16x32_bf16 v[156:159], a[60:63], a[20:23], v[156:159]
    ds_read_b64_tr_b16 a[70:71], v5 offset:12800
    v_mfma_f32_16x16x32_bf16 v[156:159], a[56:59], a[16:19], v[156:159]
    ds_read_b64_tr_b16 a[72:73], v6 offset:8192
    v_mfma_f32_16x16x32_bf16 a[160:163], a[96:99], a[16:19], a[160:163]
    ds_read_b64_tr_b16 a[74:75], v6 offset:8704
    v_mfma_f32_16x16x32_bf16 a[160:163], a[100:103], a[20:23], a[160:163]
    ds_read_b64_tr_b16 a[76:77], v6 offset:12288
    v_mfma_f32_16x16x32_bf16 a[164:167], a[108:111], a[20:23], a[164:167]
    ds_read_b64_tr_b16 a[78:79], v6 offset:12800
    v_mfma_f32_16x16x32_bf16 a[164:167], a[104:107], a[16:19], a[164:167]
    ds_read_b64_tr_b16 a[80:81], v7 offset:8192
    v_mfma_f32_16x16x32_bf16 a[168:171], a[112:115], a[16:19], a[168:171]
    ds_read_b64_tr_b16 a[82:83], v7 offset:8704
    v_mfma_f32_16x16x32_bf16 a[168:171], a[116:119], a[20:23], a[168:171]
    ds_read_b64_tr_b16 a[84:85], v7 offset:12288
    v_mfma_f32_16x16x32_bf16 a[172:175], a[124:127], a[20:23], a[172:175]
    ds_read_b64_tr_b16 a[86:87], v7 offset:12800
    v_mfma_f32_16x16x32_bf16 a[172:175], a[120:123], a[16:19], a[172:175]
    ds_read_b64_tr_b16 a[88:89], v8 offset:8192
    v_mfma_f32_16x16x32_bf16 a[240:243], a[128:131], a[16:19], a[240:243]
    ds_read_b64_tr_b16 a[90:91], v8 offset:8704
    v_mfma_f32_16x16x32_bf16 a[240:243], a[132:135], a[20:23], a[240:243]
    ds_read_b64_tr_b16 a[92:93], v8 offset:12288
    v_mfma_f32_16x16x32_bf16 a[244:247], a[140:143], a[20:23], a[244:247]
    ds_read_b64_tr_b16 a[94:95], v8 offset:12800
    v_mfma_f32_16x16x32_bf16 a[244:247], a[136:139], a[16:19], a[244:247]
    ds_read_b128 a[0:3], v4 offset:32768
    v_mfma_f32_16x16x32_bf16 a[176:179], a[96:99], a[24:27], a[176:179]
    ds_read_b128 a[4:7], v4 offset:49152
    v_mfma_f32_16x16x32_bf16 a[176:179], a[100:103], a[28:31], a[176:179]
    ds_read_b64_tr_b16 a[96:97], v5 offset:40960
    v_mfma_f32_16x16x32_bf16 a[180:183], a[108:111], a[28:31], a[180:183]
    ds_read_b64_tr_b16 a[98:99], v5 offset:41472
    v_mfma_f32_16x16x32_bf16 a[180:183], a[104:107], a[24:27], a[180:183]
    ds_read_b64_tr_b16 a[100:101], v5 offset:45056
    v_mfma_f32_16x16x32_bf16 a[184:187], a[112:115], a[24:27], a[184:187]
    ds_read_b64_tr_b16 a[102:103], v5 offset:45568
    v_mfma_f32_16x16x32_bf16 a[184:187], a[116:119], a[28:31], a[184:187]
    ds_read_b64_tr_b16 a[104:105], v6 offset:40960
    v_mfma_f32_16x16x32_bf16 a[188:191], a[124:127], a[28:31], a[188:191]
    ds_read_b64_tr_b16 a[106:107], v6 offset:41472
    v_mfma_f32_16x16x32_bf16 a[188:191], a[120:123], a[24:27], a[188:191]
    ds_read_b64_tr_b16 a[108:109], v6 offset:45056
    v_mfma_f32_16x16x32_bf16 a[248:251], a[128:131], a[24:27], a[248:251]
    ds_read_b64_tr_b16 a[110:111], v6 offset:45568
    v_mfma_f32_16x16x32_bf16 a[248:251], a[132:135], a[28:31], a[248:251]
    ds_read_b64_tr_b16 a[112:113], v7 offset:40960
    v_mfma_f32_16x16x32_bf16 a[252:255], a[140:143], a[28:31], a[252:255]
    ds_read_b64_tr_b16 a[114:115], v7 offset:41472
    v_mfma_f32_16x16x32_bf16 a[252:255], a[136:139], a[24:27], a[252:255]
    ds_read_b64_tr_b16 a[116:117], v7 offset:45056
    v_mfma_f32_16x16x32_bf16 v[160:163], a[32:35], a[24:27], v[160:163]
    ds_read_b64_tr_b16 a[118:119], v7 offset:45568
    v_mfma_f32_16x16x32_bf16 v[160:163], a[36:39], a[28:31], v[160:163]
    ds_read_b64_tr_b16 a[120:121], v8 offset:40960
    v_mfma_f32_16x16x32_bf16 v[164:167], a[44:47], a[28:31], v[164:167]
    ds_read_b64_tr_b16 a[122:123], v8 offset:41472
    v_mfma_f32_16x16x32_bf16 v[164:167], a[40:43], a[24:27], v[164:167]
    ds_read_b64_tr_b16 a[124:125], v8 offset:45056
    v_mfma_f32_16x16x32_bf16 v[168:171], a[48:51], a[24:27], v[168:171]
    s_sub_u32 s42, s42, 1
    ds_read_b64_tr_b16 a[126:127], v8 offset:45568
    v_mfma_f32_16x16x32_bf16 v[168:171], a[52:55], a[28:31], v[168:171]
    ds_read_b64_tr_b16 a[128:129], v9 offset:8192
    v_mfma_f32_16x16x32_bf16 v[172:175], a[60:63], a[28:31], v[172:175]
    ds_read_b64_tr_b16 a[130:131], v9 offset:8704
    v_mfma_f32_16x16x32_bf16 v[172:175], a[56:59], a[24:27], v[172:175]
    s_waitcnt lgkmcnt(15)
    s_cmp_lg_u32 s42, 0
    ds_read_b64_tr_b16 a[132:133], v9 offset:12288
    s_cbranch_scc1 L_k1_loop_f
    v_mfma_f32_16x16x32_bf16 v[48:51], a[64:67], a[0:3], v[48:51]
    s_add_u32 m0, s40, 0
    ds_read_b64_tr_b16 a[134:135], v9 offset:12800
    v_mfma_f32_16x16x32_bf16 v[48:51], a[68:71], a[4:7], v[48:51]
    buffer_load_dwordx4 v1, s[12:15], s36 offen offset:0 sc1 lds
    ds_read_b64_tr_b16 a[136:137], v10 offset:8192
    v_mfma_f32_16x16x32_bf16 v[52:55], a[76:79], a[4:7], v[52:55]
    ds_read_b64_tr_b16 a[138:139], v10 offset:8704
    v_mfma_f32_16x16x32_bf16 v[52:55], a[72:75], a[0:3], v[52:55]
    ds_read_b64_tr_b16 a[140:141], v10 offset:12288
    v_mfma_f32_16x16x32_bf16 v[56:59], a[80:83], a[0:3], v[56:59]
    ds_read_b64_tr_b16 a[142:143], v10 offset:12800
    v_mfma_f32_16x16x32_bf16 v[56:59], a[84:87], a[4:7], v[56:59]
    buffer_load_dwordx4 v17, s[12:15], s36 offen offset:1024 sc1 lds
    ds_read_b128 a[8:11], v4 offset:33792
    v_mfma_f32_16x16x32_bf16 v[60:63], a[92:95], a[4:7], v[60:63]
    ds_read_b128 a[12:15], v4 offset:50176
    v_mfma_f32_16x16x32_bf16 v[60:63], a[88:91], a[0:3], v[60:63]
    s_waitcnt lgkmcnt(15)
    v_mfma_f32_16x16x32_bf16 v[176:179], a[96:99], a[0:3], v[176:179]
    ds_read_b128 a[16:19], v4 offset:34816
    v_mfma_f32_16x16x32_bf16 v[176:179], a[100:103], a[4:7], v[176:179]
    buffer_load_dwordx4 v18, s[12:15], s36 offen offset:2048 sc1 lds
    v_mfma_f32_16x16x32_bf16 v[180:183], a[108:111], a[4:7], v[180:183]
    ds_read_b128 a[20:23], v4 offset:51200
    v_mfma_f32_16x16x32_bf16 v[180:183], a[104:107], a[0:3], v[180:183]
    s_waitcnt lgkmcnt(15)
    v_mfma_f32_16x16x32_bf16 v[184:187], a[112:115], a[0:3], v[184:187]
    ds_read_b128 a[24:27], v4 offset:35840
    v_mfma_f32_16x16x32_bf16 v[184:187], a[116:119], a[4:7], v[184:187]
    s_waitcnt lgkmcnt(13)
    buffer_load_dwordx4 v19, s[12:15], s36 offen offset:3072 sc1 lds
    v_mfma_f32_16x16x32_bf16 v[188:191], a[124:127], a[4:7], v[188:191]
    s_add_u32 s36, s36, 0x80
    ds_read_b128 a[28:31], v4 offset:52224
    v_mfma_f32_16x16x32_bf16 v[188:191], a[120:123], a[0:3], v[188:191]
    s_waitcnt lgkmcnt(10)
    v_mfma_f32_16x16x32_bf16 a[192:195], a[128:131], a[0:3], a[192:195]
    s_add_u32 m0, s40, 16384
    ds_read_b128 a[32:35], v4 offset:36864
    v_mfma_f32_16x16x32_bf16 a[192:195], a[132:135], a[4:7], a[192:195]
    s_waitcnt lgkmcnt(7)
    buffer_load_dwordx4 v1, s[12:15], s36 offen offset:0 sc1 lds
    v_mfma_f32_16x16x32_bf16 a[196:199], a[140:143], a[4:7], a[196:199]
    ds_read_b128 a[36:39], v4 offset:53248
    v_mfma_f32_16x16x32_bf16 a[196:199], a[136:139], a[0:3], a[196:199]
    s_waitcnt lgkmcnt(6)
    v_mfma_f32_16x16x32_bf16 a[204:207], a[136:139], a[8:11], a[204:207]
    ds_read_b128 a[40:43], v4 offset:37888
    v_mfma_f32_16x16x32_bf16 a[204:207], a[140:143], a[12:15], a[204:207]
    s_barrier
    buffer_load_dwordx4 v17, s[12:15], s36 offen offset:1024 sc1 lds
    v_mfma_f32_16x16x32_bf16 a[200:203], a[132:135], a[12:15], a[200:203]
    ds_read_b128 a[44:47], v4 offset:54272
    v_mfma_f32_16x16x32_bf16 a[200:203], a[128:131], a[8:11], a[200:203]
    v_mfma_f32_16x16x32_bf16 v[204:207], a[120:123], a[8:11], v[204:207]
    ds_read_b128 a[48:51], v4 offset:38912
    v_mfma_f32_16x16x32_bf16 v[204:207], a[124:127], a[12:15], v[204:207]
    buffer_load_dwordx4 v18, s[12:15], s36 offen offset:2048 sc1 lds
    v_mfma_f32_16x16x32_bf16 v[200:203], a[116:119], a[12:15], v[200:203]
    ds_read_b128 a[52:55], v4 offset:55296
    v_mfma_f32_16x16x32_bf16 v[200:203], a[112:115], a[8:11], v[200:203]
    v_mfma_f32_16x16x32_bf16 v[196:199], a[104:107], a[8:11], v[196:199]
    ds_read_b128 a[56:59], v4 offset:39936
    v_mfma_f32_16x16x32_bf16 v[196:199], a[108:111], a[12:15], v[196:199]
    buffer_load_dwordx4 v19, s[12:15], s36 offen offset:3072 sc1 lds
    v_mfma_f32_16x16x32_bf16 v[192:195], a[100:103], a[12:15], v[192:195]
    s_add_u32 s36, s36, 0x80
    ds_read_b128 a[60:63], v4 offset:56320
    v_mfma_f32_16x16x32_bf16 v[192:195], a[96:99], a[8:11], v[192:195]
    v_mfma_f32_16x16x32_bf16 v[76:79], a[88:91], a[8:11], v[76:79]
    v_mfma_f32_16x16x32_bf16 v[76:79], a[92:95], a[12:15], v[76:79]
    s_add_u32 m0, s41, 8192
    v_mfma_f32_16x16x32_bf16 v[72:75], a[84:87], a[12:15], v[72:75]
    buffer_load_dwordx4 v2, s[16:19], s37 offen offset:0 lds
    v_mfma_f32_16x16x32_bf16 v[72:75], a[80:83], a[8:11], v[72:75]
    v_mfma_f32_16x16x32_bf16 v[68:71], a[72:75], a[8:11], v[68:71]
    v_mfma_f32_16x16x32_bf16 v[68:71], a[76:79], a[12:15], v[68:71]
    s_add_u32 m0, s41, 24448
    v_mfma_f32_16x16x32_bf16 v[64:67], a[68:71], a[12:15], v[64:67]
    buffer_load_dwordx4 v2, s[16:19], s37 offen offset:128 lds
    v_mfma_f32_16x16x32_bf16 v[64:67], a[64:67], a[8:11], v[64:67]
    s_waitcnt lgkmcnt(10)
    v_mfma_f32_16x16x32_bf16 v[80:83], a[64:67], a[16:19], v[80:83]
    s_waitcnt lgkmcnt(0)
    v_mfma_f32_16x16x32_bf16 v[80:83], a[68:71], a[20:23], v[80:83]
    s_barrier
    s_add_u32 m0, s41, 40960
    v_mfma_f32_16x16x32_bf16 v[84:87], a[76:79], a[20:23], v[84:87]
    buffer_load_dwordx4 v2, s[20:23], s37 offen offset:0 lds
    v_mfma_f32_16x16x32_bf16 v[84:87], a[72:75], a[16:19], v[84:87]
    v_mfma_f32_16x16x32_bf16 v[88:91], a[80:83], a[16:19], v[88:91]
    v_mfma_f32_16x16x32_bf16 v[88:91], a[84:87], a[20:23], v[88:91]
    s_add_u32 m0, s41, 57216
    v_mfma_f32_16x16x32_bf16 v[92:95], a[92:95], a[20:23], v[92:95]
    buffer_load_dwordx4 v2, s[20:23], s37 offen offset:128 lds
    v_mfma_f32_16x16x32_bf16 v[92:95], a[88:91], a[16:19], v[92:95]
    v_mfma_f32_16x16x32_bf16 v[208:211], a[96:99], a[16:19], v[208:211]
    v_mfma_f32_16x16x32_bf16 v[208:211], a[100:103], a[20:23], v[208:211]
    s_add_u32 m0, s41, 73728
    v_mfma_f32_16x16x32_bf16 v[212:215], a[108:111], a[20:23], v[212:215]
    buffer_load_dwordx4 v3, s[24:27], s38 offen offset:0 lds
    v_mfma_f32_16x16x32_bf16 v[212:215], a[104:107], a[16:19], v[212:215]
    s_add_u32 s37, s37, s39
    v_mfma_f32_16x16x32_bf16 v[216:219], a[112:115], a[16:19], v[216:219]
    s_add_u32 s38, s38, 196608
    v_mfma_f32_16x16x32_bf16 v[216:219], a[116:119], a[20:23], v[216:219]
    s_add_u32 m0, s41, 12288
    v_mfma_f32_16x16x32_bf16 v[220:223], a[124:127], a[20:23], v[220:223]
    buffer_load_dwordx4 v2, s[16:19], s37 offen offset:0 lds
    v_mfma_f32_16x16x32_bf16 v[220:223], a[120:123], a[16:19], v[220:223]
    v_mfma_f32_16x16x32_bf16 a[208:211], a[128:131], a[16:19], a[208:211]
    v_mfma_f32_16x16x32_bf16 a[208:211], a[132:135], a[20:23], a[208:211]
    s_add_u32 m0, s41, 28544
    v_mfma_f32_16x16x32_bf16 a[212:215], a[140:143], a[20:23], a[212:215]
    buffer_load_dwordx4 v2, s[16:19], s37 offen offset:128 lds
    v_mfma_f32_16x16x32_bf16 a[212:215], a[136:139], a[16:19], a[212:215]
    v_mfma_f32_16x16x32_bf16 a[220:223], a[136:139], a[24:27], a[220:223]
    v_mfma_f32_16x16x32_bf16 a[220:223], a[140:143], a[28:31], a[220:223]
    s_add_u32 m0, s41, 45056
    v_mfma_f32_16x16x32_bf16 a[216:219], a[132:135], a[28:31], a[216:219]
    buffer_load_dwordx4 v2, s[20:23], s37 offen offset:0 lds
    v_mfma_f32_16x16x32_bf16 a[216:219], a[128:131], a[24:27], a[216:219]
    v_mfma_f32_16x16x32_bf16 v[236:239], a[120:123], a[24:27], v[236:239]
    v_mfma_f32_16x16x32_bf16 v[236:239], a[124:127], a[28:31], v[236:239]
    s_add_u32 m0, s41, 61312
    v_mfma_f32_16x16x32_bf16 v[232:235], a[116:119], a[28:31], v[232:235]
    buffer_load_dwordx4 v2, s[20:23], s37 offen offset:128 lds
    v_mfma_f32_16x16x32_bf16 v[232:235], a[112:115], a[24:27], v[232:235]
    v_mfma_f32_16x16x32_bf16 v[228:231], a[104:107], a[24:27], v[228:231]
    v_mfma_f32_16x16x32_bf16 v[228:231], a[108:111], a[28:31], v[228:231]
    s_add_u32 m0, s41, 77824
    v_mfma_f32_16x16x32_bf16 v[224:227], a[100:103], a[28:31], v[224:227]
    buffer_load_dwordx4 v3, s[24:27], s38 offen offset:0 lds
    v_mfma_f32_16x16x32_bf16 v[224:227], a[96:99], a[24:27], v[224:227]
    s_add_u32 s37, s37, s39
    v_mfma_f32_16x16x32_bf16 v[108:111], a[88:91], a[24:27], v[108:111]
    s_add_u32 s38, s38, 196608
    v_mfma_f32_16x16x32_bf16 v[108:111], a[92:95], a[28:31], v[108:111]
    v_mfma_f32_16x16x32_bf16 v[104:107], a[84:87], a[28:31], v[104:107]
    s_add_u32 m0, s40, 32768
    v_mfma_f32_16x16x32_bf16 v[104:107], a[80:83], a[24:27], v[104:107]
    buffer_load_dwordx4 v1, s[12:15], s36 offen offset:0 sc1 lds
    v_mfma_f32_16x16x32_bf16 v[100:103], a[72:75], a[24:27], v[100:103]
    v_mfma_f32_16x16x32_bf16 v[100:103], a[76:79], a[28:31], v[100:103]
    v_mfma_f32_16x16x32_bf16 v[96:99], a[68:71], a[28:31], v[96:99]
    v_mfma_f32_16x16x32_bf16 v[96:99], a[64:67], a[24:27], v[96:99]
    buffer_load_dwordx4 v17, s[12:15], s36 offen offset:1024 sc1 lds
    v_mfma_f32_16x16x32_bf16 v[112:115], a[64:67], a[32:35], v[112:115]
    v_mfma_f32_16x16x32_bf16 v[112:115], a[68:71], a[36:39], v[112:115]
    v_mfma_f32_16x16x32_bf16 v[116:119], a[76:79], a[36:39], v[116:119]
    v_mfma_f32_16x16x32_bf16 v[116:119], a[72:75], a[32:35], v[116:119]
    buffer_load_dwordx4 v18, s[12:15], s36 offen offset:2048 sc1 lds
    v_mfma_f32_16x16x32_bf16 v[120:123], a[80:83], a[32:35], v[120:123]
    v_mfma_f32_16x16x32_bf16 v[120:123], a[84:87], a[36:39], v[120:123]
    v_mfma_f32_16x16x32_bf16 v[124:127], a[92:95], a[36:39], v[124:127]
    v_mfma_f32_16x16x32_bf16 v[124:127], a[88:91], a[32:35], v[124:127]
    buffer_load_dwordx4 v19, s[12:15], s36 offen offset:3072 sc1 lds
    v_mfma_f32_16x16x32_bf16 v[240:243], a[96:99], a[32:35], v[240:243]
    s_add_u32 s36, s36, 0x80
    v_mfma_f32_16x16x32_bf16 v[240:243], a[100:103], a[36:39], v[240:243]
    v_mfma_f32_16x16x32_bf16 v[244:247], a[108:111], a[36:39], v[244:247]
    s_add_u32 m0, s40, 49152
    v_mfma_f32_16x16x32_bf16 v[244:247], a[104:107], a[32:35], v[244:247]
    buffer_load_dwordx4 v1, s[12:15], s36 offen offset:0 sc1 lds
    v_mfma_f32_16x16x32_bf16 v[248:251], a[112:115], a[32:35], v[248:251]
    v_mfma_f32_16x16x32_bf16 v[248:251], a[116:119], a[36:39], v[248:251]
    v_mfma_f32_16x16x32_bf16 v[252:255], a[124:127], a[36:39], v[252:255]
    v_mfma_f32_16x16x32_bf16 v[252:255], a[120:123], a[32:35], v[252:255]
    buffer_load_dwordx4 v17, s[12:15], s36 offen offset:1024 sc1 lds
    v_mfma_f32_16x16x32_bf16 a[224:227], a[128:131], a[32:35], a[224:227]
    v_mfma_f32_16x16x32_bf16 a[224:227], a[132:135], a[36:39], a[224:227]
    v_mfma_f32_16x16x32_bf16 a[228:231], a[140:143], a[36:39], a[228:231]
    v_mfma_f32_16x16x32_bf16 a[228:231], a[136:139], a[32:35], a[228:231]
    buffer_load_dwordx4 v18, s[12:15], s36 offen offset:2048 sc1 lds
    v_mfma_f32_16x16x32_bf16 a[236:239], a[136:139], a[40:43], a[236:239]
    v_mfma_f32_16x16x32_bf16 a[236:239], a[140:143], a[44:47], a[236:239]
    v_mfma_f32_16x16x32_bf16 a[232:235], a[132:135], a[44:47], a[232:235]
    v_mfma_f32_16x16x32_bf16 a[232:235], a[128:131], a[40:43], a[232:235]
    buffer_load_dwordx4 v19, s[12:15], s36 offen offset:3072 sc1 lds
    v_mfma_f32_16x16x32_bf16 a[156:159], a[120:123], a[40:43], a[156:159]
    s_add_u32 s36, s36, 0x80
    v_mfma_f32_16x16x32_bf16 a[156:159], a[124:127], a[44:47], a[156:159]
    v_mfma_f32_16x16x32_bf16 a[152:155], a[116:119], a[44:47], a[152:155]
    v_mfma_f32_16x16x32_bf16 a[152:155], a[112:115], a[40:43], a[152:155]
    v_mfma_f32_16x16x32_bf16 a[148:151], a[104:107], a[40:43], a[148:151]
    s_waitcnt vmcnt(18)
    v_mfma_f32_16x16x32_bf16 a[148:151], a[108:111], a[44:47], a[148:151]
    s_barrier
    ds_read_b128 a[4:7], v4 offset:0
    v_mfma_f32_16x16x32_bf16 a[144:147], a[100:103], a[44:47], a[144:147]
    ds_read_b64_tr_b16 a[0:1], v9 offset:0
    v_mfma_f32_16x16x32_bf16 a[144:147], a[96:99], a[40:43], a[144:147]
    ds_read_b64_tr_b16 a[2:3], v9 offset:512
    v_mfma_f32_16x16x32_bf16 v[140:143], a[88:91], a[40:43], v[140:143]
    ds_read_b128 a[12:15], v4 offset:16384
    v_mfma_f32_16x16x32_bf16 v[140:143], a[92:95], a[44:47], v[140:143]
    ds_read_b64_tr_b16 a[8:9], v9 offset:4096
    v_mfma_f32_16x16x32_bf16 v[136:139], a[84:87], a[44:47], v[136:139]
    ds_read_b64_tr_b16 a[10:11], v9 offset:4608
    v_mfma_f32_16x16x32_bf16 v[136:139], a[80:83], a[40:43], v[136:139]
    ds_read_b64_tr_b16 a[20:21], v10 offset:4096
    v_mfma_f32_16x16x32_bf16 v[132:135], a[72:75], a[40:43], v[132:135]
    ds_read_b64_tr_b16 a[22:23], v10 offset:4608
    v_mfma_f32_16x16x32_bf16 v[132:135], a[76:79], a[44:47], v[132:135]
    ds_read_b64_tr_b16 a[16:17], v10 offset:0
    v_mfma_f32_16x16x32_bf16 v[128:131], a[68:71], a[44:47], v[128:131]
    ds_read_b64_tr_b16 a[18:19], v10 offset:512
    v_mfma_f32_16x16x32_bf16 v[128:131], a[64:67], a[40:43], v[128:131]
    ds_read_b128 a[28:31], v4 offset:1024
    v_mfma_f32_16x16x32_bf16 v[144:147], a[64:67], a[48:51], v[144:147]
    ds_read_b128 a[24:27], v4 offset:17408
    v_mfma_f32_16x16x32_bf16 v[144:147], a[68:71], a[52:55], v[144:147]
    ds_read_b128 a[36:39], v4 offset:2048
    v_mfma_f32_16x16x32_bf16 v[148:151], a[76:79], a[52:55], v[148:151]
    ds_read_b128 a[32:35], v4 offset:18432
    v_mfma_f32_16x16x32_bf16 v[148:151], a[72:75], a[48:51], v[148:151]
    ds_read_b128 a[44:47], v4 offset:3072
    v_mfma_f32_16x16x32_bf16 v[152:155], a[80:83], a[48:51], v[152:155]
    ds_read_b128 a[40:43], v4 offset:19456
    v_mfma_f32_16x16x32_bf16 v[152:155], a[84:87], a[52:55], v[152:155]
    v_mfma_f32_16x16x32_bf16 v[156:159], a[92:95], a[52:55], v[156:159]
    v_mfma_f32_16x16x32_bf16 v[156:159], a[88:91], a[48:51], v[156:159]
    v_mfma_f32_16x16x32_bf16 a[160:163], a[96:99], a[48:51], a[160:163]
    v_mfma_f32_16x16x32_bf16 a[160:163], a[100:103], a[52:55], a[160:163]
    v_mfma_f32_16x16x32_bf16 a[164:167], a[108:111], a[52:55], a[164:167]
    v_mfma_f32_16x16x32_bf16 a[164:167], a[104:107], a[48:51], a[164:167]
    v_mfma_f32_16x16x32_bf16 a[168:171], a[112:115], a[48:51], a[168:171]
    v_mfma_f32_16x16x32_bf16 a[168:171], a[116:119], a[52:55], a[168:171]
    v_mfma_f32_16x16x32_bf16 a[172:175], a[124:127], a[52:55], a[172:175]
    v_mfma_f32_16x16x32_bf16 a[172:175], a[120:123], a[48:51], a[172:175]
    v_mfma_f32_16x16x32_bf16 a[240:243], a[128:131], a[48:51], a[240:243]
    v_mfma_f32_16x16x32_bf16 a[240:243], a[132:135], a[52:55], a[240:243]
    v_mfma_f32_16x16x32_bf16 a[244:247], a[140:143], a[52:55], a[244:247]
L_pw2:
    s_cbranch_execz L_pw5
    ds_read_b128 a[52:55], v4 offset:4096
    v_mfma_f32_16x16x32_bf16 a[244:247], a[136:139], a[48:51], a[244:247]
    ds_read_b128 a[48:51], v4 offset:20480
    v_mfma_f32_16x16x32_bf16 a[176:179], a[96:99], a[56:59], a[176:179]
    ds_read_b128 a[96:99], v4 offset:5120
    v_mfma_f32_16x16x32_bf16 a[176:179], a[100:103], a[60:63], a[176:179]
    ds_read_b128 a[100:103], v4 offset:21504
    v_mfma_f32_16x16x32_bf16 a[180:183], a[108:111], a[60:63], a[180:183]
    ds_read_b128 a[108:111], v4 offset:6144
    v_mfma_f32_16x16x32_bf16 a[180:183], a[104:107], a[56:59], a[180:183]
    ds_read_b128 a[104:107], v4 offset:22528
    v_mfma_f32_16x16x32_bf16 a[184:187], a[112:115], a[56:59], a[184:187]
    ds_read_b128 a[112:115], v4 offset:7168
    v_mfma_f32_16x16x32_bf16 a[184:187], a[116:119], a[60:63], a[184:187]
    ds_read_b128 a[116:119], v4 offset:23552
    v_mfma_f32_16x16x32_bf16 a[188:191], a[124:127], a[60:63], a[188:191]
    v_mfma_f32_16x16x32_bf16 a[188:191], a[120:123], a[56:59], a[188:191]
    v_mfma_f32_16x16x32_bf16 a[248:251], a[128:131], a[56:59], a[248:251]
    v_mfma_f32_16x16x32_bf16 a[248:251], a[132:135], a[60:63], a[248:251]
    v_mfma_f32_16x16x32_bf16 a[252:255], a[140:143], a[60:63], a[252:255]
    v_mfma_f32_16x16x32_bf16 a[252:255], a[136:139], a[56:59], a[252:255]
    v_mfma_f32_16x16x32_bf16 v[160:163], a[64:67], a[56:59], v[160:163]
    v_mfma_f32_16x16x32_bf16 v[160:163], a[68:71], a[60:63], v[160:163]
    v_mfma_f32_16x16x32_bf16 v[164:167], a[76:79], a[60:63], v[164:167]
    v_mfma_f32_16x16x32_bf16 v[164:167], a[72:75], a[56:59], v[164:167]
    v_mfma_f32_16x16x32_bf16 v[168:171], a[80:83], a[56:59], v[168:171]
    v_mfma_f32_16x16x32_bf16 v[168:171], a[84:87], a[60:63], v[168:171]
    v_mfma_f32_16x16x32_bf16 v[172:175], a[92:95], a[60:63], v[172:175]
    v_mfma_f32_16x16x32_bf16 v[172:175], a[88:91], a[56:59], v[172:175]
    s_waitcnt lgkmcnt(15)
    v_mfma_f32_16x16x32_bf16 a[192:195], a[0:3], a[4:7], a[192:195]
    v_mfma_f32_16x16x32_bf16 a[192:195], a[8:11], a[12:15], a[192:195]
    s_waitcnt lgkmcnt(14)
    v_mfma_f32_16x16x32_bf16 a[196:199], a[20:23], a[12:15], a[196:199]
    v_mfma_f32_16x16x32_bf16 a[196:199], a[16:19], a[4:7], a[196:199]
    s_waitcnt lgkmcnt(12)
    v_mfma_f32_16x16x32_bf16 a[204:207], a[16:19], a[28:31], a[204:207]
    v_mfma_f32_16x16x32_bf16 a[204:207], a[20:23], a[24:27], a[204:207]
    v_mfma_f32_16x16x32_bf16 a[200:203], a[8:11], a[24:27], a[200:203]
    v_mfma_f32_16x16x32_bf16 a[200:203], a[0:3], a[28:31], a[200:203]
    s_waitcnt lgkmcnt(10)
    v_mfma_f32_16x16x32_bf16 a[208:211], a[0:3], a[36:39], a[208:211]
    v_mfma_f32_16x16x32_bf16 a[208:211], a[8:11], a[32:35], a[208:211]
    v_mfma_f32_16x16x32_bf16 a[212:215], a[20:23], a[32:35], a[212:215]
    v_mfma_f32_16x16x32_bf16 a[212:215], a[16:19], a[36:39], a[212:215]
    s_waitcnt lgkmcnt(8)
    v_mfma_f32_16x16x32_bf16 a[220:223], a[16:19], a[44:47], a[220:223]
    s_waitcnt vmcnt(0)
    v_mfma_f32_16x16x32_bf16 a[220:223], a[20:23], a[40:43], a[220:223]
    s_barrier
    ds_read_b128 a[124:127], v4 offset:32768
    v_mfma_f32_16x16x32_bf16 a[216:219], a[8:11], a[40:43], a[216:219]
    ds_read_b64_tr_b16 a[120:121], v9 offset:8192
    v_mfma_f32_16x16x32_bf16 a[216:219], a[0:3], a[44:47], a[216:219]
    s_waitcnt lgkmcnt(8)
    ds_read_b64_tr_b16 a[122:123], v9 offset:8704
    v_mfma_f32_16x16x32_bf16 a[224:227], a[0:3], a[52:55], a[224:227]
    ds_read_b128 a[128:131], v4 offset:49152
    v_mfma_f32_16x16x32_bf16 a[224:227], a[8:11], a[48:51], a[224:227]
    ds_read_b64_tr_b16 a[132:133], v9 offset:12288
    v_mfma_f32_16x16x32_bf16 a[228:231], a[20:23], a[48:51], a[228:231]
    ds_read_b64_tr_b16 a[134:135], v9 offset:12800
    v_mfma_f32_16x16x32_bf16 a[228:231], a[16:19], a[52:55], a[228:231]
    s_waitcnt lgkmcnt(10)
    ds_read_b64_tr_b16 a[140:141], v10 offset:12288
    v_mfma_f32_16x16x32_bf16 a[236:239], a[16:19], a[96:99], a[236:239]
    ds_read_b64_tr_b16 a[142:143], v10 offset:12800
    v_mfma_f32_16x16x32_bf16 a[236:239], a[20:23], a[100:103], a[236:239]
    ds_read_b64_tr_b16 a[136:137], v10 offset:8192
    v_mfma_f32_16x16x32_bf16 a[232:235], a[8:11], a[100:103], a[232:235]
    ds_read_b64_tr_b16 a[138:139], v10 offset:8704
    v_mfma_f32_16x16x32_bf16 a[232:235], a[0:3], a[96:99], a[232:235]
    s_waitcnt lgkmcnt(12)
    ds_read_b128 a[64:67], v4 offset:33792
    v_mfma_f32_16x16x32_bf16 a[240:243], a[0:3], a[108:111], a[240:243]
    ds_read_b128 a[68:71], v4 offset:50176
    v_mfma_f32_16x16x32_bf16 a[240:243], a[8:11], a[104:107], a[240:243]
    ds_read_b128 a[76:79], v4 offset:34816
    v_mfma_f32_16x16x32_bf16 a[244:247], a[20:23], a[104:107], a[244:247]
    ds_read_b128 a[72:75], v4 offset:51200
    v_mfma_f32_16x16x32_bf16 a[244:247], a[16:19], a[108:111], a[244:247]
    s_waitcnt lgkmcnt(14)
    ds_read_b128 a[80:83], v4 offset:35840
    v_mfma_f32_16x16x32_bf16 a[252:255], a[16:19], a[112:115], a[252:255]
    ds_read_b128 a[84:87], v4 offset:52224
    v_mfma_f32_16x16x32_bf16 a[252:255], a[20:23], a[116:119], a[252:255]
    ds_read_b128 a[60:63], v4 offset:36864
    v_mfma_f32_16x16x32_bf16 a[248:251], a[8:11], a[116:119], a[248:251]
    s_and_b32 s44, s2, 7
    ds_read_b128 a[92:95], v4 offset:53248
    v_mfma_f32_16x16x32_bf16 a[248:251], a[0:3], a[112:115], a[248:251]
    s_waitcnt lgkmcnt(12)
    s_lshl_b32 s44, s44, 2
    ds_read_b128 a[56:59], v4 offset:37888
    v_mfma_f32_16x16x32_bf16 a[192:195], a[120:123], a[124:127], a[192:195]
    s_lshr_b32 s44, 0x04621753, s44
    ds_read_b128 a[88:91], v4 offset:54272
    v_mfma_f32_16x16x32_bf16 a[192:195], a[132:135], a[128:131], a[192:195]
    s_waitcnt lgkmcnt(10)
    s_and_b32 s44, s44, 7
    ds_read_b128 a[12:15], v4 offset:38912
    v_mfma_f32_16x16x32_bf16 a[196:199], a[140:143], a[128:131], a[196:199]
    s_lshl_b32 s44, s44, 2
    ds_read_b128 a[4:7], v4 offset:55296
    v_mfma_f32_16x16x32_bf16 a[196:199], a[136:139], a[124:127], a[196:199]
    s_waitcnt lgkmcnt(10)
    s_lshr_b32 s43, s2, 3
    ds_read_b128 a[24:27], v4 offset:39936
    v_mfma_f32_16x16x32_bf16 a[204:207], a[136:139], a[64:67], a[204:207]
    s_lshr_b32 s3, s43, 3
    ds_read_b128 a[28:31], v4 offset:56320
    v_mfma_f32_16x16x32_bf16 a[204:207], a[140:143], a[68:71], a[204:207]
    s_add_u32 s44, s44, s3
    ds_read_b64_tr_b16 a[32:33], v5 offset:0
    v_mfma_f32_16x16x32_bf16 a[200:203], a[132:135], a[68:71], a[200:203]
    s_and_b32 s43, s43, 7
    ds_read_b64_tr_b16 a[34:35], v5 offset:512
    v_mfma_f32_16x16x32_bf16 a[200:203], a[120:123], a[64:67], a[200:203]
    s_waitcnt lgkmcnt(12)
    s_lshl_b32 s36, s45, 12
    ds_read_b64_tr_b16 a[36:37], v5 offset:4096
    v_mfma_f32_16x16x32_bf16 a[208:211], a[120:123], a[76:79], a[208:211]
    s_mov_b32 s37, s36
    ds_read_b64_tr_b16 a[38:39], v5 offset:4608
    v_mfma_f32_16x16x32_bf16 a[208:211], a[132:135], a[72:75], a[208:211]
    s_lshl_b32 s3, s44, 18
    ds_read_b64_tr_b16 a[40:41], v6 offset:4096
    v_mfma_f32_16x16x32_bf16 a[212:215], a[140:143], a[72:75], a[212:215]
    s_add_u32 s3, s3, 0x800000
    ds_read_b64_tr_b16 a[42:43], v6 offset:4608
    v_mfma_f32_16x16x32_bf16 a[212:215], a[136:139], a[76:79], a[212:215]
    s_waitcnt lgkmcnt(14)
    s_add_u32 s12, s4, s3
    s_addc_u32 s13, s5, 0
    ds_read_b64_tr_b16 a[44:45], v6 offset:0
    v_mfma_f32_16x16x32_bf16 a[220:223], a[136:139], a[80:83], a[220:223]
    s_and_b32 s13, s13, 0xffff
    ds_read_b64_tr_b16 a[46:47], v6 offset:512
    v_mfma_f32_16x16x32_bf16 a[220:223], a[140:143], a[84:87], a[220:223]
    s_mov_b32 s14, 0x40000
    ds_read_b64_tr_b16 a[16:17], v5 offset:32768
    v_mfma_f32_16x16x32_bf16 a[216:219], a[132:135], a[84:87], a[216:219]
    s_mov_b32 s15, 0x20000
    ds_read_b64_tr_b16 a[18:19], v5 offset:33280
    v_mfma_f32_16x16x32_bf16 a[216:219], a[120:123], a[80:83], a[216:219]
    s_waitcnt lgkmcnt(15)
    s_lshl_b32 s3, s44, 17
    ds_read_b64_tr_b16 a[20:21], v5 offset:36864
    v_mfma_f32_16x16x32_bf16 a[224:227], a[120:123], a[60:63], a[224:227]
    s_lshl_b32 s6, s43, 14
    ds_read_b64_tr_b16 a[22:23], v5 offset:37376
    v_mfma_f32_16x16x32_bf16 a[224:227], a[132:135], a[92:95], a[224:227]
    s_add_u32 s3, s3, s6
    ds_read_b64_tr_b16 a[8:9], v6 offset:36864
    v_mfma_f32_16x16x32_bf16 a[228:231], a[140:143], a[92:95], a[228:231]
    s_add_u32 s3, s3, s36
    ds_read_b64_tr_b16 a[10:11], v6 offset:37376
    v_mfma_f32_16x16x32_bf16 a[228:231], a[136:139], a[60:63], a[228:231]
    s_waitcnt lgkmcnt(15)
    s_add_u32 s3, s3, 0x400000
    ds_read_b64_tr_b16 a[0:1], v6 offset:32768
    v_mfma_f32_16x16x32_bf16 a[236:239], a[136:139], a[56:59], a[236:239]
    s_add_u32 s16, s4, s3
    s_addc_u32 s17, s5, 0
    ds_read_b64_tr_b16 a[2:3], v6 offset:33280
    v_mfma_f32_16x16x32_bf16 a[236:239], a[140:143], a[88:91], a[236:239]
    s_and_b32 s17, s17, 0xffff
    ds_read_b64_tr_b16 a[128:129], v5 offset:8192
    v_mfma_f32_16x16x32_bf16 a[232:235], a[132:135], a[88:91], a[232:235]
    s_mov_b32 s18, 0x1000
    ds_read_b64_tr_b16 a[130:131], v5 offset:8704
    v_mfma_f32_16x16x32_bf16 a[232:235], a[120:123], a[56:59], a[232:235]
    s_mov_b32 s19, 0x20000
    ds_read_b64_tr_b16 a[124:125], v5 offset:12288
    v_mfma_f32_16x16x32_bf16 a[240:243], a[120:123], a[12:15], a[240:243]
    s_and_b32 s3, s2, 7
    ds_read_b64_tr_b16 a[126:127], v5 offset:12800
    v_mfma_f32_16x16x32_bf16 a[240:243], a[132:135], a[4:7], a[240:243]
    s_lshr_b32 s6, s2, 3
    ds_read_b64_tr_b16 a[68:69], v6 offset:12288
    v_mfma_f32_16x16x32_bf16 a[244:247], a[140:143], a[4:7], a[244:247]
    s_lshr_b32 s46, s3, 1
    ds_read_b64_tr_b16 a[70:71], v6 offset:12800
    v_mfma_f32_16x16x32_bf16 a[244:247], a[136:139], a[12:15], a[244:247]
    s_waitcnt lgkmcnt(15)
    s_lshl_b32 s46, s46, 2
    ds_read_b64_tr_b16 a[64:65], v6 offset:8192
    v_mfma_f32_16x16x32_bf16 a[252:255], a[136:139], a[24:27], a[252:255]
    s_and_b32 s7, s6, 3
    ds_read_b64_tr_b16 a[66:67], v6 offset:8704
    v_mfma_f32_16x16x32_bf16 a[252:255], a[140:143], a[28:31], a[252:255]
    s_add_u32 s46, s46, s7
    ds_read_b64_tr_b16 a[72:73], v5 offset:40960
    v_mfma_f32_16x16x32_bf16 a[248:251], a[132:135], a[28:31], a[248:251]
    s_and_b32 s47, s3, 1
    ds_read_b64_tr_b16 a[74:75], v5 offset:41472
    v_mfma_f32_16x16x32_bf16 a[248:251], a[120:123], a[24:27], a[248:251]
    s_lshl_b32 s47, s47, 3
    ds_read_b64_tr_b16 a[76:77], v5 offset:45056
    v_mfma_f32_16x16x32_bf16 v[112:115], a[32:35], a[52:55], v[112:115]
    s_lshr_b32 s7, s6, 2
    ds_read_b64_tr_b16 a[78:79], v5 offset:45568
    v_mfma_f32_16x16x32_bf16 v[112:115], a[36:39], a[48:51], v[112:115]
    s_waitcnt lgkmcnt(15)
    s_add_u32 s47, s47, s7
    ds_read_b64_tr_b16 a[84:85], v6 offset:45056
    v_mfma_f32_16x16x32_bf16 v[116:119], a[40:43], a[48:51], v[116:119]
    s_lshl_b32 s41, s45, 14
    ds_read_b64_tr_b16 a[86:87], v6 offset:45568
    v_mfma_f32_16x16x32_bf16 v[116:119], a[44:47], a[52:55], v[116:119]
    s_add_u32 s41, s41, 0x10000
    ds_read_b64_tr_b16 a[80:81], v6 offset:40960
    v_accvgpr_read_b32 v16, a192
    v_accvgpr_read_b32 v17, a193
    v_accvgpr_read_b32 v18, a194
    v_accvgpr_read_b32 v19, a195
    v_mfma_f32_16x16x32_bf16 v[240:243], a[16:19], a[52:55], v[240:243]
    s_mul_i32 s3, s45, 1835008
    ds_read_b64_tr_b16 a[82:83], v6 offset:41472
    v_accvgpr_read_b32 v20, a196
    v_accvgpr_read_b32 v21, a197
    v_accvgpr_read_b32 v22, a198
    v_accvgpr_read_b32 v23, a199
    v_mul_f32 v16, s56, v16
    v_mfma_f32_16x16x32_bf16 v[240:243], a[20:23], a[48:51], v[240:243]
    s_waitcnt lgkmcnt(15)
    s_lshl_b32 s6, s47, 7
    ds_read_b64_tr_b16 a[136:137], v7 offset:0
    v_mul_f32 v17, s56, v17
    v_mul_f32 v18, s56, v18
    v_mul_f32 v19, s56, v19
    v_mul_f32 v20, s56, v20
    v_mfma_f32_16x16x32_bf16 v[244:247], a[8:11], a[48:51], v[244:247]
    s_add_u32 s3, s3, s6
    ds_read_b64_tr_b16 a[138:139], v7 offset:512
    v_mul_f32 v21, s56, v21
    v_mul_f32 v22, s56, v22
    v_mul_f32 v23, s56, v23
    v_cvt_pk_bf16_f32 v24, v16, v17
    v_mfma_f32_16x16x32_bf16 v[244:247], a[0:3], a[52:55], v[244:247]
    s_sub_u32 s7, 1835008, s6
    ds_read_b64_tr_b16 a[140:141], v7 offset:4096
    v_cvt_pk_bf16_f32 v25, v18, v19
    v_cvt_pk_bf16_f32 v26, v20, v21
    v_cvt_pk_bf16_f32 v27, v22, v23
    buffer_store_dwordx4 v[24:27], v13, s[32:35], s52 offen sc1
    v_accvgpr_read_b32 v32, a200
    v_mfma_f32_16x16x32_bf16 a[148:151], a[0:3], a[96:99], a[148:151]
    s_add_u32 s64, s60, s3
    s_addc_u32 s65, s61, 0
    ds_read_b64_tr_b16 a[142:143], v7 offset:4608
    v_accvgpr_read_b32 v33, a201
    v_accvgpr_read_b32 v34, a202
    v_accvgpr_read_b32 v35, a203
    v_accvgpr_read_b32 v36, a204
    v_mfma_f32_16x16x32_bf16 a[148:151], a[8:11], a[100:103], a[148:151]
    s_and_b32 s65, s65, 0xffff
    ds_read_b64_tr_b16 a[132:133], v8 offset:4096
    v_accvgpr_read_b32 v37, a205
    v_accvgpr_read_b32 v38, a206
    v_accvgpr_read_b32 v39, a207
    v_mul_f32 v32, s56, v32
    v_mul_f32 v33, s56, v33
    v_mfma_f32_16x16x32_bf16 a[144:147], a[20:23], a[100:103], a[144:147]
    s_mov_b32 s66, s7
    ds_read_b64_tr_b16 a[134:135], v8 offset:4608
    v_mul_f32 v34, s56, v34
    v_mul_f32 v35, s56, v35
    v_mul_f32 v36, s56, v36
    v_mul_f32 v37, s56, v37
    v_mfma_f32_16x16x32_bf16 a[144:147], a[16:19], a[96:99], a[144:147]
    s_mov_b32 s67, 0x20000
    ds_read_b64_tr_b16 a[120:121], v8 offset:0
    v_mul_f32 v38, s56, v38
    v_mul_f32 v39, s56, v39
    v_cvt_pk_bf16_f32 v40, v32, v33
    v_cvt_pk_bf16_f32 v41, v34, v35
    v_mfma_f32_16x16x32_bf16 v[132:135], a[44:47], a[96:99], v[132:135]
    s_mov_b32 s39, 0
    ds_read_b64_tr_b16 a[122:123], v8 offset:512
    v_cvt_pk_bf16_f32 v42, v36, v37
    v_cvt_pk_bf16_f32 v43, v38, v39
    buffer_store_dwordx4 v[40:43], v14, s[32:35], s52 offen sc1
    v_accvgpr_read_b32 v16, a208
    v_accvgpr_read_b32 v17, a209
    v_mfma_f32_16x16x32_bf16 v[132:135], a[40:43], a[100:103], v[132:135]
    s_mov_b32 s40, 0
    v_accvgpr_read_b32 v18, a210
    v_accvgpr_read_b32 v19, a211
    v_accvgpr_read_b32 v20, a212
    v_accvgpr_read_b32 v21, a213
    v_mfma_f32_16x16x32_bf16 v[128:131], a[36:39], a[100:103], v[128:131]
    s_mul_i32 s3, s46, 917504
    v_accvgpr_read_b32 v22, a214
    v_accvgpr_read_b32 v23, a215
    v_mul_f32 v16, s56, v16
    v_mul_f32 v17, s56, v17
    v_mfma_f32_16x16x32_bf16 v[128:131], a[32:35], a[96:99], v[128:131]
    s_mul_i32 s6, s45, 229376
    v_mul_f32 v18, s56, v18
    v_mul_f32 v19, s56, v19
    v_mul_f32 v20, s56, v20
    v_mul_f32 v21, s56, v21
    v_mul_f32 v22, s56, v22
    v_mfma_f32_16x16x32_bf16 v[144:147], a[32:35], a[108:111], v[144:147]
    s_add_u32 s3, s3, s6
    v_mul_f32 v23, s56, v23
    v_cvt_pk_bf16_f32 v24, v16, v17
    v_cvt_pk_bf16_f32 v25, v18, v19
    v_cvt_pk_bf16_f32 v26, v20, v21
    v_mfma_f32_16x16x32_bf16 v[144:147], a[36:39], a[104:107], v[144:147]
    s_add_u32 s3, s3, 0x1000000
    v_cvt_pk_bf16_f32 v27, v22, v23
    buffer_store_dwordx4 v[24:27], v13, s[32:35], s53 offen sc1
    v_accvgpr_read_b32 v32, a216
    v_accvgpr_read_b32 v33, a217
    v_mfma_f32_16x16x32_bf16 v[148:151], a[40:43], a[104:107], v[148:151]
    s_add_u32 s24, s4, s3
    s_addc_u32 s25, s5, 0
    v_accvgpr_read_b32 v34, a218
    v_accvgpr_read_b32 v35, a219
    v_accvgpr_read_b32 v36, a220
    v_accvgpr_read_b32 v37, a221
    v_accvgpr_read_b32 v38, a222
    v_mfma_f32_16x16x32_bf16 v[148:151], a[44:47], a[108:111], v[148:151]
    s_and_b32 s25, s25, 0xffff
    v_accvgpr_read_b32 v39, a223
    v_mul_f32 v32, s56, v32
    v_mul_f32 v33, s56, v33
    v_mul_f32 v34, s56, v34
    v_mfma_f32_16x16x32_bf16 a[160:163], a[16:19], a[108:111], a[160:163]
    s_mov_b32 s26, 0x38000
    v_mul_f32 v35, s56, v35
    v_mul_f32 v36, s56, v36
    v_mul_f32 v37, s56, v37
    v_mul_f32 v38, s56, v38
    v_mul_f32 v39, s56, v39
    v_mfma_f32_16x16x32_bf16 a[160:163], a[20:23], a[104:107], a[160:163]
    s_mov_b32 s27, 0x20000
    v_cvt_pk_bf16_f32 v40, v32, v33
    v_cvt_pk_bf16_f32 v41, v34, v35
    v_cvt_pk_bf16_f32 v42, v36, v37
    v_cvt_pk_bf16_f32 v43, v38, v39
    v_mfma_f32_16x16x32_bf16 a[164:167], a[8:11], a[104:107], a[164:167]
    s_lshl_b32 s3, s43, 2
    buffer_store_dwordx4 v[40:43], v14, s[32:35], s53 offen sc1
    v_accvgpr_read_b32 v16, a224
    v_accvgpr_read_b32 v17, a225
    v_accvgpr_read_b32 v18, a226
    v_mfma_f32_16x16x32_bf16 a[164:167], a[0:3], a[108:111], a[164:167]
    s_add_u32 s3, s3, s45
    v_accvgpr_read_b32 v19, a227
    v_accvgpr_read_b32 v20, a228
    v_accvgpr_read_b32 v21, a229
    v_accvgpr_read_b32 v22, a230
    v_accvgpr_read_b32 v23, a231
    v_mfma_f32_16x16x32_bf16 a[180:183], a[0:3], a[112:115], a[180:183]
    s_mul_i32 s3, s3, 139776
    ds_read_b64_tr_b16 a[0:1], v7 offset:32768
    v_mul_f32 v16, s56, v16
    v_mul_f32 v17, s56, v17
    v_mul_f32 v18, s56, v18
    v_mul_f32 v19, s56, v19
    v_mfma_f32_16x16x32_bf16 a[180:183], a[8:11], a[116:119], a[180:183]
    s_lshl_b32 s6, s44, 11
    ds_read_b64_tr_b16 a[2:3], v7 offset:33280
    v_mul_f32 v20, s56, v20
    v_mul_f32 v21, s56, v21
    v_mul_f32 v22, s56, v22
    v_mul_f32 v23, s56, v23
    v_mfma_f32_16x16x32_bf16 a[176:179], a[20:23], a[116:119], a[176:179]
    s_add_u32 s3, s3, s6
    ds_read_b64_tr_b16 a[8:9], v7 offset:36864
    v_cvt_pk_bf16_f32 v24, v16, v17
    v_cvt_pk_bf16_f32 v25, v18, v19
    v_cvt_pk_bf16_f32 v26, v20, v21
    v_cvt_pk_bf16_f32 v27, v22, v23
    buffer_store_dwordx4 v[24:27], v13, s[32:35], s54 offen sc1
    v_mfma_f32_16x16x32_bf16 a[176:179], a[16:19], a[112:115], a[176:179]
    s_add_u32 s3, s3, 0x2000000
    ds_read_b64_tr_b16 a[10:11], v7 offset:37376
    v_accvgpr_read_b32 v32, a232
    v_accvgpr_read_b32 v33, a233
    v_accvgpr_read_b32 v34, a234
    v_accvgpr_read_b32 v35, a235
    v_mfma_f32_16x16x32_bf16 v[164:167], a[44:47], a[112:115], v[164:167]
    s_add_u32 s20, s4, s3
    s_addc_u32 s21, s5, 0
    ds_read_b64_tr_b16 a[20:21], v8 offset:36864
    v_accvgpr_read_b32 v36, a236
    v_accvgpr_read_b32 v37, a237
    v_accvgpr_read_b32 v38, a238
    v_accvgpr_read_b32 v39, a239
    v_mfma_f32_16x16x32_bf16 v[164:167], a[40:43], a[116:119], v[164:167]
    s_and_b32 s21, s21, 0xffff
    ds_read_b64_tr_b16 a[22:23], v8 offset:37376
    v_mul_f32 v32, s56, v32
    v_mul_f32 v33, s56, v33
    v_mul_f32 v34, s56, v34
    v_mul_f32 v35, s56, v35
    v_mul_f32 v36, s56, v36
    v_mfma_f32_16x16x32_bf16 v[160:163], a[36:39], a[116:119], v[160:163]
    s_mov_b32 s22, 0x11900
    ds_read_b64_tr_b16 a[16:17], v8 offset:32768
    v_mul_f32 v37, s56, v37
    v_mul_f32 v38, s56, v38
    v_mul_f32 v39, s56, v39
    v_cvt_pk_bf16_f32 v40, v32, v33
    v_mfma_f32_16x16x32_bf16 v[160:163], a[32:35], a[112:115], v[160:163]
    s_waitcnt lgkmcnt(15)
    s_mov_b32 s23, 0x20000
    ds_read_b64_tr_b16 a[18:19], v8 offset:33280
    v_cvt_pk_bf16_f32 v41, v34, v35
    v_cvt_pk_bf16_f32 v42, v36, v37
    v_cvt_pk_bf16_f32 v43, v38, v39
    buffer_store_dwordx4 v[40:43], v14, s[32:35], s54 offen sc1
    v_accvgpr_read_b32 v16, a240
    v_mfma_f32_16x16x32_bf16 v[112:115], a[128:131], a[60:63], v[112:115]
    s_mov_b32 s50, 69888
    ds_read_b64_tr_b16 a[44:45], v7 offset:8192
    v_accvgpr_read_b32 v17, a241
    v_accvgpr_read_b32 v18, a242
    v_accvgpr_read_b32 v19, a243
    v_accvgpr_read_b32 v20, a244
    v_mfma_f32_16x16x32_bf16 v[112:115], a[124:127], a[92:95], v[112:115]
    s_mov_b32 s38, 0x4000
    ds_read_b64_tr_b16 a[46:47], v7 offset:8704
    v_accvgpr_read_b32 v21, a245
    v_accvgpr_read_b32 v22, a246
    v_accvgpr_read_b32 v23, a247
    v_mul_f32 v16, s56, v16
    v_mfma_f32_16x16x32_bf16 v[116:119], a[68:71], a[92:95], v[116:119]
    s_lshl_b32 s68, s45, 16
    ds_read_b64_tr_b16 a[40:41], v7 offset:12288
    v_mul_f32 v17, s56, v17
    v_mul_f32 v18, s56, v18
    v_mul_f32 v19, s56, v19
    v_mul_f32 v20, s56, v20
    v_mul_f32 v21, s56, v21
    v_mfma_f32_16x16x32_bf16 v[116:119], a[64:67], a[60:63], v[116:119]
    s_lshl_b32 s49, s45, 12
    ds_read_b64_tr_b16 a[42:43], v7 offset:12800
    v_mul_f32 v22, s56, v22
    v_mul_f32 v23, s56, v23
    v_cvt_pk_bf16_f32 v24, v16, v17
    v_cvt_pk_bf16_f32 v25, v18, v19
    v_mfma_f32_16x16x32_bf16 v[240:243], a[72:75], a[60:63], v[240:243]
    s_lshr_b32 s69, s46, 1
    ds_read_b64_tr_b16 a[36:37], v8 offset:12288
    v_cvt_pk_bf16_f32 v26, v20, v21
    v_cvt_pk_bf16_f32 v27, v22, v23
    buffer_store_dwordx4 v[24:27], v13, s[32:35], s55 offen sc1
    v_accvgpr_read_b32 v32, a248
    v_mfma_f32_16x16x32_bf16 v[240:243], a[76:79], a[92:95], v[240:243]
    s_mov_b32 s42, 13
    ds_read_b64_tr_b16 a[38:39], v8 offset:12800
    v_accvgpr_read_b32 v33, a249
    v_accvgpr_read_b32 v34, a250
    v_accvgpr_read_b32 v35, a251
    v_accvgpr_read_b32 v36, a252
    v_accvgpr_read_b32 v37, a253
    v_mfma_f32_16x16x32_bf16 v[244:247], a[84:87], a[92:95], v[244:247]
    ds_read_b64_tr_b16 a[32:33], v8 offset:8192
    v_accvgpr_read_b32 v38, a254
    v_accvgpr_read_b32 v39, a255
    v_mul_f32 v32, s56, v32
    v_mul_f32 v33, s56, v33
    v_mfma_f32_16x16x32_bf16 v[244:247], a[80:83], a[60:63], v[244:247]
    ds_read_b64_tr_b16 a[34:35], v8 offset:8704
    v_mul_f32 v34, s56, v34
    v_mul_f32 v35, s56, v35
    v_mul_f32 v36, s56, v36
    v_mul_f32 v37, s56, v37
    v_mfma_f32_16x16x32_bf16 a[148:151], a[80:83], a[56:59], a[148:151]
    v_mul_f32 v38, s56, v38
    v_mul_f32 v39, s56, v39
    v_cvt_pk_bf16_f32 v40, v32, v33
    v_cvt_pk_bf16_f32 v41, v34, v35
    v_cvt_pk_bf16_f32 v42, v36, v37
    v_mfma_f32_16x16x32_bf16 a[148:151], a[84:87], a[88:91], a[148:151]
    v_cvt_pk_bf16_f32 v43, v38, v39
    buffer_store_dwordx4 v[40:43], v14, s[32:35], s55 offen sc1
    v_mfma_f32_16x16x32_bf16 a[144:147], a[76:79], a[88:91], a[144:147]
    v_mfma_f32_16x16x32_bf16 a[144:147], a[72:75], a[56:59], a[144:147]
    v_mfma_f32_16x16x32_bf16 v[132:135], a[64:67], a[56:59], v[132:135]
    v_mfma_f32_16x16x32_bf16 v[132:135], a[68:71], a[88:91], v[132:135]
    v_mfma_f32_16x16x32_bf16 v[128:131], a[124:127], a[88:91], v[128:131]
    v_mfma_f32_16x16x32_bf16 v[128:131], a[128:131], a[56:59], v[128:131]
    v_mfma_f32_16x16x32_bf16 v[144:147], a[128:131], a[12:15], v[144:147]
    v_mfma_f32_16x16x32_bf16 v[144:147], a[124:127], a[4:7], v[144:147]
    v_mfma_f32_16x16x32_bf16 v[148:151], a[68:71], a[4:7], v[148:151]
    v_mfma_f32_16x16x32_bf16 v[148:151], a[64:67], a[12:15], v[148:151]
    v_mfma_f32_16x16x32_bf16 a[160:163], a[72:75], a[12:15], a[160:163]
    v_mfma_f32_16x16x32_bf16 a[160:163], a[76:79], a[4:7], a[160:163]
    v_mfma_f32_16x16x32_bf16 a[164:167], a[84:87], a[4:7], a[164:167]
    v_mfma_f32_16x16x32_bf16 a[164:167], a[80:83], a[12:15], a[164:167]
    v_mfma_f32_16x16x32_bf16 a[180:183], a[80:83], a[24:27], a[180:183]
    ds_read_b64_tr_b16 a[80:81], v7 offset:40960
    v_mfma_f32_16x16x32_bf16 a[180:183], a[84:87], a[28:31], a[180:183]
    ds_read_b64_tr_b16 a[82:83], v7 offset:41472
    v_mfma_f32_16x16x32_bf16 a[176:179], a[76:79], a[28:31], a[176:179]
    ds_read_b64_tr_b16 a[84:85], v7 offset:45056
    v_mfma_f32_16x16x32_bf16 a[176:179], a[72:75], a[24:27], a[176:179]
    ds_read_b64_tr_b16 a[86:87], v7 offset:45568
    v_mfma_f32_16x16x32_bf16 v[164:167], a[64:67], a[24:27], v[164:167]
    ds_read_b64_tr_b16 a[76:77], v8 offset:45056
    v_mfma_f32_16x16x32_bf16 v[164:167], a[68:71], a[28:31], v[164:167]
    ds_read_b64_tr_b16 a[78:79], v8 offset:45568
    v_mfma_f32_16x16x32_bf16 v[160:163], a[124:127], a[28:31], v[160:163]
    ds_read_b64_tr_b16 a[72:73], v8 offset:40960
    v_mfma_f32_16x16x32_bf16 v[160:163], a[128:131], a[24:27], v[160:163]
    s_waitcnt lgkmcnt(15)
    ds_read_b64_tr_b16 a[74:75], v8 offset:41472
    v_mfma_f32_16x16x32_bf16 v[120:123], a[136:139], a[52:55], v[120:123]
    ds_read_b128 a[64:67], v4 offset:0
    v_mfma_f32_16x16x32_bf16 v[120:123], a[140:143], a[48:51], v[120:123]
    ds_read_b128 a[68:71], v4 offset:16384
    v_mfma_f32_16x16x32_bf16 v[124:127], a[132:135], a[48:51], v[124:127]
    ds_read_b128 a[124:127], v4 offset:1024
    v_mfma_f32_16x16x32_bf16 v[124:127], a[120:123], a[52:55], v[124:127]
    ds_read_b128 a[128:131], v4 offset:17408
    v_mul_f32 v112, s58, v112
    v_mul_f32 v113, s58, v113
    v_mul_f32 v114, s58, v114
    v_mul_f32 v115, s58, v115
    v_mfma_f32_16x16x32_bf16 v[248:251], a[0:3], a[52:55], v[248:251]
    v_mul_f32 v116, s58, v116
    v_mul_f32 v117, s58, v117
    v_mul_f32 v118, s58, v118
    v_mul_f32 v119, s58, v119
    v_mfma_f32_16x16x32_bf16 v[248:251], a[8:11], a[48:51], v[248:251]
    v_exp_f32 v112, v112
    v_exp_f32 v113, v113
    v_exp_f32 v114, v114
    v_mfma_f32_16x16x32_bf16 v[252:255], a[20:23], a[48:51], v[252:255]
    v_exp_f32 v115, v115
    v_exp_f32 v116, v116
    v_mfma_f32_16x16x32_bf16 v[252:255], a[16:19], a[52:55], v[252:255]
    v_exp_f32 v117, v117
    v_exp_f32 v118, v118
    v_mfma_f32_16x16x32_bf16 a[156:159], a[16:19], a[96:99], a[156:159]
    ds_read_b128 a[48:51], v4 offset:2048
    v_exp_f32 v119, v119
    v_add_f32 v112, 1.0, v112
    v_add_f32 v113, 1.0, v113
    v_mfma_f32_16x16x32_bf16 a[156:159], a[20:23], a[100:103], a[156:159]
    ds_read_b128 a[52:55], v4 offset:18432
    v_add_f32 v114, 1.0, v114
    v_add_f32 v115, 1.0, v115
    v_add_f32 v116, 1.0, v116
    v_add_f32 v117, 1.0, v117
    v_add_f32 v118, 1.0, v118
    v_mfma_f32_16x16x32_bf16 a[152:155], a[8:11], a[100:103], a[152:155]
    v_add_f32 v119, 1.0, v119
    v_rcp_f32 v112, v112
    v_mfma_f32_16x16x32_bf16 a[152:155], a[0:3], a[96:99], a[152:155]
    v_rcp_f32 v113, v113
    v_rcp_f32 v114, v114
    v_rcp_f32 v115, v115
    v_mfma_f32_16x16x32_bf16 v[140:143], a[120:123], a[96:99], v[140:143]
    v_rcp_f32 v116, v116
    v_rcp_f32 v117, v117
    v_mfma_f32_16x16x32_bf16 v[140:143], a[132:135], a[100:103], v[140:143]
    v_rcp_f32 v118, v118
    v_rcp_f32 v119, v119
    v_mfma_f32_16x16x32_bf16 v[136:139], a[140:143], a[100:103], v[136:139]
    v_mul_f32 v112, v112, v240
    v_mul_f32 v113, v113, v241
    v_mul_f32 v114, v114, v242
    v_mul_f32 v115, v115, v243
    v_mfma_f32_16x16x32_bf16 v[136:139], a[136:139], a[96:99], v[136:139]
    v_mul_f32 v116, v116, v244
    v_mul_f32 v117, v117, v245
    v_mul_f32 v118, v118, v246
    v_mul_f32 v119, v119, v247
    v_cvt_pk_bf16_f32 v24, v112, v113
    v_mfma_f32_16x16x32_bf16 v[152:155], a[136:139], a[108:111], v[152:155]
    ds_read_b128 a[100:103], v4 offset:3072
    v_cvt_pk_bf16_f32 v25, v114, v115
    s_movk_i32 s51, 0x1000
    v_cvt_pk_bf16_f32 v26, v116, v117
    v_cvt_pk_bf16_f32 v27, v118, v119
    v_mfma_f32_16x16x32_bf16 v[152:155], a[140:143], a[104:107], v[152:155]
    ds_read_b128 a[96:99], v4 offset:19456
    buffer_store_dwordx4 v[24:27], v12, s[28:31], s51 offen offset:0 sc1
    v_mul_f32 v128, s58, v128
    v_mul_f32 v129, s58, v129
    v_mul_f32 v130, s58, v130
    v_mfma_f32_16x16x32_bf16 v[156:159], a[132:135], a[104:107], v[156:159]
    v_mul_f32 v131, s58, v131
    v_mul_f32 v132, s58, v132
    v_mul_f32 v133, s58, v133
    v_mul_f32 v134, s58, v134
    v_mul_f32 v135, s58, v135
    v_mfma_f32_16x16x32_bf16 v[156:159], a[120:123], a[108:111], v[156:159]
    v_exp_f32 v128, v128
    v_exp_f32 v129, v129
    v_mfma_f32_16x16x32_bf16 a[168:171], a[0:3], a[108:111], a[168:171]
    v_exp_f32 v130, v130
    v_exp_f32 v131, v131
    v_mfma_f32_16x16x32_bf16 a[168:171], a[8:11], a[104:107], a[168:171]
    v_exp_f32 v132, v132
    v_exp_f32 v133, v133
    v_mfma_f32_16x16x32_bf16 a[172:175], a[20:23], a[104:107], a[172:175]
    v_exp_f32 v134, v134
    v_exp_f32 v135, v135
    v_accvgpr_read_b32 v32, a144
    v_mfma_f32_16x16x32_bf16 a[172:175], a[16:19], a[108:111], a[172:175]
L_pw3:
    s_cbranch_execz L_pw6
    v_accvgpr_read_b32 v33, a145
    v_accvgpr_read_b32 v34, a146
    v_accvgpr_read_b32 v35, a147
    v_accvgpr_read_b32 v36, a148
    v_accvgpr_read_b32 v37, a149
    v_mfma_f32_16x16x32_bf16 a[188:191], a[16:19], a[112:115], a[188:191]
    ds_read_b128 a[104:107], v4 offset:32768
    v_accvgpr_read_b32 v38, a150
    v_accvgpr_read_b32 v39, a151
    v_add_f32 v128, 1.0, v128
    v_add_f32 v129, 1.0, v129
    v_mfma_f32_16x16x32_bf16 a[188:191], a[20:23], a[116:119], a[188:191]
    ds_read_b128 a[108:111], v4 offset:49152
    v_add_f32 v130, 1.0, v130
    v_add_f32 v131, 1.0, v131
    v_add_f32 v132, 1.0, v132
    v_add_f32 v133, 1.0, v133
    v_mfma_f32_16x16x32_bf16 a[184:187], a[8:11], a[116:119], a[184:187]
    v_add_f32 v134, 1.0, v134
    v_add_f32 v135, 1.0, v135
    v_rcp_f32 v128, v128
    v_mfma_f32_16x16x32_bf16 a[184:187], a[0:3], a[112:115], a[184:187]
    v_rcp_f32 v129, v129
    v_rcp_f32 v130, v130
    v_rcp_f32 v131, v131
    v_mfma_f32_16x16x32_bf16 v[172:175], a[120:123], a[112:115], v[172:175]
    v_rcp_f32 v132, v132
    v_rcp_f32 v133, v133
    v_mfma_f32_16x16x32_bf16 v[172:175], a[132:135], a[116:119], v[172:175]
    v_rcp_f32 v134, v134
    v_rcp_f32 v135, v135
    v_mfma_f32_16x16x32_bf16 v[168:171], a[140:143], a[116:119], v[168:171]
    v_mul_f32 v128, v128, v32
    v_mul_f32 v129, v129, v33
    v_mul_f32 v130, v130, v34
    v_mul_f32 v131, v131, v35
    v_mfma_f32_16x16x32_bf16 v[168:171], a[136:139], a[112:115], v[168:171]
    s_waitcnt lgkmcnt(15)
    v_mul_f32 v132, v132, v36
    v_mul_f32 v133, v133, v37
    v_mul_f32 v134, v134, v38
    v_mul_f32 v135, v135, v39
    v_cvt_pk_bf16_f32 v40, v128, v129
    v_mfma_f32_16x16x32_bf16 v[120:123], a[44:47], a[60:63], v[120:123]
    ds_read_b128 a[116:119], v4 offset:33792
    v_cvt_pk_bf16_f32 v41, v130, v131
    s_movk_i32 s51, 0x1000
    v_cvt_pk_bf16_f32 v42, v132, v133
    v_cvt_pk_bf16_f32 v43, v134, v135
    v_mfma_f32_16x16x32_bf16 v[120:123], a[40:43], a[92:95], v[120:123]
    ds_read_b128 a[112:115], v4 offset:50176
    buffer_store_dwordx4 v[40:43], v12, s[28:31], s51 offen offset:1024 sc1
    v_mul_f32 v144, s58, v144
    v_mul_f32 v145, s58, v145
    v_mul_f32 v146, s58, v146
    v_mfma_f32_16x16x32_bf16 v[124:127], a[36:39], a[92:95], v[124:127]
    v_mul_f32 v147, s58, v147
    v_mul_f32 v148, s58, v148
    v_mul_f32 v149, s58, v149
    v_mul_f32 v150, s58, v150
    v_mul_f32 v151, s58, v151
    v_mfma_f32_16x16x32_bf16 v[124:127], a[32:35], a[60:63], v[124:127]
    s_waitcnt lgkmcnt(15)
    v_exp_f32 v144, v144
    v_exp_f32 v145, v145
    v_mfma_f32_16x16x32_bf16 v[248:251], a[80:83], a[60:63], v[248:251]
    v_exp_f32 v146, v146
    v_exp_f32 v147, v147
    v_mfma_f32_16x16x32_bf16 v[248:251], a[84:87], a[92:95], v[248:251]
    s_waitcnt lgkmcnt(12)
    v_exp_f32 v148, v148
    v_exp_f32 v149, v149
    v_mfma_f32_16x16x32_bf16 v[252:255], a[76:79], a[92:95], v[252:255]
    v_exp_f32 v150, v150
    v_exp_f32 v151, v151
    v_accvgpr_read_b32 v16, a160
    v_mfma_f32_16x16x32_bf16 v[252:255], a[72:75], a[60:63], v[252:255]
    v_accvgpr_read_b32 v17, a161
    v_accvgpr_read_b32 v18, a162
    v_accvgpr_read_b32 v19, a163
    v_accvgpr_read_b32 v20, a164
    v_mfma_f32_16x16x32_bf16 a[156:159], a[72:75], a[56:59], a[156:159]
    ds_read_b128 a[92:95], v4 offset:34816
    v_accvgpr_read_b32 v21, a165
    v_accvgpr_read_b32 v22, a166
    v_accvgpr_read_b32 v23, a167
    v_add_f32 v144, 1.0, v144
    v_add_f32 v145, 1.0, v145
    v_mfma_f32_16x16x32_bf16 a[156:159], a[76:79], a[88:91], a[156:159]
    ds_read_b128 a[60:63], v4 offset:51200
    v_add_f32 v146, 1.0, v146
    v_add_f32 v147, 1.0, v147
    v_add_f32 v148, 1.0, v148
    v_add_f32 v149, 1.0, v149
    v_mfma_f32_16x16x32_bf16 a[152:155], a[84:87], a[88:91], a[152:155]
    s_waitcnt vmcnt(2)
    v_add_f32 v150, 1.0, v150
    v_add_f32 v151, 1.0, v151
    v_rcp_f32 v144, v144
    v_mfma_f32_16x16x32_bf16 a[152:155], a[80:83], a[56:59], a[152:155]
    s_barrier
    v_rcp_f32 v145, v145
    v_rcp_f32 v146, v146
    v_mfma_f32_16x16x32_bf16 v[140:143], a[32:35], a[56:59], v[140:143]
    s_cmp_lg_u32 s45, 0
    s_cbranch_scc1 L_f2_ns
    v_mov_b32 v44, 2
    v_mov_b32 v45, 0
    s_mov_b64 exec, 1
    buffer_store_dword v44, v45, s[76:79], s73 offen sc1
    s_mov_b64 exec, -1
L_f2_ns:
    v_rcp_f32 v147, v147
    v_rcp_f32 v148, v148
    v_rcp_f32 v149, v149
    v_mfma_f32_16x16x32_bf16 v[140:143], a[36:39], a[88:91], v[140:143]
    v_rcp_f32 v150, v150
    v_rcp_f32 v151, v151
    v_mfma_f32_16x16x32_bf16 v[136:139], a[40:43], a[88:91], v[136:139]
    s_lshl_b32 s6, s47, 7
    v_mul_f32 v144, v144, v16
    v_mul_f32 v145, v145, v17
    v_mul_f32 v146, v146, v18
    v_mul_f32 v147, v147, v19
    v_mfma_f32_16x16x32_bf16 v[136:139], a[44:47], a[56:59], v[136:139]
    s_sub_u32 s7, 2097152, s6
    v_mul_f32 v148, v148, v20
    v_mul_f32 v149, v149, v21
    v_mul_f32 v150, v150, v22
    v_mul_f32 v151, v151, v23
    v_mfma_f32_16x16x32_bf16 v[152:155], a[44:47], a[12:15], v[152:155]
    s_add_u32 s32, s8, s6
    s_addc_u32 s33, s9, 0
    ds_read_b128 a[88:91], v4 offset:35840
    v_cvt_pk_bf16_f32 v24, v144, v145
    v_cvt_pk_bf16_f32 v25, v146, v147
    s_movk_i32 s51, 0x1000
    v_cvt_pk_bf16_f32 v26, v148, v149
    v_cvt_pk_bf16_f32 v27, v150, v151
    v_mfma_f32_16x16x32_bf16 v[152:155], a[40:43], a[4:7], v[152:155]
    s_and_b32 s33, s33, 0xffff
    ds_read_b128 a[56:59], v4 offset:52224
    buffer_store_dwordx4 v[24:27], v12, s[28:31], s51 offen offset:2048 sc1
    v_mul_f32 v160, s58, v160
    v_mul_f32 v161, s58, v161
    v_mul_f32 v162, s58, v162
    v_mfma_f32_16x16x32_bf16 v[156:159], a[36:39], a[4:7], v[156:159]
    s_mov_b32 s34, s7
    v_mul_f32 v163, s58, v163
    v_mul_f32 v164, s58, v164
    v_mul_f32 v165, s58, v165
    v_mul_f32 v166, s58, v166
    v_mfma_f32_16x16x32_bf16 v[156:159], a[32:35], a[12:15], v[156:159]
    s_mov_b32 s35, 0x20000
    v_mul_f32 v167, s58, v167
    v_exp_f32 v160, v160
    v_exp_f32 v161, v161
    v_mfma_f32_16x16x32_bf16 a[168:171], a[80:83], a[12:15], a[168:171]
    s_add_u32 s52, s45, 0
    v_exp_f32 v162, v162
    v_exp_f32 v163, v163
    v_mfma_f32_16x16x32_bf16 a[168:171], a[84:87], a[4:7], a[168:171]
    s_and_b32 s52, s52, 3
    v_exp_f32 v164, v164
    v_exp_f32 v165, v165
    v_mfma_f32_16x16x32_bf16 a[172:175], a[76:79], a[4:7], a[172:175]
    s_lshl_b32 s52, s52, 11
    v_exp_f32 v166, v166
    v_exp_f32 v167, v167
    v_accvgpr_read_b32 v32, a176
    v_mfma_f32_16x16x32_bf16 a[172:175], a[72:75], a[12:15], a[172:175]
    s_add_u32 s53, s45, 1
    v_accvgpr_read_b32 v33, a177
    v_accvgpr_read_b32 v34, a178
    v_accvgpr_read_b32 v35, a179
    v_accvgpr_read_b32 v36, a180
    v_mfma_f32_16x16x32_bf16 a[188:191], a[72:75], a[24:27], a[188:191]
    s_and_b32 s53, s53, 3
    ds_read_b64_tr_b16 a[4:5], v5 offset:0
    v_accvgpr_read_b32 v37, a181
    v_accvgpr_read_b32 v38, a182
    v_accvgpr_read_b32 v39, a183
    v_add_f32 v160, 1.0, v160
    v_add_f32 v161, 1.0, v161
    v_mfma_f32_16x16x32_bf16 a[188:191], a[76:79], a[28:31], a[188:191]
    s_lshl_b32 s53, s53, 11
    ds_read_b64_tr_b16 a[6:7], v5 offset:512
    v_add_f32 v162, 1.0, v162
    v_add_f32 v163, 1.0, v163
    v_add_f32 v164, 1.0, v164
    v_add_f32 v165, 1.0, v165
    v_mfma_f32_16x16x32_bf16 a[184:187], a[84:87], a[28:31], a[184:187]
    s_add_u32 s54, s45, 2
    ds_read_b64_tr_b16 a[12:13], v5 offset:4096
    v_add_f32 v166, 1.0, v166
    v_add_f32 v167, 1.0, v167
    v_rcp_f32 v160, v160
    v_mfma_f32_16x16x32_bf16 a[184:187], a[80:83], a[24:27], a[184:187]
    s_and_b32 s54, s54, 3
    ds_read_b64_tr_b16 a[14:15], v5 offset:4608
    v_rcp_f32 v161, v161
    v_rcp_f32 v162, v162
    v_mfma_f32_16x16x32_bf16 v[172:175], a[32:35], a[24:27], v[172:175]
    s_lshl_b32 s54, s54, 11
    v_rcp_f32 v163, v163
    v_rcp_f32 v164, v164
    v_rcp_f32 v165, v165
    v_mfma_f32_16x16x32_bf16 v[172:175], a[36:39], a[28:31], v[172:175]
    s_add_u32 s55, s45, 3
    v_rcp_f32 v166, v166
    v_rcp_f32 v167, v167
    v_mfma_f32_16x16x32_bf16 v[168:171], a[40:43], a[28:31], v[168:171]
    s_and_b32 s55, s55, 3
    ds_read_b64_tr_b16 a[28:29], v6 offset:4096
    v_mul_f32 v160, v160, v32
    v_mul_f32 v161, v161, v33
    v_mul_f32 v162, v162, v34
    v_mul_f32 v163, v163, v35
    v_mfma_f32_16x16x32_bf16 v[168:171], a[44:47], a[24:27], v[168:171]
    s_waitcnt lgkmcnt(15)
    s_lshl_b32 s55, s55, 11
    ds_read_b64_tr_b16 a[30:31], v6 offset:4608
    v_mul_f32 v164, v164, v36
    v_mul_f32 v165, v165, v37
    v_mul_f32 v166, v166, v38
    v_mul_f32 v167, v167, v39
    v_mfma_f32_16x16x32_bf16 v[56:59], a[136:139], a[64:67], v[56:59]
    ds_read_b64_tr_b16 a[24:25], v6 offset:0
    v_cvt_pk_bf16_f32 v40, v160, v161
    v_cvt_pk_bf16_f32 v41, v162, v163
    s_movk_i32 s51, 0x1000
    v_cvt_pk_bf16_f32 v42, v164, v165
    v_cvt_pk_bf16_f32 v43, v166, v167
    v_mfma_f32_16x16x32_bf16 v[56:59], a[140:143], a[68:71], v[56:59]
    ds_read_b64_tr_b16 a[26:27], v6 offset:512
    buffer_store_dwordx4 v[40:43], v12, s[28:31], s51 offen offset:3072 sc1
    v_mfma_f32_16x16x32_bf16 v[60:63], a[132:135], a[68:71], v[60:63]
    v_mfma_f32_16x16x32_bf16 v[60:63], a[120:123], a[64:67], v[60:63]
    v_mul_f32 v120, s58, v120
    v_mul_f32 v121, s58, v121
    v_mul_f32 v122, s58, v122
    v_mul_f32 v123, s58, v123
    v_mfma_f32_16x16x32_bf16 v[184:187], a[0:3], a[64:67], v[184:187]
    v_mul_f32 v124, s58, v124
    v_mul_f32 v125, s58, v125
    v_mul_f32 v126, s58, v126
    v_mul_f32 v127, s58, v127
    v_mfma_f32_16x16x32_bf16 v[184:187], a[8:11], a[68:71], v[184:187]
    v_exp_f32 v120, v120
    v_exp_f32 v121, v121
    v_exp_f32 v122, v122
    v_mfma_f32_16x16x32_bf16 v[188:191], a[20:23], a[68:71], v[188:191]
    v_exp_f32 v123, v123
    v_exp_f32 v124, v124
    v_mfma_f32_16x16x32_bf16 v[188:191], a[16:19], a[64:67], v[188:191]
    v_exp_f32 v125, v125
    v_exp_f32 v126, v126
    v_mfma_f32_16x16x32_bf16 v[204:207], a[16:19], a[124:127], v[204:207]
    v_exp_f32 v127, v127
    v_add_f32 v120, 1.0, v120
    v_add_f32 v121, 1.0, v121
    v_mfma_f32_16x16x32_bf16 v[204:207], a[20:23], a[128:131], v[204:207]
    v_add_f32 v122, 1.0, v122
    v_add_f32 v123, 1.0, v123
    v_add_f32 v124, 1.0, v124
    v_add_f32 v125, 1.0, v125
    v_add_f32 v126, 1.0, v126
    v_mfma_f32_16x16x32_bf16 v[200:203], a[8:11], a[128:131], v[200:203]
    v_add_f32 v127, 1.0, v127
    v_rcp_f32 v120, v120
    v_mfma_f32_16x16x32_bf16 v[200:203], a[0:3], a[124:127], v[200:203]
    v_rcp_f32 v121, v121
    v_rcp_f32 v122, v122
    v_rcp_f32 v123, v123
    v_mfma_f32_16x16x32_bf16 v[76:79], a[120:123], a[124:127], v[76:79]
    v_rcp_f32 v124, v124
    v_rcp_f32 v125, v125
    v_mfma_f32_16x16x32_bf16 v[76:79], a[132:135], a[128:131], v[76:79]
    v_rcp_f32 v126, v126
    v_rcp_f32 v127, v127
    v_mfma_f32_16x16x32_bf16 v[72:75], a[140:143], a[128:131], v[72:75]
    v_mul_f32 v120, v120, v248
    v_mul_f32 v121, v121, v249
    v_mul_f32 v122, v122, v250
    v_mul_f32 v123, v123, v251
    v_mfma_f32_16x16x32_bf16 v[72:75], a[136:139], a[124:127], v[72:75]
    v_mul_f32 v124, v124, v252
    v_mul_f32 v125, v125, v253
    v_mul_f32 v126, v126, v254
    v_mul_f32 v127, v127, v255
    v_cvt_pk_bf16_f32 v24, v120, v121
    v_mfma_f32_16x16x32_bf16 v[88:91], a[136:139], a[48:51], v[88:91]
    v_cvt_pk_bf16_f32 v25, v122, v123
    s_movk_i32 s51, 0x3000
    v_cvt_pk_bf16_f32 v26, v124, v125
    v_cvt_pk_bf16_f32 v27, v126, v127
    v_mfma_f32_16x16x32_bf16 v[88:91], a[140:143], a[52:55], v[88:91]
    buffer_store_dwordx4 v[24:27], v12, s[28:31], s51 offen offset:0 sc1
    v_mul_f32 v136, s58, v136
    v_mul_f32 v137, s58, v137
    v_mul_f32 v138, s58, v138
    v_mfma_f32_16x16x32_bf16 v[92:95], a[132:135], a[52:55], v[92:95]
    v_mul_f32 v139, s58, v139
    v_mul_f32 v140, s58, v140
    v_mul_f32 v141, s58, v141
    v_mul_f32 v142, s58, v142
    v_mul_f32 v143, s58, v143
    v_mfma_f32_16x16x32_bf16 v[92:95], a[120:123], a[48:51], v[92:95]
    v_exp_f32 v136, v136
    v_exp_f32 v137, v137
    v_mfma_f32_16x16x32_bf16 v[216:219], a[0:3], a[48:51], v[216:219]
    v_exp_f32 v138, v138
    v_exp_f32 v139, v139
    v_mfma_f32_16x16x32_bf16 v[216:219], a[8:11], a[52:55], v[216:219]
    v_exp_f32 v140, v140
    v_exp_f32 v141, v141
    v_mfma_f32_16x16x32_bf16 v[220:223], a[20:23], a[52:55], v[220:223]
    v_exp_f32 v142, v142
    v_exp_f32 v143, v143
    v_accvgpr_read_b32 v32, a152
    v_mfma_f32_16x16x32_bf16 v[220:223], a[16:19], a[48:51], v[220:223]
    s_waitcnt lgkmcnt(15)
    v_accvgpr_read_b32 v33, a153
    v_accvgpr_read_b32 v34, a154
    v_accvgpr_read_b32 v35, a155
    v_accvgpr_read_b32 v36, a156
    v_accvgpr_read_b32 v37, a157
    v_mfma_f32_16x16x32_bf16 v[236:239], a[16:19], a[100:103], v[236:239]
    ds_read_b64_tr_b16 a[16:17], v5 offset:32768
    v_accvgpr_read_b32 v38, a158
    v_accvgpr_read_b32 v39, a159
    v_add_f32 v136, 1.0, v136
    v_add_f32 v137, 1.0, v137
    v_mfma_f32_16x16x32_bf16 v[236:239], a[20:23], a[96:99], v[236:239]
    ds_read_b64_tr_b16 a[18:19], v5 offset:33280
    v_add_f32 v138, 1.0, v138
    v_add_f32 v139, 1.0, v139
    v_add_f32 v140, 1.0, v140
    v_add_f32 v141, 1.0, v141
    v_mfma_f32_16x16x32_bf16 v[232:235], a[8:11], a[96:99], v[232:235]
    ds_read_b64_tr_b16 a[20:21], v5 offset:36864
    v_add_f32 v142, 1.0, v142
    v_add_f32 v143, 1.0, v143
    v_rcp_f32 v136, v136
    v_mfma_f32_16x16x32_bf16 v[232:235], a[0:3], a[100:103], v[232:235]
    ds_read_b64_tr_b16 a[22:23], v5 offset:37376
    v_rcp_f32 v137, v137
    v_rcp_f32 v138, v138
    v_rcp_f32 v139, v139
    v_mfma_f32_16x16x32_bf16 v[108:111], a[120:123], a[100:103], v[108:111]
    ds_read_b64_tr_b16 a[8:9], v6 offset:36864
    v_rcp_f32 v140, v140
    v_rcp_f32 v141, v141
    v_mfma_f32_16x16x32_bf16 v[108:111], a[132:135], a[96:99], v[108:111]
    ds_read_b64_tr_b16 a[10:11], v6 offset:37376
    v_rcp_f32 v142, v142
    v_rcp_f32 v143, v143
    v_mfma_f32_16x16x32_bf16 v[104:107], a[140:143], a[96:99], v[104:107]
    ds_read_b64_tr_b16 a[0:1], v6 offset:32768
    v_mul_f32 v136, v136, v32
    v_mul_f32 v137, v137, v33
    v_mul_f32 v138, v138, v34
    v_mul_f32 v139, v139, v35
    v_mfma_f32_16x16x32_bf16 v[104:107], a[136:139], a[100:103], v[104:107]
    s_waitcnt lgkmcnt(15)
    ds_read_b64_tr_b16 a[2:3], v6 offset:33280
    v_mul_f32 v140, v140, v36
    v_mul_f32 v141, v141, v37
    v_mul_f32 v142, v142, v38
    v_mul_f32 v143, v143, v39
    v_cvt_pk_bf16_f32 v40, v136, v137
    v_mfma_f32_16x16x32_bf16 v[56:59], a[44:47], a[104:107], v[56:59]
    ds_read_b64_tr_b16 a[120:121], v5 offset:8192
    v_cvt_pk_bf16_f32 v41, v138, v139
    s_movk_i32 s51, 0x3000
    v_cvt_pk_bf16_f32 v42, v140, v141
    v_cvt_pk_bf16_f32 v43, v142, v143
    v_mfma_f32_16x16x32_bf16 v[56:59], a[40:43], a[108:111], v[56:59]
    ds_read_b64_tr_b16 a[122:123], v5 offset:8704
    buffer_store_dwordx4 v[40:43], v12, s[28:31], s51 offen offset:1024 sc1
    v_mul_f32 v152, s58, v152
    v_mul_f32 v153, s58, v153
    v_mul_f32 v154, s58, v154
    v_mfma_f32_16x16x32_bf16 v[60:63], a[36:39], a[108:111], v[60:63]
    ds_read_b64_tr_b16 a[132:133], v5 offset:12288
    v_mul_f32 v155, s58, v155
    v_mul_f32 v156, s58, v156
    v_mul_f32 v157, s58, v157
    v_mul_f32 v158, s58, v158
    v_mul_f32 v159, s58, v159
    v_mfma_f32_16x16x32_bf16 v[60:63], a[32:35], a[104:107], v[60:63]
    ds_read_b64_tr_b16 a[134:135], v5 offset:12800
    v_exp_f32 v152, v152
    v_exp_f32 v153, v153
    v_mfma_f32_16x16x32_bf16 v[184:187], a[80:83], a[104:107], v[184:187]
    ds_read_b64_tr_b16 a[140:141], v6 offset:12288
    v_exp_f32 v154, v154
    v_exp_f32 v155, v155
    v_mfma_f32_16x16x32_bf16 v[184:187], a[84:87], a[108:111], v[184:187]
    ds_read_b64_tr_b16 a[142:143], v6 offset:12800
    v_exp_f32 v156, v156
    v_exp_f32 v157, v157
    v_mfma_f32_16x16x32_bf16 v[188:191], a[76:79], a[108:111], v[188:191]
    ds_read_b64_tr_b16 a[136:137], v6 offset:8192
    v_exp_f32 v158, v158
    v_exp_f32 v159, v159
    v_accvgpr_read_b32 v16, a168
    v_mfma_f32_16x16x32_bf16 v[188:191], a[72:75], a[104:107], v[188:191]
    ds_read_b64_tr_b16 a[138:139], v6 offset:8704
    v_accvgpr_read_b32 v17, a169
    v_accvgpr_read_b32 v18, a170
    v_accvgpr_read_b32 v19, a171
    v_accvgpr_read_b32 v20, a172
    v_mfma_f32_16x16x32_bf16 v[204:207], a[72:75], a[116:119], v[204:207]
    v_accvgpr_read_b32 v21, a173
    v_accvgpr_read_b32 v22, a174
    v_accvgpr_read_b32 v23, a175
    v_add_f32 v152, 1.0, v152
    v_add_f32 v153, 1.0, v153
    v_mfma_f32_16x16x32_bf16 v[204:207], a[76:79], a[112:115], v[204:207]
    v_add_f32 v154, 1.0, v154
    v_add_f32 v155, 1.0, v155
    v_add_f32 v156, 1.0, v156
    v_add_f32 v157, 1.0, v157
    v_mfma_f32_16x16x32_bf16 v[200:203], a[84:87], a[112:115], v[200:203]
    v_add_f32 v158, 1.0, v158
    v_add_f32 v159, 1.0, v159
    v_rcp_f32 v152, v152
    v_mfma_f32_16x16x32_bf16 v[200:203], a[80:83], a[116:119], v[200:203]
    v_rcp_f32 v153, v153
    v_rcp_f32 v154, v154
    v_mfma_f32_16x16x32_bf16 v[76:79], a[32:35], a[116:119], v[76:79]
    v_rcp_f32 v155, v155
    v_rcp_f32 v156, v156
    v_rcp_f32 v157, v157
    v_mfma_f32_16x16x32_bf16 v[76:79], a[36:39], a[112:115], v[76:79]
    v_rcp_f32 v158, v158
    v_rcp_f32 v159, v159
    v_mfma_f32_16x16x32_bf16 v[72:75], a[40:43], a[112:115], v[72:75]
    v_mul_f32 v152, v152, v16
    v_mul_f32 v153, v153, v17
    v_mul_f32 v154, v154, v18
    v_mul_f32 v155, v155, v19
    v_mfma_f32_16x16x32_bf16 v[72:75], a[44:47], a[116:119], v[72:75]
    v_mul_f32 v156, v156, v20
    v_mul_f32 v157, v157, v21
    v_mul_f32 v158, v158, v22
    v_mul_f32 v159, v159, v23
    v_mfma_f32_16x16x32_bf16 v[88:91], a[44:47], a[92:95], v[88:91]
    v_cvt_pk_bf16_f32 v24, v152, v153
    v_cvt_pk_bf16_f32 v25, v154, v155
    s_movk_i32 s51, 0x3000
    v_cvt_pk_bf16_f32 v26, v156, v157
    v_cvt_pk_bf16_f32 v27, v158, v159
    v_mfma_f32_16x16x32_bf16 v[88:91], a[40:43], a[60:63], v[88:91]
    buffer_store_dwordx4 v[24:27], v12, s[28:31], s51 offen offset:2048 sc1
    v_mul_f32 v168, s58, v168
    v_mul_f32 v169, s58, v169
    v_mul_f32 v170, s58, v170
    v_mfma_f32_16x16x32_bf16 v[92:95], a[36:39], a[60:63], v[92:95]
    v_mul_f32 v171, s58, v171
    v_mul_f32 v172, s58, v172
    v_mul_f32 v173, s58, v173
    v_mul_f32 v174, s58, v174
    v_mfma_f32_16x16x32_bf16 v[92:95], a[32:35], a[92:95], v[92:95]
    v_mul_f32 v175, s58, v175
    v_exp_f32 v168, v168
    v_exp_f32 v169, v169
    v_mfma_f32_16x16x32_bf16 v[216:219], a[80:83], a[92:95], v[216:219]
    v_exp_f32 v170, v170
    v_exp_f32 v171, v171
    v_mfma_f32_16x16x32_bf16 v[216:219], a[84:87], a[60:63], v[216:219]
    v_exp_f32 v172, v172
    v_exp_f32 v173, v173
    v_mfma_f32_16x16x32_bf16 v[220:223], a[76:79], a[60:63], v[220:223]
    v_exp_f32 v174, v174
    v_exp_f32 v175, v175
    v_accvgpr_read_b32 v32, a184
    v_mfma_f32_16x16x32_bf16 v[220:223], a[72:75], a[92:95], v[220:223]
    v_accvgpr_read_b32 v33, a185
    v_accvgpr_read_b32 v34, a186
    v_accvgpr_read_b32 v35, a187
    v_accvgpr_read_b32 v36, a188
    v_mfma_f32_16x16x32_bf16 v[236:239], a[72:75], a[88:91], v[236:239]
    ds_read_b64_tr_b16 a[72:73], v5 offset:40960
    v_accvgpr_read_b32 v37, a189
    v_accvgpr_read_b32 v38, a190
    v_accvgpr_read_b32 v39, a191
    v_add_f32 v168, 1.0, v168
    v_add_f32 v169, 1.0, v169
    v_mfma_f32_16x16x32_bf16 v[236:239], a[76:79], a[56:59], v[236:239]
    ds_read_b64_tr_b16 a[74:75], v5 offset:41472
    v_add_f32 v170, 1.0, v170
    v_add_f32 v171, 1.0, v171
    v_add_f32 v172, 1.0, v172
    v_add_f32 v173, 1.0, v173
    v_mfma_f32_16x16x32_bf16 v[232:235], a[84:87], a[56:59], v[232:235]
    ds_read_b64_tr_b16 a[76:77], v5 offset:45056
    v_add_f32 v174, 1.0, v174
    v_add_f32 v175, 1.0, v175
    v_rcp_f32 v168, v168
    v_mfma_f32_16x16x32_bf16 v[232:235], a[80:83], a[88:91], v[232:235]
    ds_read_b64_tr_b16 a[78:79], v5 offset:45568
    v_rcp_f32 v169, v169
    v_rcp_f32 v170, v170
    v_mfma_f32_16x16x32_bf16 v[108:111], a[32:35], a[88:91], v[108:111]
    ds_read_b64_tr_b16 a[84:85], v6 offset:45056
    v_rcp_f32 v171, v171
    v_rcp_f32 v172, v172
    v_rcp_f32 v173, v173
    v_mfma_f32_16x16x32_bf16 v[108:111], a[36:39], a[56:59], v[108:111]
    ds_read_b64_tr_b16 a[86:87], v6 offset:45568
    v_rcp_f32 v174, v174
    v_rcp_f32 v175, v175
    v_mfma_f32_16x16x32_bf16 v[104:107], a[40:43], a[56:59], v[104:107]
    ds_read_b64_tr_b16 a[80:81], v6 offset:40960
    v_mul_f32 v168, v168, v32
    v_mul_f32 v169, v169, v33
    v_mul_f32 v170, v170, v34
    v_mul_f32 v171, v171, v35
    v_mfma_f32_16x16x32_bf16 v[104:107], a[44:47], a[88:91], v[104:107]
    s_waitcnt lgkmcnt(15)
    ds_read_b64_tr_b16 a[82:83], v6 offset:41472
    v_mul_f32 v172, v172, v36
    v_mul_f32 v173, v173, v37
    v_mul_f32 v174, v174, v38
    v_mul_f32 v175, v175, v39
    v_mfma_f32_16x16x32_bf16 v[48:51], a[4:7], a[64:67], v[48:51]
    v_cvt_pk_bf16_f32 v40, v168, v169
    v_cvt_pk_bf16_f32 v41, v170, v171
    s_movk_i32 s51, 0x3000
    v_cvt_pk_bf16_f32 v42, v172, v173
    v_cvt_pk_bf16_f32 v43, v174, v175
    v_mfma_f32_16x16x32_bf16 v[48:51], a[12:15], a[68:71], v[48:51]
    buffer_store_dwordx4 v[40:43], v12, s[28:31], s51 offen offset:3072 sc1
    v_mfma_f32_16x16x32_bf16 v[52:55], a[28:31], a[68:71], v[52:55]
    v_mfma_f32_16x16x32_bf16 v[52:55], a[24:27], a[64:67], v[52:55]
    v_mul_f32 v56, s58, v56
    v_mul_f32 v57, s58, v57
    v_mul_f32 v58, s58, v58
    v_mul_f32 v59, s58, v59
    v_mfma_f32_16x16x32_bf16 v[176:179], a[16:19], a[64:67], v[176:179]
    v_mul_f32 v60, s58, v60
    v_mul_f32 v61, s58, v61
    v_mul_f32 v62, s58, v62
    v_mul_f32 v63, s58, v63
    v_mfma_f32_16x16x32_bf16 v[176:179], a[20:23], a[68:71], v[176:179]
    v_exp_f32 v56, v56
    v_exp_f32 v57, v57
    v_exp_f32 v58, v58
    v_mfma_f32_16x16x32_bf16 v[180:183], a[8:11], a[68:71], v[180:183]
    v_exp_f32 v59, v59
    v_exp_f32 v60, v60
    v_mfma_f32_16x16x32_bf16 v[180:183], a[0:3], a[64:67], v[180:183]
    v_exp_f32 v61, v61
    v_exp_f32 v62, v62
    v_mfma_f32_16x16x32_bf16 v[196:199], a[0:3], a[124:127], v[196:199]
    v_exp_f32 v63, v63
    v_add_f32 v56, 1.0, v56
    v_add_f32 v57, 1.0, v57
    v_mfma_f32_16x16x32_bf16 v[196:199], a[8:11], a[128:131], v[196:199]
    v_add_f32 v58, 1.0, v58
    v_add_f32 v59, 1.0, v59
    v_add_f32 v60, 1.0, v60
    v_add_f32 v61, 1.0, v61
    v_add_f32 v62, 1.0, v62
    v_mfma_f32_16x16x32_bf16 v[192:195], a[20:23], a[128:131], v[192:195]
    v_add_f32 v63, 1.0, v63
    v_rcp_f32 v56, v56
    v_mfma_f32_16x16x32_bf16 v[192:195], a[16:19], a[124:127], v[192:195]
    v_rcp_f32 v57, v57
    v_rcp_f32 v58, v58
    v_rcp_f32 v59, v59
    v_mfma_f32_16x16x32_bf16 v[68:71], a[24:27], a[124:127], v[68:71]
    v_rcp_f32 v60, v60
    v_rcp_f32 v61, v61
    v_mfma_f32_16x16x32_bf16 v[68:71], a[28:31], a[128:131], v[68:71]
    v_rcp_f32 v62, v62
    v_rcp_f32 v63, v63
    v_mfma_f32_16x16x32_bf16 v[64:67], a[12:15], a[128:131], v[64:67]
    buffer_load_dword v47, v15, s[76:79], 0 offen sc1
    v_mul_f32 v56, v56, v184
    v_mul_f32 v57, v57, v185
    v_mul_f32 v58, v58, v186
    v_mul_f32 v59, v59, v187
    v_mfma_f32_16x16x32_bf16 v[64:67], a[4:7], a[124:127], v[64:67]
    v_mul_f32 v60, v60, v188
    v_mul_f32 v61, v61, v189
    v_mul_f32 v62, v62, v190
    v_mul_f32 v63, v63, v191
    v_cvt_pk_bf16_f32 v24, v56, v57
    v_mfma_f32_16x16x32_bf16 v[80:83], a[4:7], a[48:51], v[80:83]
    v_cvt_pk_bf16_f32 v25, v58, v59
    s_movk_i32 s51, 0x2000
    v_cvt_pk_bf16_f32 v26, v60, v61
    v_cvt_pk_bf16_f32 v27, v62, v63
    v_mfma_f32_16x16x32_bf16 v[80:83], a[12:15], a[52:55], v[80:83]
    buffer_store_dwordx4 v[24:27], v12, s[28:31], s51 offen offset:0 sc1
    v_mul_f32 v72, s58, v72
    v_mul_f32 v73, s58, v73
    v_mul_f32 v74, s58, v74
    v_mfma_f32_16x16x32_bf16 v[84:87], a[28:31], a[52:55], v[84:87]
    v_mul_f32 v75, s58, v75
    v_mul_f32 v76, s58, v76
    v_mul_f32 v77, s58, v77
    v_mul_f32 v78, s58, v78
    v_mul_f32 v79, s58, v79
    v_mfma_f32_16x16x32_bf16 v[84:87], a[24:27], a[48:51], v[84:87]
    v_exp_f32 v72, v72
    v_exp_f32 v73, v73
    v_mfma_f32_16x16x32_bf16 v[208:211], a[16:19], a[48:51], v[208:211]
    v_exp_f32 v74, v74
    v_exp_f32 v75, v75
    v_mfma_f32_16x16x32_bf16 v[208:211], a[20:23], a[52:55], v[208:211]
    v_exp_f32 v76, v76
    v_exp_f32 v77, v77
    v_mfma_f32_16x16x32_bf16 v[212:215], a[8:11], a[52:55], v[212:215]
    v_exp_f32 v78, v78
    v_exp_f32 v79, v79
    v_add_f32 v72, 1.0, v72
    v_mfma_f32_16x16x32_bf16 v[212:215], a[0:3], a[48:51], v[212:215]
    v_add_f32 v73, 1.0, v73
    v_add_f32 v74, 1.0, v74
    v_add_f32 v75, 1.0, v75
    v_add_f32 v76, 1.0, v76
    v_add_f32 v77, 1.0, v77
    v_mfma_f32_16x16x32_bf16 v[228:231], a[0:3], a[100:103], v[228:231]
    v_add_f32 v78, 1.0, v78
    v_add_f32 v79, 1.0, v79
    v_rcp_f32 v72, v72
    v_mfma_f32_16x16x32_bf16 v[228:231], a[8:11], a[96:99], v[228:231]
    v_rcp_f32 v73, v73
    v_rcp_f32 v74, v74
    v_mfma_f32_16x16x32_bf16 v[224:227], a[20:23], a[96:99], v[224:227]
    v_rcp_f32 v75, v75
    v_rcp_f32 v76, v76
    v_mfma_f32_16x16x32_bf16 v[224:227], a[16:19], a[100:103], v[224:227]
    v_rcp_f32 v77, v77
    v_rcp_f32 v78, v78
    v_rcp_f32 v79, v79
    v_mfma_f32_16x16x32_bf16 v[100:103], a[24:27], a[100:103], v[100:103]
    v_mul_f32 v72, v72, v200
    v_mul_f32 v73, v73, v201
    v_mul_f32 v74, v74, v202
    v_mfma_f32_16x16x32_bf16 v[100:103], a[28:31], a[96:99], v[100:103]
    v_mul_f32 v75, v75, v203
    v_mul_f32 v76, v76, v204
    v_mul_f32 v77, v77, v205
    v_mul_f32 v78, v78, v206
    v_mul_f32 v79, v79, v207
    v_mfma_f32_16x16x32_bf16 v[96:99], a[12:15], a[96:99], v[96:99]
    v_cvt_pk_bf16_f32 v40, v72, v73
    v_cvt_pk_bf16_f32 v41, v74, v75
    s_movk_i32 s51, 0x2000
    v_cvt_pk_bf16_f32 v42, v76, v77
    v_mfma_f32_16x16x32_bf16 v[96:99], a[4:7], a[100:103], v[96:99]
    s_waitcnt lgkmcnt(12)
    v_cvt_pk_bf16_f32 v43, v78, v79
    buffer_store_dwordx4 v[40:43], v12, s[28:31], s51 offen offset:1024 sc1
    v_mul_f32 v88, s58, v88
    v_mul_f32 v89, s58, v89
    v_mul_f32 v90, s58, v90
    v_mfma_f32_16x16x32_bf16 v[48:51], a[120:123], a[104:107], v[48:51]
    v_mul_f32 v91, s58, v91
    v_mul_f32 v92, s58, v92
    v_mul_f32 v93, s58, v93
    v_mul_f32 v94, s58, v94
    v_mfma_f32_16x16x32_bf16 v[48:51], a[132:135], a[108:111], v[48:51]
    s_waitcnt lgkmcnt(8)
    v_mul_f32 v95, s58, v95
    v_exp_f32 v88, v88
    v_exp_f32 v89, v89
    v_mfma_f32_16x16x32_bf16 v[52:55], a[140:143], a[108:111], v[52:55]
    v_exp_f32 v90, v90
    v_exp_f32 v91, v91
    v_mfma_f32_16x16x32_bf16 v[52:55], a[136:139], a[104:107], v[52:55]
    s_waitcnt lgkmcnt(4)
    v_exp_f32 v92, v92
    v_exp_f32 v93, v93
    v_mfma_f32_16x16x32_bf16 v[176:179], a[72:75], a[104:107], v[176:179]
    v_exp_f32 v94, v94
    v_exp_f32 v95, v95
    v_mfma_f32_16x16x32_bf16 v[176:179], a[76:79], a[108:111], v[176:179]
    s_waitcnt lgkmcnt(0)
    v_add_f32 v88, 1.0, v88
    v_add_f32 v89, 1.0, v89
    v_add_f32 v90, 1.0, v90
    v_add_f32 v91, 1.0, v91
    v_add_f32 v92, 1.0, v92
    v_mfma_f32_16x16x32_bf16 v[180:183], a[84:87], a[108:111], v[180:183]
    v_add_f32 v93, 1.0, v93
    v_add_f32 v94, 1.0, v94
    v_add_f32 v95, 1.0, v95
    v_rcp_f32 v88, v88
    v_mfma_f32_16x16x32_bf16 v[180:183], a[80:83], a[104:107], v[180:183]
    v_rcp_f32 v89, v89
    v_rcp_f32 v90, v90
    v_mfma_f32_16x16x32_bf16 v[196:199], a[80:83], a[116:119], v[196:199]
    v_rcp_f32 v91, v91
    v_rcp_f32 v92, v92
    v_mfma_f32_16x16x32_bf16 v[196:199], a[84:87], a[112:115], v[196:199]
    v_rcp_f32 v93, v93
    v_rcp_f32 v94, v94
    v_mfma_f32_16x16x32_bf16 v[192:195], a[76:79], a[112:115], v[192:195]
    v_rcp_f32 v95, v95
    v_mul_f32 v88, v88, v216
    v_mul_f32 v89, v89, v217
    v_mul_f32 v90, v90, v218
    v_mfma_f32_16x16x32_bf16 v[192:195], a[72:75], a[116:119], v[192:195]
    v_mul_f32 v91, v91, v219
    v_mul_f32 v92, v92, v220
    v_mul_f32 v93, v93, v221
    v_mul_f32 v94, v94, v222
    v_mfma_f32_16x16x32_bf16 v[68:71], a[136:139], a[116:119], v[68:71]
    v_mul_f32 v95, v95, v223
    v_cvt_pk_bf16_f32 v24, v88, v89
    v_cvt_pk_bf16_f32 v25, v90, v91
    s_movk_i32 s51, 0x2000
    v_mfma_f32_16x16x32_bf16 v[68:71], a[140:143], a[112:115], v[68:71]
    v_cvt_pk_bf16_f32 v26, v92, v93
    v_cvt_pk_bf16_f32 v27, v94, v95
    buffer_store_dwordx4 v[24:27], v12, s[28:31], s51 offen offset:2048 sc1
    v_mul_f32 v104, s58, v104
    v_mul_f32 v105, s58, v105
    v_mfma_f32_16x16x32_bf16 v[64:67], a[132:135], a[112:115], v[64:67]
    v_mul_f32 v106, s58, v106
    v_mul_f32 v107, s58, v107
    v_mul_f32 v108, s58, v108
    v_mul_f32 v109, s58, v109
    v_mfma_f32_16x16x32_bf16 v[64:67], a[120:123], a[116:119], v[64:67]
L_pw4:
    s_cbranch_execz L_pw7
    v_mul_f32 v110, s58, v110
    v_mul_f32 v111, s58, v111
    v_exp_f32 v104, v104
    v_mfma_f32_16x16x32_bf16 v[80:83], a[120:123], a[92:95], v[80:83]
    v_exp_f32 v105, v105
    v_exp_f32 v106, v106
    v_mfma_f32_16x16x32_bf16 v[80:83], a[132:135], a[60:63], v[80:83]
    v_exp_f32 v107, v107
    v_exp_f32 v108, v108
    v_exp_f32 v109, v109
    v_mfma_f32_16x16x32_bf16 v[84:87], a[140:143], a[60:63], v[84:87]
    v_exp_f32 v110, v110
    v_exp_f32 v111, v111
    v_mfma_f32_16x16x32_bf16 v[84:87], a[136:139], a[92:95], v[84:87]
    v_add_f32 v104, 1.0, v104
    v_add_f32 v105, 1.0, v105
    v_add_f32 v106, 1.0, v106
    v_add_f32 v107, 1.0, v107
    v_mfma_f32_16x16x32_bf16 v[208:211], a[72:75], a[92:95], v[208:211]
    v_add_f32 v108, 1.0, v108
    v_add_f32 v109, 1.0, v109
    v_add_f32 v110, 1.0, v110
    v_add_f32 v111, 1.0, v111
    v_mfma_f32_16x16x32_bf16 v[208:211], a[76:79], a[60:63], v[208:211]
    v_rcp_f32 v104, v104
    v_rcp_f32 v105, v105
    v_mfma_f32_16x16x32_bf16 v[212:215], a[84:87], a[60:63], v[212:215]
    v_rcp_f32 v106, v106
    v_rcp_f32 v107, v107
    v_mfma_f32_16x16x32_bf16 v[212:215], a[80:83], a[92:95], v[212:215]
    v_rcp_f32 v108, v108
    v_rcp_f32 v109, v109
    v_rcp_f32 v110, v110
    v_mfma_f32_16x16x32_bf16 v[228:231], a[80:83], a[88:91], v[228:231]
    v_rcp_f32 v111, v111
    v_mul_f32 v104, v104, v232
    v_mul_f32 v105, v105, v233
    v_mfma_f32_16x16x32_bf16 v[228:231], a[84:87], a[56:59], v[228:231]
    v_mul_f32 v106, v106, v234
    v_mul_f32 v107, v107, v235
    v_mul_f32 v108, v108, v236
    v_mul_f32 v109, v109, v237
    v_mfma_f32_16x16x32_bf16 v[224:227], a[76:79], a[56:59], v[224:227]
    v_mul_f32 v110, v110, v238
    v_mul_f32 v111, v111, v239
    v_cvt_pk_bf16_f32 v40, v104, v105
    v_cvt_pk_bf16_f32 v41, v106, v107
    v_mfma_f32_16x16x32_bf16 v[224:227], a[72:75], a[88:91], v[224:227]
    s_movk_i32 s51, 0x2000
    v_cvt_pk_bf16_f32 v42, v108, v109
    v_cvt_pk_bf16_f32 v43, v110, v111
    buffer_store_dwordx4 v[40:43], v12, s[28:31], s51 offen offset:3072 sc1
    v_mfma_f32_16x16x32_bf16 v[100:103], a[136:139], a[88:91], v[100:103]
    v_mfma_f32_16x16x32_bf16 v[100:103], a[140:143], a[56:59], v[100:103]
    v_mfma_f32_16x16x32_bf16 v[96:99], a[132:135], a[56:59], v[96:99]
    v_mfma_f32_16x16x32_bf16 v[96:99], a[120:123], a[88:91], v[96:99]
    v_lshlrev_b32 v1, 4, v0
    v_lshrrev_b32 v6, 3, v0
    v_lshrrev_b32 v7, 4, v0
    v_and_b32 v8, 7, v0
    v_lshlrev_b32 v9, 1, v7
    v_xor_b32 v8, v8, v9
    v_lshlrev_b32 v8, 4, v8
    v_lshl_add_u32 v116, v6, 11, v8
    v_add_u32 v117, 0x3c00, v116
    v_add_u32 v118, 0x7800, v116
    v_add_u32 v119, 0xb400, v116
    s_mov_b32 s72, 0
    s_barrier
    s_waitcnt vmcnt(4)
    v_readlane_b32 s72, v47, 16
    s_nop 1
    s_cmp_lt_u32 s72, 2
    s_cbranch_scc1 L_noq_f
    buffer_load_dwordx4 a[240:243], v1, s[16:19], 0 offen offset:0 sc1
    buffer_load_dwordx4 a[244:247], v1, s[16:19], 0 offen offset:1024 sc1
    buffer_load_dwordx4 a[248:251], v1, s[16:19], 0 offen offset:2048 sc1
    buffer_load_dwordx4 a[252:255], v1, s[16:19], 0 offen offset:3072 sc1
L_noq_f:
    v_pk_mul_f32 v[48:49], v[48:49], s[58:59]
    v_pk_mul_f32 v[50:51], v[50:51], s[58:59]
    v_pk_mul_f32 v[52:53], v[52:53], s[58:59]
    v_pk_mul_f32 v[54:55], v[54:55], s[58:59]
    v_exp_f32 v48, v48
    v_exp_f32 v49, v49
    v_exp_f32 v50, v50
    v_exp_f32 v51, v51
    v_exp_f32 v52, v52
    v_exp_f32 v53, v53
    v_exp_f32 v54, v54
    v_exp_f32 v55, v55
    v_pk_add_f32 v[48:49], v[48:49], 1.0 op_sel_hi:[1,0]
    v_pk_add_f32 v[50:51], v[50:51], 1.0 op_sel_hi:[1,0]
    v_pk_add_f32 v[52:53], v[52:53], 1.0 op_sel_hi:[1,0]
    v_pk_add_f32 v[54:55], v[54:55], 1.0 op_sel_hi:[1,0]
    v_rcp_f32 v48, v48
    v_rcp_f32 v49, v49
    v_rcp_f32 v50, v50
    v_rcp_f32 v51, v51
    v_rcp_f32 v52, v52
    v_rcp_f32 v53, v53
    v_rcp_f32 v54, v54
    v_rcp_f32 v55, v55
    v_pk_mul_f32 v[48:49], v[48:49], v[176:177]
    v_pk_mul_f32 v[50:51], v[50:51], v[178:179]
    v_pk_mul_f32 v[52:53], v[52:53], v[180:181]
    v_pk_mul_f32 v[54:55], v[54:55], v[182:183]
    v_cvt_pk_bf16_f32 v24, v48, v49
    v_cvt_pk_bf16_f32 v25, v50, v51
    s_movk_i32 s51, 0x0
    v_cvt_pk_bf16_f32 v26, v52, v53
    v_cvt_pk_bf16_f32 v27, v54, v55
    buffer_store_dwordx4 v[24:27], v12, s[28:31], s51 offen offset:0 sc1
    v_pk_mul_f32 v[64:65], v[64:65], s[58:59]
    v_pk_mul_f32 v[66:67], v[66:67], s[58:59]
    v_pk_mul_f32 v[68:69], v[68:69], s[58:59]
    v_pk_mul_f32 v[70:71], v[70:71], s[58:59]
    v_exp_f32 v64, v64
    v_exp_f32 v65, v65
    v_exp_f32 v66, v66
    v_exp_f32 v67, v67
    v_exp_f32 v68, v68
    v_exp_f32 v69, v69
    v_exp_f32 v70, v70
    v_exp_f32 v71, v71
    v_pk_add_f32 v[64:65], v[64:65], 1.0 op_sel_hi:[1,0]
    v_pk_add_f32 v[66:67], v[66:67], 1.0 op_sel_hi:[1,0]
    v_pk_add_f32 v[68:69], v[68:69], 1.0 op_sel_hi:[1,0]
    v_pk_add_f32 v[70:71], v[70:71], 1.0 op_sel_hi:[1,0]
    v_rcp_f32 v64, v64
    v_rcp_f32 v65, v65
    v_rcp_f32 v66, v66
    v_rcp_f32 v67, v67
    v_rcp_f32 v68, v68
    v_rcp_f32 v69, v69
    v_rcp_f32 v70, v70
    v_rcp_f32 v71, v71
    v_pk_mul_f32 v[64:65], v[64:65], v[192:193]
    v_pk_mul_f32 v[66:67], v[66:67], v[194:195]
    v_pk_mul_f32 v[68:69], v[68:69], v[196:197]
    v_pk_mul_f32 v[70:71], v[70:71], v[198:199]
    v_cvt_pk_bf16_f32 v40, v64, v65
    v_cvt_pk_bf16_f32 v41, v66, v67
    s_movk_i32 s51, 0x0
    v_cvt_pk_bf16_f32 v42, v68, v69
    v_cvt_pk_bf16_f32 v43, v70, v71
    buffer_store_dwordx4 v[40:43], v12, s[28:31], s51 offen offset:1024 sc1
    v_pk_mul_f32 v[80:81], v[80:81], s[58:59]
    v_pk_mul_f32 v[82:83], v[82:83], s[58:59]
    v_pk_mul_f32 v[84:85], v[84:85], s[58:59]
    v_pk_mul_f32 v[86:87], v[86:87], s[58:59]
    v_exp_f32 v80, v80
    v_exp_f32 v81, v81
    v_exp_f32 v82, v82
    v_exp_f32 v83, v83
    v_exp_f32 v84, v84
    v_exp_f32 v85, v85
    v_exp_f32 v86, v86
    v_exp_f32 v87, v87
    v_pk_add_f32 v[80:81], v[80:81], 1.0 op_sel_hi:[1,0]
    v_pk_add_f32 v[82:83], v[82:83], 1.0 op_sel_hi:[1,0]
    v_pk_add_f32 v[84:85], v[84:85], 1.0 op_sel_hi:[1,0]
    v_pk_add_f32 v[86:87], v[86:87], 1.0 op_sel_hi:[1,0]
    v_rcp_f32 v80, v80
    v_rcp_f32 v81, v81
    v_rcp_f32 v82, v82
    v_rcp_f32 v83, v83
    v_rcp_f32 v84, v84
    v_rcp_f32 v85, v85
    v_rcp_f32 v86, v86
    v_rcp_f32 v87, v87
    v_pk_mul_f32 v[80:81], v[80:81], v[208:209]
    v_pk_mul_f32 v[82:83], v[82:83], v[210:211]
    v_pk_mul_f32 v[84:85], v[84:85], v[212:213]
    v_pk_mul_f32 v[86:87], v[86:87], v[214:215]
    v_cvt_pk_bf16_f32 v24, v80, v81
    v_cvt_pk_bf16_f32 v25, v82, v83
    s_movk_i32 s51, 0x0
    v_cvt_pk_bf16_f32 v26, v84, v85
    v_cvt_pk_bf16_f32 v27, v86, v87
    buffer_store_dwordx4 v[24:27], v12, s[28:31], s51 offen offset:2048 sc1
    v_pk_mul_f32 v[96:97], v[96:97], s[58:59]
    v_pk_mul_f32 v[98:99], v[98:99], s[58:59]
    v_pk_mul_f32 v[100:101], v[100:101], s[58:59]
    v_pk_mul_f32 v[102:103], v[102:103], s[58:59]
    buffer_load_dword v47, v15, s[76:79], 0 offen sc1
    v_exp_f32 v96, v96
    v_exp_f32 v97, v97
    v_exp_f32 v98, v98
    v_exp_f32 v99, v99
    v_exp_f32 v100, v100
    v_exp_f32 v101, v101
    v_exp_f32 v102, v102
    v_exp_f32 v103, v103
    v_pk_add_f32 v[96:97], v[96:97], 1.0 op_sel_hi:[1,0]
    v_pk_add_f32 v[98:99], v[98:99], 1.0 op_sel_hi:[1,0]
    v_pk_add_f32 v[100:101], v[100:101], 1.0 op_sel_hi:[1,0]
    v_pk_add_f32 v[102:103], v[102:103], 1.0 op_sel_hi:[1,0]
    v_rcp_f32 v96, v96
    v_rcp_f32 v97, v97
    v_rcp_f32 v98, v98
    v_rcp_f32 v99, v99
    v_rcp_f32 v100, v100
    v_rcp_f32 v101, v101
    v_rcp_f32 v102, v102
    v_rcp_f32 v103, v103
    v_pk_mul_f32 v[96:97], v[96:97], v[224:225]
    v_pk_mul_f32 v[98:99], v[98:99], v[226:227]
    v_pk_mul_f32 v[100:101], v[100:101], v[228:229]
    v_pk_mul_f32 v[102:103], v[102:103], v[230:231]
    v_cvt_pk_bf16_f32 v40, v96, v97
    v_cvt_pk_bf16_f32 v41, v98, v99
    s_movk_i32 s51, 0x0
    v_cvt_pk_bf16_f32 v42, v100, v101
    v_cvt_pk_bf16_f32 v43, v102, v103
    buffer_store_dwordx4 v[40:43], v12, s[28:31], s51 offen offset:3072 sc1
L_p2:
    s_mov_b32 s3, s41
    v_lshrrev_b32 v6, 2, v0
    v_bfe_u32 v7, v0, 3, 2
    v_and_b32 v8, 3, v0
    v_lshlrev_b32 v8, 3, v8
    v_lshl_add_u32 v8, v6, 7, v8
    v_add_u32 v8, s3, v8
    v_xor_b32 v9, 0, v7
    v_lshl_add_u32 v64, v9, 5, v8
    v_xor_b32 v9, 1, v7
    v_lshl_add_u32 v65, v9, 5, v8
    v_xor_b32 v9, 2, v7
    v_lshl_add_u32 v66, v9, 5, v8
    v_xor_b32 v9, 3, v7
    v_lshl_add_u32 v67, v9, 5, v8
    v_add_u32 v9, 0x20000, v1
    v_add_u32 v120, s52, v1
    v_lshl_add_u32 v71, s52, 2, v9
    v_add_u32 v121, s53, v1
    v_lshl_add_u32 v68, s53, 2, v9
    v_add_u32 v122, s54, v1
    v_lshl_add_u32 v69, s54, 2, v9
    v_add_u32 v123, s55, v1
    v_lshl_add_u32 v70, s55, 2, v9
    v_and_b32 v2, 3, v0
    v_cmp_eq_u32 vcc, 0, v2
    v_mov_b32 v3, 0x3f803f80
    v_mov_b32 v4, v1
    v_cndmask_b32 v112, 0, v3, vcc
    v_mov_b32 v113, v112
    v_mov_b32 v114, v112
    v_mov_b32 v115, v112
    v_add_u32 v5, 0x4000, v1
    s_mov_b32 s51, 0xffff0000
    v_min_u32 v6, 6, v0
    s_mul_i32 s3, s45, 7
    v_add_u32 v6, s3, v6
    v_mov_b32 v7, s69
    v_mul_u32_u24 v14, 43, v6
    v_lshrrev_b32 v14, 7, v14
    v_mul_u32_u24 v8, 3, v14
    v_sub_u32 v8, v6, v8
    v_lshl_add_u32 v14, v8, 6, v14
    v_and_b32 v8, 3, v6
    v_lshlrev_b32 v8, 1, v8
    v_lshrrev_b32 v9, 2, v7
    v_bfe_u32 v10, v6, 2, 1
    v_xor_b32 v9, v9, v10
    v_xor_b32 v9, 1, v9
    v_add3_u32 v8, v8, v9, 64
    v_add_u32 v8, 128, v8
    v_cmp_gt_u32 vcc, 24, v6
    s_nop 1
    v_cndmask_b32 v14, v8, v14, vcc
    v_lshl_add_u32 v14, v7, 3, v14
    v_lshlrev_b32 v14, 7, v14
    s_lshl_b32 s69, s69, 10
    v_and_b32 v12, 7, v0
    v_bfe_u32 v13, v0, 3, 2
    v_lshl_add_u32 v12, v13, 6, v12
    v_lshlrev_b32 v12, 7, v12
    v_accvgpr_write_b32 a0, 0
    v_accvgpr_write_b32 a1, 0
    v_accvgpr_write_b32 a2, 0
    v_accvgpr_write_b32 a3, 0
    v_accvgpr_write_b32 a4, 0
    v_accvgpr_write_b32 a5, 0
    v_accvgpr_write_b32 a6, 0
    v_accvgpr_write_b32 a7, 0
    v_accvgpr_write_b32 a8, 0
    v_accvgpr_write_b32 a9, 0
    v_accvgpr_write_b32 a10, 0
    v_accvgpr_write_b32 a11, 0
    v_accvgpr_write_b32 a12, 0
    v_accvgpr_write_b32 a13, 0
    v_accvgpr_write_b32 a14, 0
    v_accvgpr_write_b32 a15, 0
    v_accvgpr_write_b32 a16, 0
    v_accvgpr_write_b32 a17, 0
    v_accvgpr_write_b32 a18, 0
    v_accvgpr_write_b32 a19, 0
    v_accvgpr_write_b32 a20, 0
    v_accvgpr_write_b32 a21, 0
    v_accvgpr_write_b32 a22, 0
    v_accvgpr_write_b32 a23, 0
    v_accvgpr_write_b32 a24, 0
    v_accvgpr_write_b32 a25, 0
    v_accvgpr_write_b32 a26, 0
    v_accvgpr_write_b32 a27, 0
    v_accvgpr_write_b32 a28, 0
    v_accvgpr_write_b32 a29, 0
    v_accvgpr_write_b32 a30, 0
    v_accvgpr_write_b32 a31, 0
    v_accvgpr_write_b32 a32, 0
    v_accvgpr_write_b32 a33, 0
    v_accvgpr_write_b32 a34, 0
    v_accvgpr_write_b32 a35, 0
    v_accvgpr_write_b32 a36, 0
    v_accvgpr_write_b32 a37, 0
    v_accvgpr_write_b32 a38, 0
    v_accvgpr_write_b32 a39, 0
    v_accvgpr_write_b32 a40, 0
    v_accvgpr_write_b32 a41, 0
    v_accvgpr_write_b32 a42, 0
    v_accvgpr_write_b32 a43, 0
    v_accvgpr_write_b32 a44, 0
    v_accvgpr_write_b32 a45, 0
    v_accvgpr_write_b32 a46, 0
    v_accvgpr_write_b32 a47, 0
    v_accvgpr_write_b32 a80, 0
    v_accvgpr_write_b32 a81, 0
    v_accvgpr_write_b32 a82, 0
    v_accvgpr_write_b32 a83, 0
    v_accvgpr_write_b32 a84, 0
    v_accvgpr_write_b32 a85, 0
    v_accvgpr_write_b32 a86, 0
    v_accvgpr_write_b32 a87, 0
    v_accvgpr_write_b32 a88, 0
    v_accvgpr_write_b32 a89, 0
    v_accvgpr_write_b32 a90, 0
    v_accvgpr_write_b32 a91, 0
    v_accvgpr_write_b32 a92, 0
    v_accvgpr_write_b32 a93, 0
    v_accvgpr_write_b32 a94, 0
    v_accvgpr_write_b32 a95, 0
    s_waitcnt vmcnt(1)
    v_cmp_gt_u32 vcc, 2, v47
    s_mov_b32 s71, 0
    s_nop 2
    s_cbranch_vccnz L_p2_late
    s_mov_b32 s71, 1
    s_cmp_ge_u32 s72, 2
    s_cbranch_scc1 L_hasq_e
    buffer_load_dwordx4 a[240:243], v1, s[16:19], 0 offen offset:0 sc1
    buffer_load_dwordx4 a[244:247], v1, s[16:19], 0 offen offset:1024 sc1
    buffer_load_dwordx4 a[248:251], v1, s[16:19], 0 offen offset:2048 sc1
    buffer_load_dwordx4 a[252:255], v1, s[16:19], 0 offen offset:3072 sc1
L_hasq_e:
    buffer_load_dwordx4 a[48:51], v1, s[12:15], 0 offen offset:0 sc1
    buffer_load_dwordx4 a[52:55], v1, s[12:15], 0 offen offset:1024 sc1
    s_mov_b32 m0, s37
    s_nop 0
    buffer_load_dwordx4 v1, s[12:15], s36 offen offset:0 sc1 lds
    buffer_load_dwordx4 v1, s[12:15], s36 offen offset:1024 sc1 lds
    buffer_load_dwordx4 v1, s[12:15], s36 offen offset:2048 sc1 lds
    buffer_load_dwordx4 v1, s[12:15], s36 offen offset:3072 sc1 lds
    s_add_u32 s36, s36, 0x4000
    s_add_u32 s37, s37, 0x4000
    s_and_b32 s37, s37, 0xffff
L_p2_late:
    v_accvgpr_write_b32 a96, 0
    v_accvgpr_write_b32 a97, 0
    v_accvgpr_write_b32 a98, 0
    v_accvgpr_write_b32 a99, 0
    v_accvgpr_write_b32 a100, 0
    v_accvgpr_write_b32 a101, 0
    v_accvgpr_write_b32 a102, 0
    v_accvgpr_write_b32 a103, 0
    v_accvgpr_write_b32 a104, 0
    v_accvgpr_write_b32 a105, 0
    v_accvgpr_write_b32 a106, 0
    v_accvgpr_write_b32 a107, 0
    v_accvgpr_write_b32 a108, 0
    v_accvgpr_write_b32 a109, 0
    v_accvgpr_write_b32 a110, 0
    v_accvgpr_write_b32 a111, 0
    v_accvgpr_write_b32 a112, 0
    v_accvgpr_write_b32 a113, 0
    v_accvgpr_write_b32 a114, 0
    v_accvgpr_write_b32 a115, 0
    v_accvgpr_write_b32 a116, 0
    v_accvgpr_write_b32 a117, 0
    v_accvgpr_write_b32 a118, 0
    v_accvgpr_write_b32 a119, 0
    v_accvgpr_write_b32 a120, 0
    v_accvgpr_write_b32 a121, 0
    v_accvgpr_write_b32 a122, 0
    v_accvgpr_write_b32 a123, 0
    v_accvgpr_write_b32 a124, 0
    v_accvgpr_write_b32 a125, 0
    v_accvgpr_write_b32 a126, 0
    v_accvgpr_write_b32 a127, 0
    v_accvgpr_write_b32 a128, 0
    v_accvgpr_write_b32 a129, 0
    v_accvgpr_write_b32 a130, 0
    v_accvgpr_write_b32 a131, 0
    v_accvgpr_write_b32 a132, 0
    v_accvgpr_write_b32 a133, 0
    v_accvgpr_write_b32 a134, 0
    v_accvgpr_write_b32 a135, 0
    s_cmp_eq_u32 s71, 1
    s_cbranch_scc1 L_p2_w6
    s_waitcnt vmcnt(0)
L_p2_w6:
    s_waitcnt vmcnt(6)
    s_barrier
    s_or_b32 s3, s48, s45
    s_cmp_lg_u32 s3, 0
    s_cbranch_scc1 L_b3_ns
    v_mov_b32 v6, 3
    v_mov_b32 v7, 0
    s_mov_b64 exec, 1
    buffer_store_dword v6, v7, s[76:79], s73 offen sc1
    s_mov_b64 exec, -1
L_b3_ns:
    s_cmp_eq_u32 s71, 1
    s_cbranch_scc1 L_p2_have
    s_mov_b32 s70, 0x40000
    s_branch L_qkv_ld
L_qkv_ck:
    v_cmp_gt_u32 vcc, 2, v47
    s_sub_u32 s70, s70, 1
    s_cmp_eq_u32 s70, 0
    s_cbranch_scc1 L_qkv_ok
    s_nop 1
    s_cbranch_vccz L_qkv_ok
L_qkv_ld:
    buffer_load_dword v47, v15, s[76:79], 0 offen sc1
    s_waitcnt vmcnt(0)
    s_branch L_qkv_ck
L_qkv_ok:
    s_cmp_ge_u32 s72, 2
    s_cbranch_scc1 L_hasq_l
    buffer_load_dwordx4 a[240:243], v1, s[16:19], 0 offen offset:0 sc1
    buffer_load_dwordx4 a[244:247], v1, s[16:19], 0 offen offset:1024 sc1
    buffer_load_dwordx4 a[248:251], v1, s[16:19], 0 offen offset:2048 sc1
    buffer_load_dwordx4 a[252:255], v1, s[16:19], 0 offen offset:3072 sc1
L_hasq_l:
    buffer_load_dwordx4 a[48:51], v1, s[12:15], 0 offen offset:0 sc1
    buffer_load_dwordx4 a[52:55], v1, s[12:15], 0 offen offset:1024 sc1
    s_mov_b32 m0, s37
    s_nop 0
    buffer_load_dwordx4 v1, s[12:15], s36 offen offset:0 sc1 lds
    buffer_load_dwordx4 v1, s[12:15], s36 offen offset:1024 sc1 lds
    buffer_load_dwordx4 v1, s[12:15], s36 offen offset:2048 sc1 lds
    buffer_load_dwordx4 v1, s[12:15], s36 offen offset:3072 sc1 lds
    s_add_u32 s36, s36, 0x4000
    s_add_u32 s37, s37, 0x4000
    s_and_b32 s37, s37, 0xffff
L_p2_have:
    v_accvgpr_write_b32 a136, 0
    v_accvgpr_write_b32 a137, 0
    v_accvgpr_write_b32 a138, 0
    v_accvgpr_write_b32 a139, 0
    v_accvgpr_write_b32 a140, 0
    v_accvgpr_write_b32 a141, 0
    v_accvgpr_write_b32 a142, 0
    v_accvgpr_write_b32 a143, 0
    v_accvgpr_write_b32 a144, 0
    v_accvgpr_write_b32 a145, 0
    v_accvgpr_write_b32 a146, 0
    v_accvgpr_write_b32 a147, 0
    v_accvgpr_write_b32 a148, 0
    v_accvgpr_write_b32 a149, 0
    v_accvgpr_write_b32 a150, 0
    v_accvgpr_write_b32 a151, 0
    v_accvgpr_write_b32 a152, 0
    v_accvgpr_write_b32 a153, 0
    v_accvgpr_write_b32 a154, 0
    v_accvgpr_write_b32 a155, 0
    v_accvgpr_write_b32 a156, 0
    v_accvgpr_write_b32 a157, 0
    v_accvgpr_write_b32 a158, 0
    v_accvgpr_write_b32 a159, 0
    v_accvgpr_write_b32 a160, 0
    v_accvgpr_write_b32 a161, 0
    v_accvgpr_write_b32 a162, 0
    v_accvgpr_write_b32 a163, 0
    v_accvgpr_write_b32 a164, 0
    v_accvgpr_write_b32 a165, 0
    v_accvgpr_write_b32 a166, 0
    v_accvgpr_write_b32 a167, 0
    v_accvgpr_write_b32 a168, 0
    v_accvgpr_write_b32 a169, 0
    v_accvgpr_write_b32 a170, 0
    v_accvgpr_write_b32 a171, 0
    v_accvgpr_write_b32 a172, 0
    v_accvgpr_write_b32 a173, 0
    v_accvgpr_write_b32 a174, 0
    v_accvgpr_write_b32 a175, 0
    v_accvgpr_write_b32 a176, 0
    v_accvgpr_write_b32 a177, 0
    v_accvgpr_write_b32 a178, 0
    v_accvgpr_write_b32 a179, 0
    v_accvgpr_write_b32 a180, 0
    v_accvgpr_write_b32 a181, 0
    v_accvgpr_write_b32 a182, 0
    v_accvgpr_write_b32 a183, 0
    v_accvgpr_write_b32 a184, 0
    v_accvgpr_write_b32 a185, 0
    v_accvgpr_write_b32 a186, 0
    v_accvgpr_write_b32 a187, 0
    v_accvgpr_write_b32 a188, 0
    v_accvgpr_write_b32 a189, 0
    v_accvgpr_write_b32 a190, 0
    v_accvgpr_write_b32 a191, 0
    v_accvgpr_write_b32 a192, 0
    v_accvgpr_write_b32 a193, 0
    v_accvgpr_write_b32 a194, 0
    v_accvgpr_write_b32 a195, 0
    v_accvgpr_write_b32 a196, 0
    v_accvgpr_write_b32 a197, 0
    v_accvgpr_write_b32 a198, 0
    v_accvgpr_write_b32 a199, 0
    s_waitcnt vmcnt(4)
    v_mfma_f32_16x16x32_bf16 v[16:19], a[48:51], a[240:243], 0
    v_mfma_f32_16x16x32_bf16 v[24:27], a[48:51], a[244:247], 0
    v_mfma_f32_16x16x32_bf16 v[28:31], a[52:55], a[244:247], 0
    v_mfma_f32_16x16x32_bf16 v[20:23], a[52:55], a[240:243], 0
    v_mfma_f32_16x16x32_bf16 v[32:35], a[48:51], a[248:251], 0
    v_mfma_f32_16x16x32_bf16 v[40:43], a[48:51], a[252:255], 0
    v_mfma_f32_16x16x32_bf16 v[44:47], a[52:55], a[252:255], 0
    v_mfma_f32_16x16x32_bf16 v[36:39], a[52:55], a[248:251], 0
    v_accvgpr_write_b32 a200, 0
    v_accvgpr_write_b32 a201, 0
    v_accvgpr_write_b32 a202, 0
    v_accvgpr_write_b32 a203, 0
    v_accvgpr_write_b32 a204, 0
    v_accvgpr_write_b32 a205, 0
    v_accvgpr_write_b32 a206, 0
    v_accvgpr_write_b32 a207, 0
    v_max3_f32 v72, v16, v17, v18
    v_max3_f32 v73, v24, v25, v26
    v_max3_f32 v74, v32, v33, v34
    v_max3_f32 v75, v40, v41, v42
    v_max3_f32 v72, v72, v19, v20
    v_max3_f32 v73, v73, v27, v28
    v_max3_f32 v74, v74, v35, v36
    v_max3_f32 v75, v75, v43, v44
    v_max3_f32 v72, v72, v21, v22
    v_max3_f32 v73, v73, v29, v30
    v_max3_f32 v74, v74, v37, v38
    v_max3_f32 v75, v75, v45, v46
    v_max_f32 v72, v72, v23
    v_max_f32 v73, v73, v31
    v_max_f32 v74, v74, v39
    v_max_f32 v75, v75, v47
    v_mov_b32 v76, v72
    v_mov_b32 v77, v73
    v_mov_b32 v78, v74
    v_mov_b32 v79, v75
    s_nop 0
    v_permlane16_swap_b32 v72, v76
    v_permlane16_swap_b32 v73, v77
    v_permlane16_swap_b32 v74, v78
    v_permlane16_swap_b32 v75, v79
    v_max_f32 v72, v72, v76
    v_max_f32 v73, v73, v77
    v_max_f32 v74, v74, v78
    v_max_f32 v75, v75, v79
    v_mov_b32 v76, v72
    v_mov_b32 v77, v73
    v_mov_b32 v78, v74
    v_mov_b32 v79, v75
    s_nop 0
    v_permlane32_swap_b32 v72, v76
    v_permlane32_swap_b32 v73, v77
    v_permlane32_swap_b32 v74, v78
    v_permlane32_swap_b32 v75, v79
    v_max_f32 v72, v72, v76
    v_max_f32 v73, v73, v77
    v_max_f32 v74, v74, v78
    v_max_f32 v75, v75, v79
    v_sub_f32 v48, 0, v72
    v_sub_f32 v49, 0, v72
    v_sub_f32 v50, 0, v72
    v_sub_f32 v51, 0, v72
    v_sub_f32 v52, 0, v73
    v_sub_f32 v53, 0, v73
    v_sub_f32 v54, 0, v73
    v_sub_f32 v55, 0, v73
    v_sub_f32 v56, 0, v74
    v_sub_f32 v57, 0, v74
    v_sub_f32 v58, 0, v74
    v_sub_f32 v59, 0, v74
    v_sub_f32 v60, 0, v75
    v_sub_f32 v61, 0, v75
    v_sub_f32 v62, 0, v75
    v_sub_f32 v63, 0, v75
    v_sub_f32 v16, v16, v72
    v_sub_f32 v17, v17, v72
    v_sub_f32 v18, v18, v72
    v_sub_f32 v19, v19, v72
    v_sub_f32 v20, v20, v72
    v_sub_f32 v21, v21, v72
    v_sub_f32 v22, v22, v72
    v_sub_f32 v23, v23, v72
    v_sub_f32 v24, v24, v73
    v_sub_f32 v25, v25, v73
    v_sub_f32 v26, v26, v73
    v_sub_f32 v27, v27, v73
    v_sub_f32 v28, v28, v73
    v_sub_f32 v29, v29, v73
    v_sub_f32 v30, v30, v73
    v_sub_f32 v31, v31, v73
    s_or_b32 s3, s48, s45
    s_cmp_eq_u32 s3, 0
    s_cselect_b32 s3, s71, 0
    s_cmp_eq_u32 s3, 1
    s_cbranch_scc1 L_p2_w1
    s_waitcnt vmcnt(0)
L_p2_w1:
    s_waitcnt vmcnt(1)
    s_barrier
    v_mfma_f32_16x16x32_bf16 v[32:35], a[48:51], a[248:251], v[56:59]
    s_add_u32 m0, s41, 0
    ds_read_b128 a[56:59], v4 offset:4096
    v_exp_f32 v16, v16
    v_exp_f32 v17, v17
    v_exp_f32 v18, v18
    v_cvt_pk_bf16_f32 v80, v16, v17
    v_exp_f32 v19, v19
    v_exp_f32 v20, v20
    v_mfma_f32_16x16x32_bf16 v[40:43], a[48:51], a[252:255], v[60:63]
    ds_read_b128 a[60:63], v4 offset:5120
    buffer_load_dwordx4 v116, s[64:67], s40 offen offset:0 lds
    buffer_load_dwordx4 v117, s[64:67], s40 offen offset:1024 lds
    v_cvt_pk_bf16_f32 v81, v18, v19
    v_exp_f32 v21, v21
    v_exp_f32 v22, v22
    v_cvt_pk_bf16_f32 v82, v20, v21
    v_exp_f32 v23, v23
    v_exp_f32 v24, v24
    v_mfma_f32_16x16x32_bf16 v[44:47], a[52:55], a[252:255], v[60:63]
    ds_read_b128 a[64:67], v4 offset:2048
    buffer_load_dwordx4 v118, s[64:67], s40 offen offset:2048 lds
    buffer_load_dwordx4 v119, s[64:67], s40 offen offset:3072 lds
    v_cvt_pk_bf16_f32 v83, v22, v23
    v_exp_f32 v25, v25
    v_exp_f32 v26, v26
    v_cvt_pk_bf16_f32 v84, v24, v25
    v_exp_f32 v27, v27
    v_mfma_f32_16x16x32_bf16 v[36:39], a[52:55], a[248:251], v[56:59]
    s_add_u32 s40, s40, 0x10000
    s_waitcnt lgkmcnt(1)
    ds_read_b128 a[68:71], v4 offset:3072
    v_exp_f32 v28, v28
    v_cvt_pk_bf16_f32 v85, v26, v27
    v_exp_f32 v29, v29
    v_exp_f32 v30, v30
    v_exp_f32 v31, v31
    v_cvt_pk_bf16_f32 v86, v28, v29
    v_cvt_pk_bf16_f32 v87, v30, v31
    v_mfma_f32_16x16x32_bf16 v[16:19], a[56:59], a[240:243], v[48:51]
    s_mov_b32 m0, s37
    v_exp_f32 v32, v32
    v_exp_f32 v33, v33
    v_mfma_f32_16x16x32_bf16 v[24:27], a[56:59], a[244:247], v[52:55]
    buffer_load_dwordx4 v1, s[12:15], s36 offen offset:0 sc1 lds
L_pw5:
    s_cbranch_execz L_pw8
    v_exp_f32 v34, v34
    v_cvt_pk_bf16_f32 v88, v32, v33
    v_exp_f32 v35, v35
    v_mfma_f32_16x16x32_bf16 v[28:31], a[60:63], a[244:247], v[52:55]
    v_exp_f32 v36, v36
    v_cvt_pk_bf16_f32 v89, v34, v35
    v_mfma_f32_16x16x32_bf16 v[20:23], a[60:63], a[240:243], v[48:51]
    s_waitcnt lgkmcnt(0)
    buffer_load_dwordx4 v1, s[12:15], s36 offen offset:1024 sc1 lds
    v_exp_f32 v37, v37
    v_exp_f32 v38, v38
    v_mfma_f32_16x16x32_bf16 a[0:3], a[64:67], v[80:83], a[0:3]
    v_cvt_pk_bf16_f32 v90, v36, v37
    v_exp_f32 v39, v39
    v_exp_f32 v40, v40
    v_mfma_f32_16x16x32_bf16 a[4:7], a[68:71], v[80:83], a[4:7]
    v_cvt_pk_bf16_f32 v91, v38, v39
    v_exp_f32 v41, v41
    v_exp_f32 v42, v42
    v_mfma_f32_16x16x32_bf16 a[32:35], v[112:115], v[80:83], a[32:35]
    buffer_load_dwordx4 v1, s[12:15], s36 offen offset:2048 sc1 lds
    v_cvt_pk_bf16_f32 v92, v40, v41
    v_exp_f32 v43, v43
    v_mfma_f32_16x16x32_bf16 a[36:39], v[112:115], v[84:87], a[36:39]
    v_exp_f32 v44, v44
    v_cvt_pk_bf16_f32 v93, v42, v43
    v_exp_f32 v45, v45
    v_mfma_f32_16x16x32_bf16 a[12:15], a[68:71], v[84:87], a[12:15]
    buffer_load_dwordx4 v1, s[12:15], s36 offen offset:3072 sc1 lds
    v_exp_f32 v46, v46
    v_exp_f32 v47, v47
    v_mfma_f32_16x16x32_bf16 a[8:11], a[64:67], v[84:87], a[8:11]
    s_add_u32 s36, s36, 0x4000
    s_add_u32 s37, s37, 0x4000
    s_and_b32 s37, s37, 0xffff
    v_cvt_pk_bf16_f32 v94, v44, v45
    v_cvt_pk_bf16_f32 v95, v46, v47
    v_mfma_f32_16x16x32_bf16 v[32:35], a[56:59], a[248:251], v[56:59]
    ds_read_b128 a[48:51], v4 offset:8192
    v_exp_f32 v16, v16
    v_exp_f32 v17, v17
    v_mfma_f32_16x16x32_bf16 v[40:43], a[56:59], a[252:255], v[60:63]
    v_exp_f32 v18, v18
    v_cvt_pk_bf16_f32 v80, v16, v17
    v_mfma_f32_16x16x32_bf16 v[44:47], a[60:63], a[252:255], v[60:63]
    ds_read_b128 a[52:55], v4 offset:9216
    v_exp_f32 v19, v19
    v_exp_f32 v20, v20
    v_mfma_f32_16x16x32_bf16 v[36:39], a[60:63], a[248:251], v[56:59]
    v_cvt_pk_bf16_f32 v81, v18, v19
    v_exp_f32 v21, v21
    v_exp_f32 v22, v22
    v_mfma_f32_16x16x32_bf16 a[16:19], a[64:67], v[88:91], a[16:19]
    v_cvt_pk_bf16_f32 v82, v20, v21
    v_exp_f32 v23, v23
    v_exp_f32 v24, v24
    v_mfma_f32_16x16x32_bf16 a[20:23], a[68:71], v[88:91], a[20:23]
    ds_read_b128 a[72:75], v4 offset:6144
    v_cvt_pk_bf16_f32 v83, v22, v23
    v_exp_f32 v25, v25
    v_mfma_f32_16x16x32_bf16 a[40:43], v[112:115], v[88:91], a[40:43]
    v_exp_f32 v26, v26
    v_cvt_pk_bf16_f32 v84, v24, v25
    v_mfma_f32_16x16x32_bf16 a[44:47], v[112:115], v[92:95], a[44:47]
    ds_read_b128 a[76:79], v4 offset:7168
    v_exp_f32 v27, v27
    v_exp_f32 v28, v28
    v_mfma_f32_16x16x32_bf16 a[28:31], a[68:71], v[92:95], a[28:31]
    v_cvt_pk_bf16_f32 v85, v26, v27
    v_exp_f32 v29, v29
    v_exp_f32 v30, v30
    v_mfma_f32_16x16x32_bf16 a[24:27], a[64:67], v[92:95], a[24:27]
    s_waitcnt lgkmcnt(2)
    v_exp_f32 v31, v31
    v_cvt_pk_bf16_f32 v86, v28, v29
    v_cvt_pk_bf16_f32 v87, v30, v31
    v_mfma_f32_16x16x32_bf16 v[16:19], a[48:51], a[240:243], v[48:51]
    buffer_load_dword v13, v14, s[76:79], 0 offen sc1
    v_exp_f32 v32, v32
    v_exp_f32 v33, v33
    v_mfma_f32_16x16x32_bf16 v[24:27], a[48:51], a[244:247], v[52:55]
    s_add_u32 s38, s38, 0x4000
    s_add_u32 m0, s41, 4096
    v_exp_f32 v34, v34
    v_cvt_pk_bf16_f32 v88, v32, v33
    v_mfma_f32_16x16x32_bf16 v[28:31], a[52:55], a[244:247], v[52:55]
    s_and_b32 s38, s38, 0xffff
    buffer_load_dwordx4 v116, s[64:67], s40 offen offset:0 lds
    v_exp_f32 v35, v35
    v_exp_f32 v36, v36
    v_mfma_f32_16x16x32_bf16 v[20:23], a[52:55], a[240:243], v[48:51]
    s_waitcnt lgkmcnt(0)
    v_cvt_pk_bf16_f32 v89, v34, v35
    v_exp_f32 v37, v37
    v_exp_f32 v38, v38
    v_mfma_f32_16x16x32_bf16 a[0:3], a[72:75], v[80:83], a[0:3]
    buffer_load_dwordx4 v117, s[64:67], s40 offen offset:1024 lds
    v_cvt_pk_bf16_f32 v90, v36, v37
    v_exp_f32 v39, v39
    v_mfma_f32_16x16x32_bf16 a[4:7], a[76:79], v[80:83], a[4:7]
    v_exp_f32 v40, v40
    v_cvt_pk_bf16_f32 v91, v38, v39
    v_exp_f32 v41, v41
    v_mfma_f32_16x16x32_bf16 a[32:35], v[112:115], v[80:83], a[32:35]
    buffer_load_dwordx4 v118, s[64:67], s40 offen offset:2048 lds
    v_exp_f32 v42, v42
    v_cvt_pk_bf16_f32 v92, v40, v41
    v_mfma_f32_16x16x32_bf16 a[36:39], v[112:115], v[84:87], a[36:39]
    v_exp_f32 v43, v43
    v_exp_f32 v44, v44
    v_cvt_pk_bf16_f32 v93, v42, v43
    v_mfma_f32_16x16x32_bf16 a[12:15], a[76:79], v[84:87], a[12:15]
    buffer_load_dwordx4 v119, s[64:67], s40 offen offset:3072 lds
    v_exp_f32 v45, v45
    v_exp_f32 v46, v46
    v_mfma_f32_16x16x32_bf16 a[8:11], a[72:75], v[84:87], a[8:11]
    s_add_u32 s40, s40, 0x10000
    s_xor_b32 s41, s41, 0x2000
    v_exp_f32 v47, v47
    v_cvt_pk_bf16_f32 v94, v44, v45
    v_cvt_pk_bf16_f32 v95, v46, v47
    v_mfma_f32_16x16x32_bf16 v[32:35], a[48:51], a[248:251], v[56:59]
    s_mov_b32 m0, s37
    ds_read_b128 a[56:59], v4 offset:12288
    v_exp_f32 v16, v16
    v_exp_f32 v17, v17
    v_mfma_f32_16x16x32_bf16 v[40:43], a[48:51], a[252:255], v[60:63]
    buffer_load_dwordx4 v1, s[12:15], s36 offen offset:0 sc1 lds
    v_exp_f32 v18, v18
    v_cvt_pk_bf16_f32 v80, v16, v17
    v_exp_f32 v19, v19
    v_mfma_f32_16x16x32_bf16 v[44:47], a[52:55], a[252:255], v[60:63]
    ds_read_b128 a[60:63], v4 offset:13312
    v_exp_f32 v20, v20
    v_cvt_pk_bf16_f32 v81, v18, v19
    v_mfma_f32_16x16x32_bf16 v[36:39], a[52:55], a[248:251], v[56:59]
    buffer_load_dwordx4 v1, s[12:15], s36 offen offset:1024 sc1 lds
    v_exp_f32 v21, v21
    v_exp_f32 v22, v22
    v_mfma_f32_16x16x32_bf16 a[16:19], a[72:75], v[88:91], a[16:19]
    v_cvt_pk_bf16_f32 v82, v20, v21
    v_exp_f32 v23, v23
    v_exp_f32 v24, v24
    v_cvt_pk_bf16_f32 v83, v22, v23
    v_mfma_f32_16x16x32_bf16 a[20:23], a[76:79], v[88:91], a[20:23]
    ds_read_b128 a[64:67], v4 offset:10240
    v_exp_f32 v25, v25
    v_exp_f32 v26, v26
    v_mfma_f32_16x16x32_bf16 a[40:43], v[112:115], v[88:91], a[40:43]
    buffer_load_dwordx4 v1, s[12:15], s36 offen offset:2048 sc1 lds
    v_cvt_pk_bf16_f32 v84, v24, v25
    v_exp_f32 v27, v27
    v_mfma_f32_16x16x32_bf16 a[44:47], v[112:115], v[92:95], a[44:47]
    ds_read_b128 a[68:71], v4 offset:11264
    v_exp_f32 v28, v28
    v_cvt_pk_bf16_f32 v85, v26, v27
    v_exp_f32 v29, v29
    v_mfma_f32_16x16x32_bf16 a[28:31], a[76:79], v[92:95], a[28:31]
    buffer_load_dwordx4 v1, s[12:15], s36 offen offset:3072 sc1 lds
    v_exp_f32 v30, v30
    v_exp_f32 v31, v31
    v_mfma_f32_16x16x32_bf16 a[24:27], a[72:75], v[92:95], a[24:27]
    s_add_u32 s36, s36, 0x4000
    s_add_u32 s37, s37, 0x4000
    s_and_b32 s37, s37, 0xffff
    s_waitcnt lgkmcnt(2)
    v_cvt_pk_bf16_f32 v86, v28, v29
    v_cvt_pk_bf16_f32 v87, v30, v31
    s_waitcnt vmcnt(8)
    s_mov_b32 s70, 0x40000
L_hp_ck:
    v_cmp_gt_u32 vcc, 3, v13
    s_sub_u32 s70, s70, 1
    s_cmp_eq_u32 s70, 0
    s_cbranch_scc1 L_hp_ok
    s_nop 1
    s_cbranch_vccz L_hp_ok
L_hp_ld:
    buffer_load_dword v13, v14, s[76:79], 0 offen sc1
    s_waitcnt vmcnt(0)
    s_branch L_hp_ck
L_hp_ok:
    v_mfma_f32_16x16x32_bf16 v[16:19], a[56:59], a[240:243], v[48:51]
    ds_read_b64_tr_b16 a[208:209], v64 offset:0
    v_exp_f32 v32, v32
    v_exp_f32 v33, v33
    v_mfma_f32_16x16x32_bf16 v[24:27], a[56:59], a[244:247], v[52:55]
    buffer_load_dwordx4 v[128:131], v120, s[24:27], s39 offen offset:0 sc1
    v_exp_f32 v34, v34
    v_cvt_pk_bf16_f32 v88, v32, v33
    v_mfma_f32_16x16x32_bf16 v[28:31], a[60:63], a[244:247], v[52:55]
    ds_read_b64_tr_b16 a[210:211], v64 offset:2048
    v_exp_f32 v35, v35
    v_exp_f32 v36, v36
    v_mfma_f32_16x16x32_bf16 v[20:23], a[60:63], a[240:243], v[48:51]
    s_waitcnt lgkmcnt(2)
    buffer_load_dwordx4 v[132:135], v120, s[24:27], s39 offen offset:1024 sc1
    v_cvt_pk_bf16_f32 v89, v34, v35
    v_exp_f32 v37, v37
    v_exp_f32 v38, v38
    v_mfma_f32_16x16x32_bf16 a[0:3], a[64:67], v[80:83], a[0:3]
    v_cvt_pk_bf16_f32 v90, v36, v37
    v_exp_f32 v39, v39
    v_exp_f32 v40, v40
    v_mfma_f32_16x16x32_bf16 a[4:7], a[68:71], v[80:83], a[4:7]
    ds_read_b64_tr_b16 a[212:213], v65 offset:0
    v_cvt_pk_bf16_f32 v91, v38, v39
    v_exp_f32 v41, v41
    v_mfma_f32_16x16x32_bf16 a[32:35], v[112:115], v[80:83], a[32:35]
    s_nop 0
    buffer_load_dwordx4 v[136:139], v121, s[24:27], s39 offen offset:0 sc1
    v_exp_f32 v42, v42
    v_cvt_pk_bf16_f32 v92, v40, v41
    v_mfma_f32_16x16x32_bf16 a[36:39], v[112:115], v[84:87], a[36:39]
    s_barrier
    ds_read_b64_tr_b16 a[214:215], v65 offset:2048
    v_exp_f32 v43, v43
    v_exp_f32 v44, v44
    v_mfma_f32_16x16x32_bf16 a[12:15], a[68:71], v[84:87], a[12:15]
    buffer_load_dwordx4 v[140:143], v121, s[24:27], s39 offen offset:1024 sc1
    v_cvt_pk_bf16_f32 v93, v42, v43
    v_exp_f32 v45, v45
    v_exp_f32 v46, v46
    v_mfma_f32_16x16x32_bf16 a[8:11], a[64:67], v[84:87], a[8:11]
    v_exp_f32 v47, v47
    v_cvt_pk_bf16_f32 v94, v44, v45
    v_cvt_pk_bf16_f32 v95, v46, v47
    v_mfma_f32_16x16x32_bf16 v[32:35], a[56:59], a[248:251], v[56:59]
    ds_read_b128 a[48:51], v5 offset:0
    v_exp_f32 v16, v16
    v_exp_f32 v17, v17
    v_mfma_f32_16x16x32_bf16 v[40:43], a[56:59], a[252:255], v[60:63]
    buffer_load_dwordx4 v[144:147], v122, s[24:27], s39 offen offset:0 sc1
    v_exp_f32 v18, v18
    v_cvt_pk_bf16_f32 v80, v16, v17
    v_exp_f32 v19, v19
    v_mfma_f32_16x16x32_bf16 v[44:47], a[60:63], a[252:255], v[60:63]
    ds_read_b128 a[52:55], v5 offset:1024
    buffer_load_dwordx4 v[148:151], v122, s[24:27], s39 offen offset:1024 sc1
    v_exp_f32 v20, v20
    v_cvt_pk_bf16_f32 v81, v18, v19
    v_mfma_f32_16x16x32_bf16 v[36:39], a[60:63], a[248:251], v[56:59]
    buffer_load_dwordx4 v[152:155], v123, s[24:27], s39 offen offset:0 sc1
    v_exp_f32 v21, v21
    v_exp_f32 v22, v22
    v_cvt_pk_bf16_f32 v82, v20, v21
    v_mfma_f32_16x16x32_bf16 a[16:19], a[64:67], v[88:91], a[16:19]
    buffer_load_dwordx4 v[156:159], v123, s[24:27], s39 offen offset:1024 sc1
    v_exp_f32 v23, v23
    v_exp_f32 v24, v24
    v_mfma_f32_16x16x32_bf16 a[20:23], a[68:71], v[88:91], a[20:23]
    s_add_u32 s39, s39, 0x2000
    s_add_u32 m0, s41, 0
    ds_read_b128 a[72:75], v4 offset:14336
    v_cvt_pk_bf16_f32 v83, v22, v23
    v_exp_f32 v25, v25
    v_mfma_f32_16x16x32_bf16 a[40:43], v[112:115], v[88:91], a[40:43]
    buffer_load_dwordx4 v116, s[64:67], s40 offen offset:0 lds
    v_exp_f32 v26, v26
    v_cvt_pk_bf16_f32 v84, v24, v25
    v_exp_f32 v27, v27
    v_mfma_f32_16x16x32_bf16 a[44:47], v[112:115], v[92:95], a[44:47]
    ds_read_b128 a[76:79], v4 offset:15360
    buffer_load_dwordx4 v117, s[64:67], s40 offen offset:1024 lds
    v_exp_f32 v28, v28
    v_cvt_pk_bf16_f32 v85, v26, v27
    v_mfma_f32_16x16x32_bf16 a[28:31], a[68:71], v[92:95], a[28:31]
    buffer_load_dwordx4 v118, s[64:67], s40 offen offset:2048 lds
    buffer_load_dwordx4 v119, s[64:67], s40 offen offset:3072 lds
    v_exp_f32 v29, v29
    v_exp_f32 v30, v30
    v_mfma_f32_16x16x32_bf16 a[24:27], a[64:67], v[92:95], a[24:27]
    s_add_u32 s40, s40, 0x10000
    s_waitcnt lgkmcnt(2)
    v_exp_f32 v31, v31
    v_cvt_pk_bf16_f32 v86, v28, v29
    v_cvt_pk_bf16_f32 v87, v30, v31
    v_mfma_f32_16x16x32_bf16 v[16:19], a[48:51], a[240:243], v[48:51]
    s_mov_b32 m0, s37
    ds_read_b64_tr_b16 a[216:217], v66 offset:0
    buffer_load_dwordx4 v[160:163], v120, s[24:27], s39 offen offset:0 sc1
    v_mov_b32 v4, v5
    v_add_u32 v5, s38, v1
    v_exp_f32 v32, v32
    v_mfma_f32_16x16x32_bf16 v[24:27], a[48:51], a[244:247], v[52:55]
    buffer_load_dwordx4 v1, s[12:15], s36 offen offset:0 sc1 lds
    v_exp_f32 v33, v33
    v_exp_f32 v34, v34
    v_mfma_f32_16x16x32_bf16 v[28:31], a[52:55], a[244:247], v[52:55]
    ds_read_b64_tr_b16 a[218:219], v66 offset:2048
    buffer_load_dwordx4 v[164:167], v120, s[24:27], s39 offen offset:1024 sc1
    v_cvt_pk_bf16_f32 v88, v32, v33
    v_exp_f32 v35, v35
    v_mfma_f32_16x16x32_bf16 v[20:23], a[52:55], a[240:243], v[48:51]
    s_waitcnt lgkmcnt(2)
    buffer_load_dwordx4 v1, s[12:15], s36 offen offset:1024 sc1 lds
    v_exp_f32 v36, v36
    v_cvt_pk_bf16_f32 v89, v34, v35
    v_exp_f32 v37, v37
    v_mfma_f32_16x16x32_bf16 a[0:3], a[72:75], v[80:83], a[0:3]
    v_exp_f32 v38, v38
    v_cvt_pk_bf16_f32 v90, v36, v37
    v_exp_f32 v39, v39
    v_exp_f32 v40, v40
    v_mfma_f32_16x16x32_bf16 a[4:7], a[76:79], v[80:83], a[4:7]
    ds_read_b64_tr_b16 a[220:221], v67 offset:0
    buffer_load_dwordx4 v[168:171], v121, s[24:27], s39 offen offset:0 sc1
    v_cvt_pk_bf16_f32 v91, v38, v39
    v_exp_f32 v41, v41
    v_mfma_f32_16x16x32_bf16 a[32:35], v[112:115], v[80:83], a[32:35]
    buffer_load_dwordx4 v1, s[12:15], s36 offen offset:2048 sc1 lds
    v_exp_f32 v42, v42
    v_cvt_pk_bf16_f32 v92, v40, v41
    v_exp_f32 v43, v43
    v_mfma_f32_16x16x32_bf16 a[36:39], v[112:115], v[84:87], a[36:39]
    ds_read_b64_tr_b16 a[222:223], v67 offset:2048
    buffer_load_dwordx4 v[172:175], v121, s[24:27], s39 offen offset:1024 sc1
    v_exp_f32 v44, v44
    v_cvt_pk_bf16_f32 v93, v42, v43
    v_mfma_f32_16x16x32_bf16 a[12:15], a[76:79], v[84:87], a[12:15]
    buffer_load_dwordx4 v1, s[12:15], s36 offen offset:3072 sc1 lds
    v_exp_f32 v45, v45
    v_exp_f32 v46, v46
    v_mfma_f32_16x16x32_bf16 a[8:11], a[72:75], v[84:87], a[8:11]
    s_add_u32 s36, s36, 0x4000
    s_add_u32 s37, s37, 0x4000
    s_and_b32 s37, s37, 0xffff
    v_exp_f32 v47, v47
    v_cvt_pk_bf16_f32 v94, v44, v45
    v_cvt_pk_bf16_f32 v95, v46, v47
.p2align 6
L_k2_loop:
    v_mfma_f32_16x16x32_bf16 v[32:35], a[48:51], a[248:251], v[56:59]
    ds_read_b128 a[56:59], v4 offset:4096
    v_exp_f32 v16, v16
    v_mfma_f32_16x16x32_bf16 v[40:43], a[48:51], a[252:255], v[60:63]
    v_exp_f32 v17, v17
    v_mfma_f32_16x16x32_bf16 v[44:47], a[52:55], a[252:255], v[60:63]
    buffer_load_dwordx4 v[176:179], v122, s[24:27], s39 offen offset:0 sc1
    v_exp_f32 v18, v18
    v_mfma_f32_16x16x32_bf16 v[36:39], a[52:55], a[248:251], v[56:59]
    s_waitcnt vmcnt(17) lgkmcnt(1)
    v_cvt_pk_bf16_f32 v80, v16, v17
    v_exp_f32 v19, v19
    v_mfma_f32_16x16x32_bf16 a[80:83], a[208:211], v[128:131], a[80:83]
    ds_read_b128 a[60:63], v4 offset:5120
    v_exp_f32 v20, v20
    v_mfma_f32_16x16x32_bf16 a[84:87], a[212:215], v[128:131], a[84:87]
    v_cvt_pk_bf16_f32 v81, v18, v19
    v_exp_f32 v21, v21
    v_mfma_f32_16x16x32_bf16 a[88:91], a[216:219], v[128:131], a[88:91]
    buffer_load_dwordx4 v[180:183], v122, s[24:27], s39 offen offset:1024 sc1
    v_exp_f32 v22, v22
    v_mfma_f32_16x16x32_bf16 a[92:95], a[220:223], v[128:131], a[92:95]
    v_cvt_pk_bf16_f32 v82, v20, v21
    v_exp_f32 v23, v23
    v_mfma_f32_16x16x32_bf16 a[16:19], a[72:75], v[88:91], a[16:19]
    v_exp_f32 v24, v24
    v_mfma_f32_16x16x32_bf16 a[20:23], a[76:79], v[88:91], a[20:23]
    ds_read_b128 a[64:67], v4 offset:2048
    v_cvt_pk_bf16_f32 v83, v22, v23
    v_mfma_f32_16x16x32_bf16 a[40:43], v[112:115], v[88:91], a[40:43]
    v_exp_f32 v25, v25
    v_mfma_f32_16x16x32_bf16 a[44:47], v[112:115], v[92:95], a[44:47]
    buffer_load_dwordx4 v[184:187], v123, s[24:27], s39 offen offset:0 sc1
    v_exp_f32 v26, v26
    v_mfma_f32_16x16x32_bf16 a[28:31], a[76:79], v[92:95], a[28:31]
    v_cvt_pk_bf16_f32 v84, v24, v25
    v_exp_f32 v27, v27
    v_mfma_f32_16x16x32_bf16 a[24:27], a[72:75], v[92:95], a[24:27]
    ds_read_b128 a[68:71], v4 offset:3072
    v_exp_f32 v28, v28
    v_mfma_f32_16x16x32_bf16 a[108:111], a[220:223], v[132:135], a[108:111]
    v_cvt_pk_bf16_f32 v85, v26, v27
    v_exp_f32 v29, v29
    v_mfma_f32_16x16x32_bf16 a[104:107], a[216:219], v[132:135], a[104:107]
    buffer_load_dwordx4 v[188:191], v123, s[24:27], s39 offen offset:1024 sc1
    v_exp_f32 v30, v30
    v_mfma_f32_16x16x32_bf16 a[100:103], a[212:215], v[132:135], a[100:103]
    s_add_u32 s39, s39, 0x2000
    v_exp_f32 v31, v31
    v_mfma_f32_16x16x32_bf16 a[96:99], a[208:211], v[132:135], a[96:99]
    s_waitcnt lgkmcnt(2)
    v_cvt_pk_bf16_f32 v86, v28, v29
    v_cvt_pk_bf16_f32 v87, v30, v31
    v_mfma_f32_16x16x32_bf16 v[16:19], a[56:59], a[240:243], v[48:51]
    s_nop 0
    ds_read_b64_tr_b16 a[224:225], v64 offset:4096
    v_exp_f32 v32, v32
    v_mfma_f32_16x16x32_bf16 v[24:27], a[56:59], a[244:247], v[52:55]
    s_add_u32 m0, s41, 4096
    v_exp_f32 v33, v33
    v_mfma_f32_16x16x32_bf16 v[28:31], a[60:63], a[244:247], v[52:55]
    buffer_load_dwordx4 v116, s[64:67], s40 offen offset:0 lds
    v_exp_f32 v34, v34
    v_mfma_f32_16x16x32_bf16 v[20:23], a[60:63], a[240:243], v[48:51]
    v_cvt_pk_bf16_f32 v88, v32, v33
    v_exp_f32 v35, v35
    v_mfma_f32_16x16x32_bf16 a[112:115], a[208:211], v[136:139], a[112:115]
    ds_read_b64_tr_b16 a[226:227], v64 offset:6144
    v_exp_f32 v36, v36
    v_mfma_f32_16x16x32_bf16 a[116:119], a[212:215], v[136:139], a[116:119]
    v_cvt_pk_bf16_f32 v89, v34, v35
    v_exp_f32 v37, v37
    v_mfma_f32_16x16x32_bf16 a[120:123], a[216:219], v[136:139], a[120:123]
    buffer_load_dwordx4 v117, s[64:67], s40 offen offset:1024 lds
    v_exp_f32 v38, v38
    v_mfma_f32_16x16x32_bf16 a[124:127], a[220:223], v[136:139], a[124:127]
    s_waitcnt lgkmcnt(2)
    v_cvt_pk_bf16_f32 v90, v36, v37
    v_exp_f32 v39, v39
    v_mfma_f32_16x16x32_bf16 a[0:3], a[64:67], v[80:83], a[0:3]
    v_exp_f32 v40, v40
    v_mfma_f32_16x16x32_bf16 a[4:7], a[68:71], v[80:83], a[4:7]
    ds_read_b64_tr_b16 a[228:229], v65 offset:4096
    v_cvt_pk_bf16_f32 v91, v38, v39
    v_mfma_f32_16x16x32_bf16 a[32:35], v[112:115], v[80:83], a[32:35]
    v_exp_f32 v41, v41
    v_mfma_f32_16x16x32_bf16 a[36:39], v[112:115], v[84:87], a[36:39]
    buffer_load_dwordx4 v118, s[64:67], s40 offen offset:2048 lds
    v_exp_f32 v42, v42
    v_mfma_f32_16x16x32_bf16 a[12:15], a[68:71], v[84:87], a[12:15]
    v_cvt_pk_bf16_f32 v92, v40, v41
    v_exp_f32 v43, v43
    v_mfma_f32_16x16x32_bf16 a[8:11], a[64:67], v[84:87], a[8:11]
    ds_read_b64_tr_b16 a[230:231], v65 offset:6144
    v_exp_f32 v44, v44
    v_mfma_f32_16x16x32_bf16 a[140:143], a[220:223], v[140:143], a[140:143]
    v_cvt_pk_bf16_f32 v93, v42, v43
    v_exp_f32 v45, v45
    v_mfma_f32_16x16x32_bf16 a[136:139], a[216:219], v[140:143], a[136:139]
    buffer_load_dwordx4 v119, s[64:67], s40 offen offset:3072 lds
    v_exp_f32 v46, v46
    v_mfma_f32_16x16x32_bf16 a[132:135], a[212:215], v[140:143], a[132:135]
    s_add_u32 s40, s40, 0x10000
    v_exp_f32 v47, v47
    v_mfma_f32_16x16x32_bf16 a[128:131], a[208:211], v[140:143], a[128:131]
    s_xor_b32 s41, s41, 0x2000
    v_cvt_pk_bf16_f32 v94, v44, v45
    v_cvt_pk_bf16_f32 v95, v46, v47
    v_mfma_f32_16x16x32_bf16 v[32:35], a[56:59], a[248:251], v[56:59]
    ds_read_b128 a[48:51], v4 offset:8192
    v_exp_f32 v16, v16
    v_mfma_f32_16x16x32_bf16 v[40:43], a[56:59], a[252:255], v[60:63]
    v_exp_f32 v17, v17
    v_mfma_f32_16x16x32_bf16 v[44:47], a[60:63], a[252:255], v[60:63]
    buffer_load_dwordx4 v[128:131], v120, s[24:27], s39 offen offset:0 sc1
    v_exp_f32 v18, v18
    v_mfma_f32_16x16x32_bf16 v[36:39], a[60:63], a[248:251], v[56:59]
    s_waitcnt vmcnt(21)
    v_cvt_pk_bf16_f32 v80, v16, v17
    v_exp_f32 v19, v19
    v_mfma_f32_16x16x32_bf16 a[144:147], a[208:211], v[144:147], a[144:147]
    ds_read_b128 a[52:55], v4 offset:9216
    v_exp_f32 v20, v20
    v_mfma_f32_16x16x32_bf16 a[148:151], a[212:215], v[144:147], a[148:151]
    v_cvt_pk_bf16_f32 v81, v18, v19
    v_exp_f32 v21, v21
    v_mfma_f32_16x16x32_bf16 a[152:155], a[216:219], v[144:147], a[152:155]
    buffer_load_dwordx4 v[132:135], v120, s[24:27], s39 offen offset:1024 sc1
    v_exp_f32 v22, v22
    v_mfma_f32_16x16x32_bf16 a[156:159], a[220:223], v[144:147], a[156:159]
    v_cvt_pk_bf16_f32 v82, v20, v21
    v_exp_f32 v23, v23
    v_mfma_f32_16x16x32_bf16 a[16:19], a[64:67], v[88:91], a[16:19]
    v_exp_f32 v24, v24
    v_mfma_f32_16x16x32_bf16 a[20:23], a[68:71], v[88:91], a[20:23]
    ds_read_b128 a[72:75], v4 offset:6144
    v_cvt_pk_bf16_f32 v83, v22, v23
    v_mfma_f32_16x16x32_bf16 a[40:43], v[112:115], v[88:91], a[40:43]
    v_exp_f32 v25, v25
    v_mfma_f32_16x16x32_bf16 a[44:47], v[112:115], v[92:95], a[44:47]
    buffer_load_dwordx4 v[136:139], v121, s[24:27], s39 offen offset:0 sc1
    v_exp_f32 v26, v26
    v_mfma_f32_16x16x32_bf16 a[28:31], a[68:71], v[92:95], a[28:31]
    v_cvt_pk_bf16_f32 v84, v24, v25
    v_exp_f32 v27, v27
    v_mfma_f32_16x16x32_bf16 a[24:27], a[64:67], v[92:95], a[24:27]
    ds_read_b128 a[76:79], v4 offset:7168
    v_exp_f32 v28, v28
    v_mfma_f32_16x16x32_bf16 a[172:175], a[220:223], v[148:151], a[172:175]
    v_cvt_pk_bf16_f32 v85, v26, v27
    v_exp_f32 v29, v29
    v_mfma_f32_16x16x32_bf16 a[168:171], a[216:219], v[148:151], a[168:171]
    buffer_load_dwordx4 v[140:143], v121, s[24:27], s39 offen offset:1024 sc1
    v_exp_f32 v30, v30
    v_mfma_f32_16x16x32_bf16 a[164:167], a[212:215], v[148:151], a[164:167]
    v_exp_f32 v31, v31
    v_mfma_f32_16x16x32_bf16 a[160:163], a[208:211], v[148:151], a[160:163]
    s_waitcnt lgkmcnt(2)
    v_cvt_pk_bf16_f32 v86, v28, v29
    v_cvt_pk_bf16_f32 v87, v30, v31
    v_mfma_f32_16x16x32_bf16 v[16:19], a[48:51], a[240:243], v[48:51]
    ds_read_b64_tr_b16 a[232:233], v66 offset:4096
    v_exp_f32 v32, v32
    v_mfma_f32_16x16x32_bf16 v[24:27], a[48:51], a[244:247], v[52:55]
    s_add_u32 s38, s38, 0x4000
    v_exp_f32 v33, v33
    v_mfma_f32_16x16x32_bf16 v[28:31], a[52:55], a[244:247], v[52:55]
    s_and_b32 s38, s38, 0xffff
    v_exp_f32 v34, v34
    v_mfma_f32_16x16x32_bf16 v[20:23], a[52:55], a[240:243], v[48:51]
    v_cvt_pk_bf16_f32 v88, v32, v33
    v_exp_f32 v35, v35
    v_mfma_f32_16x16x32_bf16 a[176:179], a[208:211], v[152:155], a[176:179]
    ds_read_b64_tr_b16 a[234:235], v66 offset:6144
    v_exp_f32 v36, v36
    v_mfma_f32_16x16x32_bf16 a[180:183], a[212:215], v[152:155], a[180:183]
    v_cvt_pk_bf16_f32 v89, v34, v35
    v_exp_f32 v37, v37
    v_mfma_f32_16x16x32_bf16 a[184:187], a[216:219], v[152:155], a[184:187]
    v_exp_f32 v38, v38
    v_mfma_f32_16x16x32_bf16 a[188:191], a[220:223], v[152:155], a[188:191]
    s_waitcnt lgkmcnt(2)
    v_cvt_pk_bf16_f32 v90, v36, v37
    v_exp_f32 v39, v39
    v_mfma_f32_16x16x32_bf16 a[0:3], a[72:75], v[80:83], a[0:3]
    v_exp_f32 v40, v40
    v_mfma_f32_16x16x32_bf16 a[4:7], a[76:79], v[80:83], a[4:7]
    ds_read_b64_tr_b16 a[236:237], v67 offset:4096
    v_cvt_pk_bf16_f32 v91, v38, v39
    v_mfma_f32_16x16x32_bf16 a[32:35], v[112:115], v[80:83], a[32:35]
    v_exp_f32 v41, v41
    v_mfma_f32_16x16x32_bf16 a[36:39], v[112:115], v[84:87], a[36:39]
    v_exp_f32 v42, v42
    v_mfma_f32_16x16x32_bf16 a[12:15], a[76:79], v[84:87], a[12:15]
    v_cvt_pk_bf16_f32 v92, v40, v41
    v_exp_f32 v43, v43
    v_mfma_f32_16x16x32_bf16 a[8:11], a[72:75], v[84:87], a[8:11]
    ds_read_b64_tr_b16 a[238:239], v67 offset:6144
    v_exp_f32 v44, v44
    v_mfma_f32_16x16x32_bf16 a[204:207], a[220:223], v[156:159], a[204:207]
    v_cvt_pk_bf16_f32 v93, v42, v43
    v_exp_f32 v45, v45
    v_mfma_f32_16x16x32_bf16 a[200:203], a[216:219], v[156:159], a[200:203]
    v_exp_f32 v46, v46
    v_mfma_f32_16x16x32_bf16 a[196:199], a[212:215], v[156:159], a[196:199]
    s_sub_u32 s42, s42, 1
    v_exp_f32 v47, v47
    v_mfma_f32_16x16x32_bf16 a[192:195], a[208:211], v[156:159], a[192:195]
    v_cvt_pk_bf16_f32 v94, v44, v45
    v_cvt_pk_bf16_f32 v95, v46, v47
    v_mfma_f32_16x16x32_bf16 v[32:35], a[48:51], a[248:251], v[56:59]
    ds_read_b128 a[56:59], v4 offset:12288
    v_xor_b32 v64, 0x2000, v64
    v_xor_b32 v65, 0x2000, v65
    v_mfma_f32_16x16x32_bf16 v[40:43], a[48:51], a[252:255], v[60:63]
    v_xor_b32 v66, 0x2000, v66
    v_xor_b32 v67, 0x2000, v67
    v_mfma_f32_16x16x32_bf16 v[44:47], a[52:55], a[252:255], v[60:63]
    buffer_load_dwordx4 v[144:147], v122, s[24:27], s39 offen offset:0 sc1
    v_exp_f32 v16, v16
    v_mfma_f32_16x16x32_bf16 v[36:39], a[52:55], a[248:251], v[56:59]
    s_waitcnt vmcnt(14) lgkmcnt(1)
    v_exp_f32 v17, v17
    v_exp_f32 v18, v18
    v_mfma_f32_16x16x32_bf16 a[80:83], a[224:227], v[160:163], a[80:83]
    ds_read_b128 a[60:63], v4 offset:13312
    v_cvt_pk_bf16_f32 v80, v16, v17
    v_mfma_f32_16x16x32_bf16 a[84:87], a[228:231], v[160:163], a[84:87]
    v_exp_f32 v19, v19
    v_exp_f32 v20, v20
    v_mfma_f32_16x16x32_bf16 a[88:91], a[232:235], v[160:163], a[88:91]
    buffer_load_dwordx4 v[148:151], v122, s[24:27], s39 offen offset:1024 sc1
    v_cvt_pk_bf16_f32 v81, v18, v19
    v_mfma_f32_16x16x32_bf16 a[92:95], a[236:239], v[160:163], a[92:95]
    v_exp_f32 v21, v21
    v_exp_f32 v22, v22
    v_mfma_f32_16x16x32_bf16 a[16:19], a[72:75], v[88:91], a[16:19]
    v_cvt_pk_bf16_f32 v82, v20, v21
    v_exp_f32 v23, v23
    v_mfma_f32_16x16x32_bf16 a[20:23], a[76:79], v[88:91], a[20:23]
    ds_read_b128 a[64:67], v4 offset:10240
    v_exp_f32 v24, v24
    v_mfma_f32_16x16x32_bf16 a[40:43], v[112:115], v[88:91], a[40:43]
    v_cvt_pk_bf16_f32 v83, v22, v23
    v_exp_f32 v25, v25
    v_mfma_f32_16x16x32_bf16 a[44:47], v[112:115], v[92:95], a[44:47]
    buffer_load_dwordx4 v[152:155], v123, s[24:27], s39 offen offset:0 sc1
    v_exp_f32 v26, v26
    v_mfma_f32_16x16x32_bf16 a[28:31], a[76:79], v[92:95], a[28:31]
    v_cvt_pk_bf16_f32 v84, v24, v25
    v_exp_f32 v27, v27
    v_mfma_f32_16x16x32_bf16 a[24:27], a[72:75], v[92:95], a[24:27]
    ds_read_b128 a[68:71], v4 offset:11264
    v_exp_f32 v28, v28
    v_mfma_f32_16x16x32_bf16 a[108:111], a[236:239], v[164:167], a[108:111]
    v_cvt_pk_bf16_f32 v85, v26, v27
    v_exp_f32 v29, v29
    v_mfma_f32_16x16x32_bf16 a[104:107], a[232:235], v[164:167], a[104:107]
    buffer_load_dwordx4 v[156:159], v123, s[24:27], s39 offen offset:1024 sc1
    v_exp_f32 v30, v30
    v_mfma_f32_16x16x32_bf16 a[100:103], a[228:231], v[164:167], a[100:103]
    s_add_u32 s39, s39, 0x2000
    v_exp_f32 v31, v31
    v_mfma_f32_16x16x32_bf16 a[96:99], a[224:227], v[164:167], a[96:99]
    s_waitcnt lgkmcnt(2)
    v_cvt_pk_bf16_f32 v86, v28, v29
    v_cvt_pk_bf16_f32 v87, v30, v31
    v_mfma_f32_16x16x32_bf16 v[16:19], a[56:59], a[240:243], v[48:51]
    s_nop 0
    ds_read_b64_tr_b16 a[208:209], v64 offset:0
    v_exp_f32 v32, v32
    v_mfma_f32_16x16x32_bf16 v[24:27], a[56:59], a[244:247], v[52:55]
    s_add_u32 m0, s41, 0
    v_exp_f32 v33, v33
    v_mfma_f32_16x16x32_bf16 v[28:31], a[60:63], a[244:247], v[52:55]
    buffer_load_dwordx4 v116, s[64:67], s40 offen offset:0 lds
    v_exp_f32 v34, v34
    v_mfma_f32_16x16x32_bf16 v[20:23], a[60:63], a[240:243], v[48:51]
    v_cvt_pk_bf16_f32 v88, v32, v33
    v_exp_f32 v35, v35
    v_mfma_f32_16x16x32_bf16 a[112:115], a[224:227], v[168:171], a[112:115]
    ds_read_b64_tr_b16 a[210:211], v64 offset:2048
    v_exp_f32 v36, v36
    v_mfma_f32_16x16x32_bf16 a[116:119], a[228:231], v[168:171], a[116:119]
    v_cvt_pk_bf16_f32 v89, v34, v35
    v_exp_f32 v37, v37
    v_mfma_f32_16x16x32_bf16 a[120:123], a[232:235], v[168:171], a[120:123]
    buffer_load_dwordx4 v117, s[64:67], s40 offen offset:1024 lds
    v_exp_f32 v38, v38
    v_mfma_f32_16x16x32_bf16 a[124:127], a[236:239], v[168:171], a[124:127]
    s_waitcnt lgkmcnt(2)
    v_cvt_pk_bf16_f32 v90, v36, v37
    v_exp_f32 v39, v39
    v_mfma_f32_16x16x32_bf16 a[0:3], a[64:67], v[80:83], a[0:3]
    v_exp_f32 v40, v40
    v_mfma_f32_16x16x32_bf16 a[4:7], a[68:71], v[80:83], a[4:7]
    ds_read_b64_tr_b16 a[212:213], v65 offset:0
    v_cvt_pk_bf16_f32 v91, v38, v39
    v_mfma_f32_16x16x32_bf16 a[32:35], v[112:115], v[80:83], a[32:35]
L_pw6:
    s_cbranch_execz L_pw9
    v_exp_f32 v41, v41
    v_mfma_f32_16x16x32_bf16 a[36:39], v[112:115], v[84:87], a[36:39]
    buffer_load_dwordx4 v118, s[64:67], s40 offen offset:2048 lds
    v_exp_f32 v42, v42
    v_mfma_f32_16x16x32_bf16 a[12:15], a[68:71], v[84:87], a[12:15]
    v_cvt_pk_bf16_f32 v92, v40, v41
    v_exp_f32 v43, v43
    v_mfma_f32_16x16x32_bf16 a[8:11], a[64:67], v[84:87], a[8:11]
    ds_read_b64_tr_b16 a[214:215], v65 offset:2048
    v_exp_f32 v44, v44
    v_mfma_f32_16x16x32_bf16 a[140:143], a[236:239], v[172:175], a[140:143]
    s_nop 0
    v_cvt_pk_bf16_f32 v93, v42, v43
    v_exp_f32 v45, v45
    v_mfma_f32_16x16x32_bf16 a[136:139], a[232:235], v[172:175], a[136:139]
    s_barrier
    buffer_load_dwordx4 v119, s[64:67], s40 offen offset:3072 lds
    v_exp_f32 v46, v46
    v_mfma_f32_16x16x32_bf16 a[132:135], a[228:231], v[172:175], a[132:135]
    s_add_u32 s40, s40, 0x10000
    v_exp_f32 v47, v47
    v_mfma_f32_16x16x32_bf16 a[128:131], a[224:227], v[172:175], a[128:131]
    v_cvt_pk_bf16_f32 v94, v44, v45
    v_cvt_pk_bf16_f32 v95, v46, v47
    v_mfma_f32_16x16x32_bf16 v[32:35], a[56:59], a[248:251], v[56:59]
    ds_read_b128 a[48:51], v5 offset:0
    v_exp_f32 v16, v16
    v_mfma_f32_16x16x32_bf16 v[40:43], a[56:59], a[252:255], v[60:63]
    v_exp_f32 v17, v17
    v_mfma_f32_16x16x32_bf16 v[44:47], a[60:63], a[252:255], v[60:63]
    buffer_load_dwordx4 v[160:163], v120, s[24:27], s39 offen offset:0 sc1
    v_exp_f32 v18, v18
    v_mfma_f32_16x16x32_bf16 v[36:39], a[60:63], a[248:251], v[56:59]
    s_waitcnt vmcnt(17)
    v_cvt_pk_bf16_f32 v80, v16, v17
    v_exp_f32 v19, v19
    v_mfma_f32_16x16x32_bf16 a[144:147], a[224:227], v[176:179], a[144:147]
    ds_read_b128 a[52:55], v5 offset:1024
    v_exp_f32 v20, v20
    v_mfma_f32_16x16x32_bf16 a[148:151], a[228:231], v[176:179], a[148:151]
    v_cvt_pk_bf16_f32 v81, v18, v19
    v_exp_f32 v21, v21
    v_mfma_f32_16x16x32_bf16 a[152:155], a[232:235], v[176:179], a[152:155]
    buffer_load_dwordx4 v[164:167], v120, s[24:27], s39 offen offset:1024 sc1
    v_exp_f32 v22, v22
    v_mfma_f32_16x16x32_bf16 a[156:159], a[236:239], v[176:179], a[156:159]
    v_cvt_pk_bf16_f32 v82, v20, v21
    v_exp_f32 v23, v23
    v_mfma_f32_16x16x32_bf16 a[16:19], a[64:67], v[88:91], a[16:19]
    v_exp_f32 v24, v24
    v_mfma_f32_16x16x32_bf16 a[20:23], a[68:71], v[88:91], a[20:23]
    ds_read_b128 a[72:75], v4 offset:14336
    v_cvt_pk_bf16_f32 v83, v22, v23
    v_mfma_f32_16x16x32_bf16 a[40:43], v[112:115], v[88:91], a[40:43]
    v_exp_f32 v25, v25
    v_mfma_f32_16x16x32_bf16 a[44:47], v[112:115], v[92:95], a[44:47]
    buffer_load_dwordx4 v[168:171], v121, s[24:27], s39 offen offset:0 sc1
    v_exp_f32 v26, v26
    v_mfma_f32_16x16x32_bf16 a[28:31], a[68:71], v[92:95], a[28:31]
    v_cvt_pk_bf16_f32 v84, v24, v25
    v_exp_f32 v27, v27
    v_mfma_f32_16x16x32_bf16 a[24:27], a[64:67], v[92:95], a[24:27]
    ds_read_b128 a[76:79], v4 offset:15360
    v_exp_f32 v28, v28
    v_mfma_f32_16x16x32_bf16 a[172:175], a[236:239], v[180:183], a[172:175]
    v_cvt_pk_bf16_f32 v85, v26, v27
    v_exp_f32 v29, v29
    v_mfma_f32_16x16x32_bf16 a[168:171], a[232:235], v[180:183], a[168:171]
    buffer_load_dwordx4 v[172:175], v121, s[24:27], s39 offen offset:1024 sc1
    v_exp_f32 v30, v30
    v_mfma_f32_16x16x32_bf16 a[164:167], a[228:231], v[180:183], a[164:167]
    v_exp_f32 v31, v31
    v_mfma_f32_16x16x32_bf16 a[160:163], a[224:227], v[180:183], a[160:163]
    s_waitcnt lgkmcnt(2)
    v_cvt_pk_bf16_f32 v86, v28, v29
    v_cvt_pk_bf16_f32 v87, v30, v31
    v_mfma_f32_16x16x32_bf16 v[16:19], a[48:51], a[240:243], v[48:51]
    ds_read_b64_tr_b16 a[216:217], v66 offset:0
    v_mov_b32 v4, v5
    v_add_u32 v5, s38, v1
    v_mfma_f32_16x16x32_bf16 v[24:27], a[48:51], a[244:247], v[52:55]
    s_mov_b32 m0, s37
    v_exp_f32 v32, v32
    v_mfma_f32_16x16x32_bf16 v[28:31], a[52:55], a[244:247], v[52:55]
    buffer_load_dwordx4 v1, s[12:15], s36 offen offset:0 sc1 lds
    v_exp_f32 v33, v33
    v_mfma_f32_16x16x32_bf16 v[20:23], a[52:55], a[240:243], v[48:51]
    v_exp_f32 v34, v34
    v_cvt_pk_bf16_f32 v88, v32, v33
    v_mfma_f32_16x16x32_bf16 a[176:179], a[224:227], v[184:187], a[176:179]
    ds_read_b64_tr_b16 a[218:219], v66 offset:2048
    v_exp_f32 v35, v35
    v_mfma_f32_16x16x32_bf16 a[180:183], a[228:231], v[184:187], a[180:183]
    v_exp_f32 v36, v36
    v_cvt_pk_bf16_f32 v89, v34, v35
    v_mfma_f32_16x16x32_bf16 a[184:187], a[232:235], v[184:187], a[184:187]
    buffer_load_dwordx4 v1, s[12:15], s36 offen offset:1024 sc1 lds
    v_exp_f32 v37, v37
    v_mfma_f32_16x16x32_bf16 a[188:191], a[236:239], v[184:187], a[188:191]
    s_waitcnt lgkmcnt(2)
    v_exp_f32 v38, v38
    v_mfma_f32_16x16x32_bf16 a[0:3], a[72:75], v[80:83], a[0:3]
    v_cvt_pk_bf16_f32 v90, v36, v37
    v_exp_f32 v39, v39
    v_mfma_f32_16x16x32_bf16 a[4:7], a[76:79], v[80:83], a[4:7]
    ds_read_b64_tr_b16 a[220:221], v67 offset:0
    v_exp_f32 v40, v40
    v_mfma_f32_16x16x32_bf16 a[32:35], v[112:115], v[80:83], a[32:35]
    buffer_load_dwordx4 v1, s[12:15], s36 offen offset:2048 sc1 lds
    v_cvt_pk_bf16_f32 v91, v38, v39
    v_mfma_f32_16x16x32_bf16 a[36:39], v[112:115], v[84:87], a[36:39]
    v_exp_f32 v41, v41
    v_exp_f32 v42, v42
    v_mfma_f32_16x16x32_bf16 a[12:15], a[76:79], v[84:87], a[12:15]
    v_cvt_pk_bf16_f32 v92, v40, v41
    v_exp_f32 v43, v43
    v_mfma_f32_16x16x32_bf16 a[8:11], a[72:75], v[84:87], a[8:11]
    ds_read_b64_tr_b16 a[222:223], v67 offset:2048
    buffer_load_dwordx4 v1, s[12:15], s36 offen offset:3072 sc1 lds
    v_mfma_f32_16x16x32_bf16 a[204:207], a[236:239], v[188:191], a[204:207]
    s_add_u32 s36, s36, 0x4000
    v_exp_f32 v44, v44
    v_cvt_pk_bf16_f32 v93, v42, v43
    v_mfma_f32_16x16x32_bf16 a[200:203], a[232:235], v[188:191], a[200:203]
    s_add_u32 s37, s37, 0x4000
    v_exp_f32 v45, v45
    v_mfma_f32_16x16x32_bf16 a[196:199], a[228:231], v[188:191], a[196:199]
    s_and_b32 s37, s37, 0xffff
    v_exp_f32 v46, v46
    v_exp_f32 v47, v47
    v_mfma_f32_16x16x32_bf16 a[192:195], a[224:227], v[188:191], a[192:195]
    s_cmp_lg_u32 s42, 0
    v_cvt_pk_bf16_f32 v94, v44, v45
    v_cvt_pk_bf16_f32 v95, v46, v47
    s_cbranch_scc1 L_k2_loop
    v_mfma_f32_16x16x32_bf16 v[32:35], a[48:51], a[248:251], v[56:59]
    ds_read_b128 a[56:59], v4 offset:4096
    v_exp_f32 v16, v16
    v_mfma_f32_16x16x32_bf16 v[40:43], a[48:51], a[252:255], v[60:63]
    v_exp_f32 v17, v17
    v_mfma_f32_16x16x32_bf16 v[44:47], a[52:55], a[252:255], v[60:63]
    buffer_load_dwordx4 v[176:179], v122, s[24:27], s39 offen offset:0 sc1
    v_exp_f32 v18, v18
    v_mfma_f32_16x16x32_bf16 v[36:39], a[52:55], a[248:251], v[56:59]
    s_waitcnt vmcnt(17) lgkmcnt(1)
    v_cvt_pk_bf16_f32 v80, v16, v17
    v_exp_f32 v19, v19
    v_mfma_f32_16x16x32_bf16 a[80:83], a[208:211], v[128:131], a[80:83]
    ds_read_b128 a[60:63], v4 offset:5120
    v_exp_f32 v20, v20
    v_mfma_f32_16x16x32_bf16 a[84:87], a[212:215], v[128:131], a[84:87]
    v_cvt_pk_bf16_f32 v81, v18, v19
    v_exp_f32 v21, v21
    v_mfma_f32_16x16x32_bf16 a[88:91], a[216:219], v[128:131], a[88:91]
    buffer_load_dwordx4 v[180:183], v122, s[24:27], s39 offen offset:1024 sc1
    v_exp_f32 v22, v22
    v_mfma_f32_16x16x32_bf16 a[92:95], a[220:223], v[128:131], a[92:95]
    v_cvt_pk_bf16_f32 v82, v20, v21
    v_exp_f32 v23, v23
    v_mfma_f32_16x16x32_bf16 a[16:19], a[72:75], v[88:91], a[16:19]
    v_exp_f32 v24, v24
    v_mfma_f32_16x16x32_bf16 a[20:23], a[76:79], v[88:91], a[20:23]
    ds_read_b128 a[64:67], v4 offset:2048
    v_cvt_pk_bf16_f32 v83, v22, v23
    v_mfma_f32_16x16x32_bf16 a[40:43], v[112:115], v[88:91], a[40:43]
    v_exp_f32 v25, v25
    v_mfma_f32_16x16x32_bf16 a[44:47], v[112:115], v[92:95], a[44:47]
    buffer_load_dwordx4 v[184:187], v123, s[24:27], s39 offen offset:0 sc1
    v_exp_f32 v26, v26
    v_mfma_f32_16x16x32_bf16 a[28:31], a[76:79], v[92:95], a[28:31]
    v_cvt_pk_bf16_f32 v84, v24, v25
    v_exp_f32 v27, v27
    v_mfma_f32_16x16x32_bf16 a[24:27], a[72:75], v[92:95], a[24:27]
    ds_read_b128 a[68:71], v4 offset:3072
    v_exp_f32 v28, v28
    v_mfma_f32_16x16x32_bf16 a[108:111], a[220:223], v[132:135], a[108:111]
    v_cvt_pk_bf16_f32 v85, v26, v27
    v_exp_f32 v29, v29
    v_mfma_f32_16x16x32_bf16 a[104:107], a[216:219], v[132:135], a[104:107]
    buffer_load_dwordx4 v[188:191], v123, s[24:27], s39 offen offset:1024 sc1
    v_exp_f32 v30, v30
    v_mfma_f32_16x16x32_bf16 a[100:103], a[212:215], v[132:135], a[100:103]
    s_add_u32 s39, s39, 0x2000
    v_exp_f32 v31, v31
    v_mfma_f32_16x16x32_bf16 a[96:99], a[208:211], v[132:135], a[96:99]
    s_waitcnt lgkmcnt(2)
    v_cvt_pk_bf16_f32 v86, v28, v29
    v_cvt_pk_bf16_f32 v87, v30, v31
    v_mfma_f32_16x16x32_bf16 v[16:19], a[56:59], a[240:243], v[48:51]
    s_nop 0
    ds_read_b64_tr_b16 a[224:225], v64 offset:4096
    v_lshlrev_b32 v6, 11, v0
    v_mfma_f32_16x16x32_bf16 v[24:27], a[56:59], a[244:247], v[52:55]
    s_and_b32 s3, s46, 3
    v_exp_f32 v32, v32
    v_exp_f32 v33, v33
    v_mfma_f32_16x16x32_bf16 v[28:31], a[60:63], a[244:247], v[52:55]
    s_lshl_b32 s3, s3, 2
    v_exp_f32 v34, v34
    v_mfma_f32_16x16x32_bf16 v[20:23], a[60:63], a[240:243], v[48:51]
    s_add_u32 s3, s3, s45
    v_cvt_pk_bf16_f32 v88, v32, v33
    v_exp_f32 v35, v35
    v_mfma_f32_16x16x32_bf16 a[112:115], a[208:211], v[136:139], a[112:115]
    ds_read_b64_tr_b16 a[226:227], v64 offset:6144
    v_exp_f32 v36, v36
    v_mfma_f32_16x16x32_bf16 a[116:119], a[212:215], v[136:139], a[116:119]
    s_lshl_b32 s3, s3, 17
    v_cvt_pk_bf16_f32 v89, v34, v35
    v_exp_f32 v37, v37
    v_mfma_f32_16x16x32_bf16 a[120:123], a[216:219], v[136:139], a[120:123]
    v_exp_f32 v38, v38
    v_mfma_f32_16x16x32_bf16 a[124:127], a[220:223], v[136:139], a[124:127]
    s_waitcnt lgkmcnt(2)
    v_cvt_pk_bf16_f32 v90, v36, v37
    v_exp_f32 v39, v39
    v_mfma_f32_16x16x32_bf16 a[0:3], a[64:67], v[80:83], a[0:3]
    v_exp_f32 v40, v40
    v_mfma_f32_16x16x32_bf16 a[4:7], a[68:71], v[80:83], a[4:7]
    ds_read_b64_tr_b16 a[228:229], v65 offset:4096
    v_cvt_pk_bf16_f32 v91, v38, v39
    v_mfma_f32_16x16x32_bf16 a[32:35], v[112:115], v[80:83], a[32:35]
    v_exp_f32 v41, v41
    v_mfma_f32_16x16x32_bf16 a[36:39], v[112:115], v[84:87], a[36:39]
    buffer_load_dword v7, v6, s[32:35], s3 offen
    v_exp_f32 v42, v42
    v_mfma_f32_16x16x32_bf16 a[12:15], a[68:71], v[84:87], a[12:15]
    v_cvt_pk_bf16_f32 v92, v40, v41
    v_exp_f32 v43, v43
    v_mfma_f32_16x16x32_bf16 a[8:11], a[64:67], v[84:87], a[8:11]
    ds_read_b64_tr_b16 a[230:231], v65 offset:6144
    v_exp_f32 v44, v44
    v_mfma_f32_16x16x32_bf16 a[140:143], a[220:223], v[140:143], a[140:143]
    v_cvt_pk_bf16_f32 v93, v42, v43
    v_exp_f32 v45, v45
    v_mfma_f32_16x16x32_bf16 a[136:139], a[216:219], v[140:143], a[136:139]
    v_exp_f32 v46, v46
    v_mfma_f32_16x16x32_bf16 a[132:135], a[212:215], v[140:143], a[132:135]
    v_exp_f32 v47, v47
    v_mfma_f32_16x16x32_bf16 a[128:131], a[208:211], v[140:143], a[128:131]
    v_cvt_pk_bf16_f32 v94, v44, v45
    v_cvt_pk_bf16_f32 v95, v46, v47
L_ct_here:
    v_mfma_f32_16x16x32_bf16 v[32:35], a[56:59], a[248:251], v[56:59]
    ds_read_b128 a[48:51], v4 offset:8192
    v_exp_f32 v16, v16
    v_mfma_f32_16x16x32_bf16 v[40:43], a[56:59], a[252:255], v[60:63]
    v_exp_f32 v17, v17
    v_mfma_f32_16x16x32_bf16 v[44:47], a[60:63], a[252:255], v[60:63]
    v_exp_f32 v18, v18
    v_mfma_f32_16x16x32_bf16 v[36:39], a[60:63], a[248:251], v[56:59]
    s_waitcnt vmcnt(17)
    v_cvt_pk_bf16_f32 v80, v16, v17
    v_exp_f32 v19, v19
    v_mfma_f32_16x16x32_bf16 a[144:147], a[208:211], v[144:147], a[144:147]
    ds_read_b128 a[52:55], v4 offset:9216
    v_exp_f32 v20, v20
    v_mfma_f32_16x16x32_bf16 a[148:151], a[212:215], v[144:147], a[148:151]
    v_cvt_pk_bf16_f32 v81, v18, v19
    v_exp_f32 v21, v21
    v_mfma_f32_16x16x32_bf16 a[152:155], a[216:219], v[144:147], a[152:155]
    v_exp_f32 v22, v22
    v_mfma_f32_16x16x32_bf16 a[156:159], a[220:223], v[144:147], a[156:159]
    v_cvt_pk_bf16_f32 v82, v20, v21
    v_exp_f32 v23, v23
    v_mfma_f32_16x16x32_bf16 a[16:19], a[64:67], v[88:91], a[16:19]
    v_exp_f32 v24, v24
    v_mfma_f32_16x16x32_bf16 a[20:23], a[68:71], v[88:91], a[20:23]
    ds_read_b128 a[72:75], v4 offset:6144
    v_cvt_pk_bf16_f32 v83, v22, v23
    v_mfma_f32_16x16x32_bf16 a[40:43], v[112:115], v[88:91], a[40:43]
    v_exp_f32 v25, v25
    v_mfma_f32_16x16x32_bf16 a[44:47], v[112:115], v[92:95], a[44:47]
    v_exp_f32 v26, v26
    v_mfma_f32_16x16x32_bf16 a[28:31], a[68:71], v[92:95], a[28:31]
    v_cvt_pk_bf16_f32 v84, v24, v25
    v_exp_f32 v27, v27
    v_mfma_f32_16x16x32_bf16 a[24:27], a[64:67], v[92:95], a[24:27]
    ds_read_b128 a[76:79], v4 offset:7168
    v_exp_f32 v28, v28
    v_mfma_f32_16x16x32_bf16 a[172:175], a[220:223], v[148:151], a[172:175]
    v_cvt_pk_bf16_f32 v85, v26, v27
    v_exp_f32 v29, v29
    v_mfma_f32_16x16x32_bf16 a[168:171], a[216:219], v[148:151], a[168:171]
    v_exp_f32 v30, v30
    v_mfma_f32_16x16x32_bf16 a[164:167], a[212:215], v[148:151], a[164:167]
    v_exp_f32 v31, v31
    v_mfma_f32_16x16x32_bf16 a[160:163], a[208:211], v[148:151], a[160:163]
    s_waitcnt lgkmcnt(2)
    v_cvt_pk_bf16_f32 v86, v28, v29
    v_cvt_pk_bf16_f32 v87, v30, v31
    v_mfma_f32_16x16x32_bf16 v[16:19], a[48:51], a[240:243], v[48:51]
    ds_read_b64_tr_b16 a[232:233], v66 offset:4096
    v_exp_f32 v32, v32
    v_mfma_f32_16x16x32_bf16 v[24:27], a[48:51], a[244:247], v[52:55]
    s_add_u32 s38, s38, 0x4000
    v_exp_f32 v33, v33
    v_mfma_f32_16x16x32_bf16 v[28:31], a[52:55], a[244:247], v[52:55]
    s_and_b32 s38, s38, 0xffff
    v_exp_f32 v34, v34
    v_mfma_f32_16x16x32_bf16 v[20:23], a[52:55], a[240:243], v[48:51]
    v_cvt_pk_bf16_f32 v88, v32, v33
    v_exp_f32 v35, v35
    v_mfma_f32_16x16x32_bf16 a[176:179], a[208:211], v[152:155], a[176:179]
    ds_read_b64_tr_b16 a[234:235], v66 offset:6144
    v_exp_f32 v36, v36
    v_mfma_f32_16x16x32_bf16 a[180:183], a[212:215], v[152:155], a[180:183]
    v_cvt_pk_bf16_f32 v89, v34, v35
    v_exp_f32 v37, v37
    v_mfma_f32_16x16x32_bf16 a[184:187], a[216:219], v[152:155], a[184:187]
    v_exp_f32 v38, v38
    v_mfma_f32_16x16x32_bf16 a[188:191], a[220:223], v[152:155], a[188:191]
    s_waitcnt lgkmcnt(2)
    v_cvt_pk_bf16_f32 v90, v36, v37
    v_exp_f32 v39, v39
    v_mfma_f32_16x16x32_bf16 a[0:3], a[72:75], v[80:83], a[0:3]
    v_exp_f32 v40, v40
    v_mfma_f32_16x16x32_bf16 a[4:7], a[76:79], v[80:83], a[4:7]
    ds_read_b64_tr_b16 a[236:237], v67 offset:4096
    v_cvt_pk_bf16_f32 v91, v38, v39
    v_mfma_f32_16x16x32_bf16 a[32:35], v[112:115], v[80:83], a[32:35]
    v_exp_f32 v41, v41
    v_mfma_f32_16x16x32_bf16 a[36:39], v[112:115], v[84:87], a[36:39]
    v_exp_f32 v42, v42
    v_mfma_f32_16x16x32_bf16 a[12:15], a[76:79], v[84:87], a[12:15]
    v_cvt_pk_bf16_f32 v92, v40, v41
    v_exp_f32 v43, v43
    v_mfma_f32_16x16x32_bf16 a[8:11], a[72:75], v[84:87], a[8:11]
    ds_read_b64_tr_b16 a[238:239], v67 offset:6144
    v_exp_f32 v44, v44
    v_mfma_f32_16x16x32_bf16 a[204:207], a[220:223], v[156:159], a[204:207]
    v_cvt_pk_bf16_f32 v93, v42, v43
    v_exp_f32 v45, v45
    v_mfma_f32_16x16x32_bf16 a[200:203], a[216:219], v[156:159], a[200:203]
    v_exp_f32 v46, v46
    v_mfma_f32_16x16x32_bf16 a[196:199], a[212:215], v[156:159], a[196:199]
    v_exp_f32 v47, v47
    v_mfma_f32_16x16x32_bf16 a[192:195], a[208:211], v[156:159], a[192:195]
    v_cvt_pk_bf16_f32 v94, v44, v45
    v_cvt_pk_bf16_f32 v95, v46, v47
    v_mfma_f32_16x16x32_bf16 v[32:35], a[48:51], a[248:251], v[56:59]
    ds_read_b128 a[56:59], v4 offset:12288
    v_exp_f32 v16, v16
    v_mfma_f32_16x16x32_bf16 v[40:43], a[48:51], a[252:255], v[60:63]
    v_exp_f32 v17, v17
    v_mfma_f32_16x16x32_bf16 v[44:47], a[52:55], a[252:255], v[60:63]
    v_exp_f32 v18, v18
    v_mfma_f32_16x16x32_bf16 v[36:39], a[52:55], a[248:251], v[56:59]
    s_waitcnt vmcnt(9) lgkmcnt(1)
    v_cvt_pk_bf16_f32 v80, v16, v17
    v_exp_f32 v19, v19
    v_mfma_f32_16x16x32_bf16 a[80:83], a[224:227], v[160:163], a[80:83]
    ds_read_b128 a[60:63], v4 offset:13312
    v_exp_f32 v20, v20
    v_mfma_f32_16x16x32_bf16 a[84:87], a[228:231], v[160:163], a[84:87]
    v_cvt_pk_bf16_f32 v81, v18, v19
    v_exp_f32 v21, v21
    v_mfma_f32_16x16x32_bf16 a[88:91], a[232:235], v[160:163], a[88:91]
    v_exp_f32 v22, v22
    v_mfma_f32_16x16x32_bf16 a[92:95], a[236:239], v[160:163], a[92:95]
    v_cvt_pk_bf16_f32 v82, v20, v21
    v_exp_f32 v23, v23
    v_mfma_f32_16x16x32_bf16 a[16:19], a[72:75], v[88:91], a[16:19]
    v_exp_f32 v24, v24
    v_mfma_f32_16x16x32_bf16 a[20:23], a[76:79], v[88:91], a[20:23]
    ds_read_b128 a[64:67], v4 offset:10240
    v_cvt_pk_bf16_f32 v83, v22, v23
    v_mfma_f32_16x16x32_bf16 a[40:43], v[112:115], v[88:91], a[40:43]
    v_exp_f32 v25, v25
    v_mfma_f32_16x16x32_bf16 a[44:47], v[112:115], v[92:95], a[44:47]
    v_exp_f32 v26, v26
    v_mfma_f32_16x16x32_bf16 a[28:31], a[76:79], v[92:95], a[28:31]
    v_cvt_pk_bf16_f32 v84, v24, v25
    v_exp_f32 v27, v27
    v_mfma_f32_16x16x32_bf16 a[24:27], a[72:75], v[92:95], a[24:27]
    ds_read_b128 a[68:71], v4 offset:11264
    v_exp_f32 v28, v28
    v_mfma_f32_16x16x32_bf16 a[108:111], a[236:239], v[164:167], a[108:111]
    v_cvt_pk_bf16_f32 v85, v26, v27
    v_exp_f32 v29, v29
    v_mfma_f32_16x16x32_bf16 a[104:107], a[232:235], v[164:167], a[104:107]
    v_exp_f32 v30, v30
    v_mfma_f32_16x16x32_bf16 a[100:103], a[228:231], v[164:167], a[100:103]
    v_exp_f32 v31, v31
    v_mfma_f32_16x16x32_bf16 a[96:99], a[224:227], v[164:167], a[96:99]
    s_waitcnt lgkmcnt(2)
    v_cvt_pk_bf16_f32 v86, v28, v29
    v_cvt_pk_bf16_f32 v87, v30, v31
    v_mfma_f32_16x16x32_bf16 v[16:19], a[56:59], a[240:243], v[48:51]
    v_exp_f32 v32, v32
    v_mfma_f32_16x16x32_bf16 v[24:27], a[56:59], a[244:247], v[52:55]
    v_exp_f32 v33, v33
    v_mfma_f32_16x16x32_bf16 v[28:31], a[60:63], a[244:247], v[52:55]
    v_exp_f32 v34, v34
    v_cvt_pk_bf16_f32 v88, v32, v33
    v_mfma_f32_16x16x32_bf16 v[20:23], a[60:63], a[240:243], v[48:51]
    v_exp_f32 v35, v35
    v_mfma_f32_16x16x32_bf16 a[112:115], a[224:227], v[168:171], a[112:115]
    v_exp_f32 v36, v36
    v_mfma_f32_16x16x32_bf16 a[116:119], a[228:231], v[168:171], a[116:119]
    v_cvt_pk_bf16_f32 v89, v34, v35
    v_exp_f32 v37, v37
    v_mfma_f32_16x16x32_bf16 a[120:123], a[232:235], v[168:171], a[120:123]
    v_exp_f32 v38, v38
    v_mfma_f32_16x16x32_bf16 a[124:127], a[236:239], v[168:171], a[124:127]
    s_waitcnt lgkmcnt(0)
    v_cvt_pk_bf16_f32 v90, v36, v37
    v_exp_f32 v39, v39
    v_mfma_f32_16x16x32_bf16 a[0:3], a[64:67], v[80:83], a[0:3]
    v_exp_f32 v40, v40
    v_mfma_f32_16x16x32_bf16 a[4:7], a[68:71], v[80:83], a[4:7]
    v_cvt_pk_bf16_f32 v91, v38, v39
    v_exp_f32 v41, v41
    v_mfma_f32_16x16x32_bf16 a[32:35], v[112:115], v[80:83], a[32:35]
    v_exp_f32 v42, v42
    v_mfma_f32_16x16x32_bf16 a[36:39], v[112:115], v[84:87], a[36:39]
    v_cvt_pk_bf16_f32 v92, v40, v41
    v_exp_f32 v43, v43
    v_mfma_f32_16x16x32_bf16 a[12:15], a[68:71], v[84:87], a[12:15]
    v_exp_f32 v44, v44
    v_mfma_f32_16x16x32_bf16 a[8:11], a[64:67], v[84:87], a[8:11]
    v_cvt_pk_bf16_f32 v93, v42, v43
    v_exp_f32 v45, v45
    v_mfma_f32_16x16x32_bf16 a[140:143], a[236:239], v[172:175], a[140:143]
    s_waitcnt vmcnt(5)
    v_exp_f32 v46, v46
    v_mfma_f32_16x16x32_bf16 a[136:139], a[232:235], v[172:175], a[136:139]
    s_barrier
    v_exp_f32 v47, v47
    v_mfma_f32_16x16x32_bf16 a[132:135], a[228:231], v[172:175], a[132:135]
    v_cvt_pk_bf16_f32 v94, v44, v45
    v_cvt_pk_bf16_f32 v95, v46, v47
    v_mfma_f32_16x16x32_bf16 a[128:131], a[224:227], v[172:175], a[128:131]
    v_mfma_f32_16x16x32_bf16 v[32:35], a[56:59], a[248:251], v[56:59]
    ds_read_b128 a[48:51], v5 offset:0
    v_exp_f32 v16, v16
    v_mfma_f32_16x16x32_bf16 v[40:43], a[56:59], a[252:255], v[60:63]
    s_add_u32 s3, s68, 0x0
    s_add_u32 m0, s49, 0x0
    v_exp_f32 v17, v17
    v_mfma_f32_16x16x32_bf16 v[44:47], a[60:63], a[252:255], v[60:63]
    buffer_load_dwordx4 v116, s[32:35], s3 offen offset:0 lds
    v_exp_f32 v18, v18
    v_mfma_f32_16x16x32_bf16 v[36:39], a[60:63], a[248:251], v[56:59]
    s_waitcnt vmcnt(2)
    v_cvt_pk_bf16_f32 v80, v16, v17
    v_exp_f32 v19, v19
    v_mfma_f32_16x16x32_bf16 a[144:147], a[224:227], v[176:179], a[144:147]
    ds_read_b128 a[52:55], v5 offset:1024
    v_exp_f32 v20, v20
    v_mfma_f32_16x16x32_bf16 a[148:151], a[228:231], v[176:179], a[148:151]
    ds_write_b128 v68, a[112:115] offset:0
    v_cvt_pk_bf16_f32 v81, v18, v19
    v_mfma_f32_16x16x32_bf16 a[152:155], a[232:235], v[176:179], a[152:155]
    buffer_load_dwordx4 v117, s[32:35], s3 offen offset:1024 lds
    v_exp_f32 v21, v21
    v_mfma_f32_16x16x32_bf16 a[156:159], a[236:239], v[176:179], a[156:159]
    v_exp_f32 v22, v22
    v_cvt_pk_bf16_f32 v82, v20, v21
    v_mfma_f32_16x16x32_bf16 a[16:19], a[64:67], v[88:91], a[16:19]
    ds_write_b128 v68, a[116:119] offset:1024
    v_exp_f32 v23, v23
    v_mfma_f32_16x16x32_bf16 a[20:23], a[68:71], v[88:91], a[20:23]
    ds_read_b128 a[72:75], v4 offset:14336
    v_exp_f32 v24, v24
    v_mfma_f32_16x16x32_bf16 a[40:43], v[112:115], v[88:91], a[40:43]
    v_cvt_pk_bf16_f32 v83, v22, v23
    v_exp_f32 v25, v25
    v_mfma_f32_16x16x32_bf16 a[44:47], v[112:115], v[92:95], a[44:47]
    buffer_load_dwordx4 v118, s[32:35], s3 offen offset:2048 lds
    v_exp_f32 v26, v26
    v_mfma_f32_16x16x32_bf16 a[28:31], a[68:71], v[92:95], a[28:31]
    ds_write_b128 v68, a[120:123] offset:2048
    v_cvt_pk_bf16_f32 v84, v24, v25
    v_exp_f32 v27, v27
    v_mfma_f32_16x16x32_bf16 a[24:27], a[64:67], v[92:95], a[24:27]
    ds_read_b128 a[76:79], v4 offset:15360
    v_exp_f32 v28, v28
    v_mfma_f32_16x16x32_bf16 a[172:175], a[236:239], v[180:183], a[172:175]
    v_cvt_pk_bf16_f32 v85, v26, v27
    v_exp_f32 v29, v29
    v_mfma_f32_16x16x32_bf16 a[168:171], a[232:235], v[180:183], a[168:171]
    buffer_load_dwordx4 v119, s[32:35], s3 offen offset:3072 lds
    v_exp_f32 v30, v30
    v_mfma_f32_16x16x32_bf16 a[164:167], a[228:231], v[180:183], a[164:167]
    ds_write_b128 v68, a[124:127] offset:3072
    v_exp_f32 v31, v31
    v_mfma_f32_16x16x32_bf16 a[160:163], a[224:227], v[180:183], a[160:163]
    s_waitcnt lgkmcnt(6)
    v_cvt_pk_bf16_f32 v86, v28, v29
    v_cvt_pk_bf16_f32 v87, v30, v31
    v_mfma_f32_16x16x32_bf16 v[16:19], a[48:51], a[240:243], v[48:51]
    ds_write_b128 v68, a[128:131] offset:4096
    v_mov_b32 v4, v5
    v_add_u32 v5, s38, v1
    v_mfma_f32_16x16x32_bf16 v[24:27], a[48:51], a[244:247], v[52:55]
    s_add_u32 s3, s68, 0x40000
    s_add_u32 m0, s49, 0x4000
    v_exp_f32 v32, v32
    v_mfma_f32_16x16x32_bf16 v[28:31], a[52:55], a[244:247], v[52:55]
    buffer_load_dwordx4 v116, s[32:35], s3 offen offset:0 lds
    v_exp_f32 v33, v33
    v_mfma_f32_16x16x32_bf16 v[20:23], a[52:55], a[240:243], v[48:51]
    v_exp_f32 v34, v34
    v_mfma_f32_16x16x32_bf16 a[176:179], a[224:227], v[184:187], a[176:179]
    ds_write_b128 v68, a[132:135] offset:5120
    v_cvt_pk_bf16_f32 v88, v32, v33
    v_exp_f32 v35, v35
    v_mfma_f32_16x16x32_bf16 a[180:183], a[228:231], v[184:187], a[180:183]
    v_exp_f32 v36, v36
    v_mfma_f32_16x16x32_bf16 a[184:187], a[232:235], v[184:187], a[184:187]
    buffer_load_dwordx4 v117, s[32:35], s3 offen offset:1024 lds
    v_cvt_pk_bf16_f32 v89, v34, v35
    v_mfma_f32_16x16x32_bf16 a[188:191], a[236:239], v[184:187], a[188:191]
    s_waitcnt lgkmcnt(3)
    v_exp_f32 v37, v37
    v_exp_f32 v38, v38
    v_mfma_f32_16x16x32_bf16 a[0:3], a[72:75], v[80:83], a[0:3]
    ds_write_b128 v68, a[136:139] offset:6144
    v_cvt_pk_bf16_f32 v90, v36, v37
    v_mfma_f32_16x16x32_bf16 a[4:7], a[76:79], v[80:83], a[4:7]
    v_exp_f32 v39, v39
    v_exp_f32 v40, v40
    v_mfma_f32_16x16x32_bf16 a[32:35], v[112:115], v[80:83], a[32:35]
    v_cvt_pk_bf16_f32 v91, v38, v39
    v_exp_f32 v41, v41
    v_mfma_f32_16x16x32_bf16 a[36:39], v[112:115], v[84:87], a[36:39]
    buffer_load_dwordx4 v118, s[32:35], s3 offen offset:2048 lds
    v_exp_f32 v42, v42
    v_mfma_f32_16x16x32_bf16 a[12:15], a[76:79], v[84:87], a[12:15]
    ds_write_b128 v68, a[140:143] offset:7168
    v_cvt_pk_bf16_f32 v92, v40, v41
    v_mfma_f32_16x16x32_bf16 a[8:11], a[72:75], v[84:87], a[8:11]
    v_exp_f32 v43, v43
    v_mfma_f32_16x16x32_bf16 a[204:207], a[236:239], v[188:191], a[204:207]
    v_exp_f32 v44, v44
    v_cvt_pk_bf16_f32 v93, v42, v43
    v_mfma_f32_16x16x32_bf16 a[200:203], a[232:235], v[188:191], a[200:203]
    buffer_load_dwordx4 v119, s[32:35], s3 offen offset:3072 lds
    v_exp_f32 v45, v45
    v_mfma_f32_16x16x32_bf16 a[196:199], a[228:231], v[188:191], a[196:199]
    v_exp_f32 v46, v46
    v_exp_f32 v47, v47
    v_mfma_f32_16x16x32_bf16 a[192:195], a[224:227], v[188:191], a[192:195]
    v_cvt_pk_bf16_f32 v94, v44, v45
    v_cvt_pk_bf16_f32 v95, v46, v47
    v_mfma_f32_16x16x32_bf16 v[32:35], a[48:51], a[248:251], v[56:59]
    s_waitcnt lgkmcnt(0)
    s_add_u32 s3, s68, 0xc0000
    s_add_u32 m0, s49, 0x10000
    ds_read_b128 a[56:59], v4 offset:4096
    v_exp_f32 v16, v16
    v_mfma_f32_16x16x32_bf16 v[40:43], a[48:51], a[252:255], v[60:63]
    s_barrier
    buffer_load_dwordx4 v116, s[32:35], s3 offen offset:0 lds
    v_exp_f32 v17, v17
    v_exp_f32 v18, v18
    v_cvt_pk_bf16_f32 v80, v16, v17
    v_mfma_f32_16x16x32_bf16 v[44:47], a[52:55], a[252:255], v[60:63]
    ds_read_b128 a[60:63], v4 offset:5120
    v_exp_f32 v19, v19
    v_exp_f32 v20, v20
    v_mfma_f32_16x16x32_bf16 v[36:39], a[52:55], a[248:251], v[56:59]
    ds_read_b128 v[128:131], v71 offset:0
    v_cvt_pk_bf16_f32 v81, v18, v19
    v_exp_f32 v21, v21
    v_exp_f32 v22, v22
    v_mfma_f32_16x16x32_bf16 a[16:19], a[72:75], v[88:91], a[16:19]
    ds_read_b128 v[132:135], v71 offset:1024
    buffer_load_dwordx4 v117, s[32:35], s3 offen offset:1024 lds
    v_cvt_pk_bf16_f32 v82, v20, v21
    v_exp_f32 v23, v23
    v_mfma_f32_16x16x32_bf16 a[20:23], a[76:79], v[88:91], a[20:23]
    ds_read_b128 a[64:67], v4 offset:2048
    v_exp_f32 v24, v24
    v_cvt_pk_bf16_f32 v83, v22, v23
    v_exp_f32 v25, v25
    v_mfma_f32_16x16x32_bf16 a[40:43], v[112:115], v[88:91], a[40:43]
    ds_read_b128 v[136:139], v71 offset:2048
    buffer_load_dwordx4 v118, s[32:35], s3 offen offset:2048 lds
    v_exp_f32 v26, v26
    v_cvt_pk_bf16_f32 v84, v24, v25
    v_mfma_f32_16x16x32_bf16 a[44:47], v[112:115], v[92:95], a[44:47]
    ds_read_b128 a[68:71], v4 offset:3072
    v_exp_f32 v27, v27
    v_exp_f32 v28, v28
    v_mfma_f32_16x16x32_bf16 a[28:31], a[76:79], v[92:95], a[28:31]
    buffer_load_dwordx4 v119, s[32:35], s3 offen offset:3072 lds
    v_cvt_pk_bf16_f32 v85, v26, v27
    v_exp_f32 v29, v29
    v_exp_f32 v30, v30
    v_mfma_f32_16x16x32_bf16 a[24:27], a[72:75], v[92:95], a[24:27]
    s_waitcnt lgkmcnt(5)
    ds_read_b128 v[140:143], v71 offset:3072
    v_exp_f32 v31, v31
    v_cvt_pk_bf16_f32 v86, v28, v29
    v_cvt_pk_bf16_f32 v87, v30, v31
    v_mfma_f32_16x16x32_bf16 v[16:19], a[56:59], a[240:243], v[48:51]
    s_add_u32 s3, s68, 0x80000
    s_add_u32 m0, s49, 0x8000
    ds_read_b128 v[144:147], v71 offset:4096
    v_exp_f32 v32, v32
    v_mfma_f32_16x16x32_bf16 v[24:27], a[56:59], a[244:247], v[52:55]
    buffer_load_dwordx4 v116, s[32:35], s3 offen offset:0 lds
    v_exp_f32 v33, v33
    v_exp_f32 v34, v34
    v_cvt_pk_bf16_f32 v88, v32, v33
    v_mfma_f32_16x16x32_bf16 v[28:31], a[60:63], a[244:247], v[52:55]
    ds_read_b128 v[148:151], v71 offset:5120
    v_exp_f32 v35, v35
    v_exp_f32 v36, v36
    v_mfma_f32_16x16x32_bf16 v[20:23], a[60:63], a[240:243], v[48:51]
    s_waitcnt lgkmcnt(3)
    buffer_load_dwordx4 v117, s[32:35], s3 offen offset:1024 lds
    v_cvt_pk_bf16_f32 v89, v34, v35
    v_exp_f32 v37, v37
    v_mfma_f32_16x16x32_bf16 a[0:3], a[64:67], v[80:83], a[0:3]
    ds_read_b128 v[152:155], v71 offset:6144
    v_exp_f32 v38, v38
    v_cvt_pk_bf16_f32 v90, v36, v37
    v_exp_f32 v39, v39
    v_mfma_f32_16x16x32_bf16 a[4:7], a[68:71], v[80:83], a[4:7]
    ds_read_b128 v[156:159], v71 offset:7168
    v_exp_f32 v40, v40
    v_cvt_pk_bf16_f32 v91, v38, v39
    v_mfma_f32_16x16x32_bf16 a[32:35], v[112:115], v[80:83], a[32:35]
    buffer_load_dwordx4 v118, s[32:35], s3 offen offset:2048 lds
    v_exp_f32 v41, v41
L_pw7:
    s_cbranch_execz L_pw10
    v_exp_f32 v42, v42
    v_mfma_f32_16x16x32_bf16 a[36:39], v[112:115], v[84:87], a[36:39]
    v_cvt_pk_bf16_f32 v92, v40, v41
    v_exp_f32 v43, v43
    v_exp_f32 v44, v44
    v_mfma_f32_16x16x32_bf16 a[12:15], a[68:71], v[84:87], a[12:15]
    buffer_load_dwordx4 v119, s[32:35], s3 offen offset:3072 lds
    v_cvt_pk_bf16_f32 v93, v42, v43
    v_exp_f32 v45, v45
    v_exp_f32 v46, v46
    v_mfma_f32_16x16x32_bf16 a[8:11], a[64:67], v[84:87], a[8:11]
    v_exp_f32 v47, v47
    v_cvt_pk_bf16_f32 v94, v44, v45
    v_cvt_pk_bf16_f32 v95, v46, v47
    v_mfma_f32_16x16x32_bf16 v[32:35], a[56:59], a[248:251], v[56:59]
    s_waitcnt lgkmcnt(0)
    s_add_u32 s3, s68, 0x100000
    s_add_u32 m0, s49, 0x14000
    ds_read_b128 a[48:51], v4 offset:8192
    v_exp_f32 v16, v16
    v_mfma_f32_16x16x32_bf16 v[40:43], a[56:59], a[252:255], v[60:63]
    s_barrier
    buffer_load_dwordx4 v116, s[32:35], s3 offen offset:0 lds
    v_exp_f32 v17, v17
    v_exp_f32 v18, v18
    v_mfma_f32_16x16x32_bf16 v[44:47], a[60:63], a[252:255], v[60:63]
    ds_read_b128 a[52:55], v4 offset:9216
    v_cvt_pk_bf16_f32 v80, v16, v17
    v_exp_f32 v19, v19
    v_exp_f32 v20, v20
    v_mfma_f32_16x16x32_bf16 v[36:39], a[60:63], a[248:251], v[56:59]
    buffer_load_dwordx4 v117, s[32:35], s3 offen offset:1024 lds
    v_cvt_pk_bf16_f32 v81, v18, v19
    v_exp_f32 v21, v21
    v_mfma_f32_16x16x32_bf16 a[16:19], a[64:67], v[88:91], a[16:19]
    ds_write_b128 v69, a[144:147] offset:0
    v_exp_f32 v22, v22
    v_cvt_pk_bf16_f32 v82, v20, v21
    v_exp_f32 v23, v23
    v_mfma_f32_16x16x32_bf16 a[20:23], a[68:71], v[88:91], a[20:23]
    ds_read_b128 a[72:75], v4 offset:6144
    v_exp_f32 v24, v24
    v_cvt_pk_bf16_f32 v83, v22, v23
    v_exp_f32 v25, v25
    v_mfma_f32_16x16x32_bf16 a[40:43], v[112:115], v[88:91], a[40:43]
    buffer_load_dwordx4 v118, s[32:35], s3 offen offset:2048 lds
    v_exp_f32 v26, v26
    v_cvt_pk_bf16_f32 v84, v24, v25
    v_mfma_f32_16x16x32_bf16 a[44:47], v[112:115], v[92:95], a[44:47]
    ds_read_b128 a[76:79], v4 offset:7168
    v_exp_f32 v27, v27
    v_exp_f32 v28, v28
    v_cvt_pk_bf16_f32 v85, v26, v27
    v_mfma_f32_16x16x32_bf16 a[28:31], a[68:71], v[92:95], a[28:31]
    buffer_load_dwordx4 v119, s[32:35], s3 offen offset:3072 lds
    v_exp_f32 v29, v29
    v_exp_f32 v30, v30
    v_mfma_f32_16x16x32_bf16 a[24:27], a[64:67], v[92:95], a[24:27]
    s_waitcnt lgkmcnt(3)
    ds_write_b128 v69, a[148:151] offset:1024
    v_exp_f32 v31, v31
    v_cvt_pk_bf16_f32 v86, v28, v29
    v_cvt_pk_bf16_f32 v87, v30, v31
    v_mfma_f32_16x16x32_bf16 v[16:19], a[48:51], a[240:243], v[48:51]
    s_add_u32 s3, s68, 0x140000
    s_add_u32 m0, s49, 0x18000
    v_exp_f32 v32, v32
    v_exp_f32 v33, v33
    v_mfma_f32_16x16x32_bf16 v[24:27], a[48:51], a[244:247], v[52:55]
    buffer_load_dwordx4 v116, s[32:35], s3 offen offset:0 lds
    v_exp_f32 v34, v34
    v_cvt_pk_bf16_f32 v88, v32, v33
    v_mfma_f32_16x16x32_bf16 v[28:31], a[52:55], a[244:247], v[52:55]
    ds_write_b128 v69, a[152:155] offset:2048
    v_exp_f32 v35, v35
    v_exp_f32 v36, v36
    v_mfma_f32_16x16x32_bf16 v[20:23], a[52:55], a[240:243], v[48:51]
    s_waitcnt lgkmcnt(2)
    buffer_load_dwordx4 v117, s[32:35], s3 offen offset:1024 lds
    v_cvt_pk_bf16_f32 v89, v34, v35
    v_exp_f32 v37, v37
    v_exp_f32 v38, v38
    v_mfma_f32_16x16x32_bf16 a[0:3], a[72:75], v[80:83], a[0:3]
    v_cvt_pk_bf16_f32 v90, v36, v37
    v_exp_f32 v39, v39
    v_exp_f32 v40, v40
    v_mfma_f32_16x16x32_bf16 a[4:7], a[76:79], v[80:83], a[4:7]
    ds_write_b128 v69, a[156:159] offset:3072
    v_cvt_pk_bf16_f32 v91, v38, v39
    v_exp_f32 v41, v41
    v_mfma_f32_16x16x32_bf16 a[32:35], v[112:115], v[80:83], a[32:35]
    buffer_load_dwordx4 v118, s[32:35], s3 offen offset:2048 lds
    v_exp_f32 v42, v42
    v_cvt_pk_bf16_f32 v92, v40, v41
    v_mfma_f32_16x16x32_bf16 a[36:39], v[112:115], v[84:87], a[36:39]
    v_exp_f32 v43, v43
    v_exp_f32 v44, v44
    v_cvt_pk_bf16_f32 v93, v42, v43
    v_mfma_f32_16x16x32_bf16 a[12:15], a[76:79], v[84:87], a[12:15]
    buffer_load_dwordx4 v119, s[32:35], s3 offen offset:3072 lds
    v_exp_f32 v45, v45
    v_exp_f32 v46, v46
    v_mfma_f32_16x16x32_bf16 a[8:11], a[72:75], v[84:87], a[8:11]
    ds_write_b128 v69, a[160:163] offset:4096
    v_exp_f32 v47, v47
    v_cvt_pk_bf16_f32 v94, v44, v45
    v_cvt_pk_bf16_f32 v95, v46, v47
    v_mfma_f32_16x16x32_bf16 v[32:35], a[48:51], a[248:251], v[56:59]
    ds_read_b128 a[56:59], v4 offset:12288
    v_exp_f32 v16, v16
    v_exp_f32 v17, v17
    v_mfma_f32_16x16x32_bf16 v[40:43], a[48:51], a[252:255], v[60:63]
    ds_write_b128 v69, a[164:167] offset:5120
    v_exp_f32 v18, v18
    v_cvt_pk_bf16_f32 v80, v16, v17
    v_mfma_f32_16x16x32_bf16 v[44:47], a[52:55], a[252:255], v[60:63]
    ds_read_b128 a[60:63], v4 offset:13312
    v_exp_f32 v19, v19
    v_exp_f32 v20, v20
    v_mfma_f32_16x16x32_bf16 v[36:39], a[52:55], a[248:251], v[56:59]
    v_cvt_pk_bf16_f32 v81, v18, v19
    v_exp_f32 v21, v21
    v_exp_f32 v22, v22
    v_mfma_f32_16x16x32_bf16 a[16:19], a[72:75], v[88:91], a[16:19]
    ds_write_b128 v69, a[168:171] offset:6144
    v_cvt_pk_bf16_f32 v82, v20, v21
    v_exp_f32 v23, v23
    v_mfma_f32_16x16x32_bf16 a[20:23], a[76:79], v[88:91], a[20:23]
    ds_read_b128 a[64:67], v4 offset:10240
    v_exp_f32 v24, v24
    v_cvt_pk_bf16_f32 v83, v22, v23
    v_exp_f32 v25, v25
    v_mfma_f32_16x16x32_bf16 a[40:43], v[112:115], v[88:91], a[40:43]
    v_exp_f32 v26, v26
    v_cvt_pk_bf16_f32 v84, v24, v25
    v_mfma_f32_16x16x32_bf16 a[44:47], v[112:115], v[92:95], a[44:47]
    ds_read_b128 a[68:71], v4 offset:11264
    v_exp_f32 v27, v27
    v_exp_f32 v28, v28
    v_cvt_pk_bf16_f32 v85, v26, v27
    v_mfma_f32_16x16x32_bf16 a[28:31], a[76:79], v[92:95], a[28:31]
    ds_write_b128 v69, a[172:175] offset:7168
    v_exp_f32 v29, v29
    v_exp_f32 v30, v30
    v_mfma_f32_16x16x32_bf16 a[24:27], a[72:75], v[92:95], a[24:27]
    s_waitcnt lgkmcnt(4)
    v_exp_f32 v31, v31
    v_cvt_pk_bf16_f32 v86, v28, v29
    v_cvt_pk_bf16_f32 v87, v30, v31
    v_mfma_f32_16x16x32_bf16 v[16:19], a[56:59], a[240:243], v[48:51]
    s_add_u32 s3, s68, 0x180000
    s_add_u32 m0, s49, 0x1c000
    v_exp_f32 v32, v32
    v_exp_f32 v33, v33
    v_mfma_f32_16x16x32_bf16 v[24:27], a[56:59], a[244:247], v[52:55]
    s_waitcnt lgkmcnt(0)
    buffer_load_dwordx4 v116, s[32:35], s3 offen offset:0 lds
    v_exp_f32 v34, v34
    v_cvt_pk_bf16_f32 v88, v32, v33
    v_mfma_f32_16x16x32_bf16 v[28:31], a[60:63], a[244:247], v[52:55]
    s_barrier
    v_exp_f32 v35, v35
    v_exp_f32 v36, v36
    v_cvt_pk_bf16_f32 v89, v34, v35
    v_mfma_f32_16x16x32_bf16 v[20:23], a[60:63], a[240:243], v[48:51]
    s_nop 0
    buffer_load_dwordx4 v117, s[32:35], s3 offen offset:1024 lds
    v_exp_f32 v37, v37
    v_exp_f32 v38, v38
    v_cvt_pk_bf16_f32 v90, v36, v37
    v_mfma_f32_16x16x32_bf16 a[0:3], a[64:67], v[80:83], a[0:3]
    ds_read_b128 v[192:195], v71 offset:0
    v_exp_f32 v39, v39
    v_exp_f32 v40, v40
    v_mfma_f32_16x16x32_bf16 a[4:7], a[68:71], v[80:83], a[4:7]
    ds_read_b128 v[196:199], v71 offset:1024
    v_cvt_pk_bf16_f32 v91, v38, v39
    v_exp_f32 v41, v41
    v_mfma_f32_16x16x32_bf16 a[32:35], v[112:115], v[80:83], a[32:35]
    buffer_load_dwordx4 v118, s[32:35], s3 offen offset:2048 lds
    v_exp_f32 v42, v42
    v_cvt_pk_bf16_f32 v92, v40, v41
    v_exp_f32 v43, v43
    v_mfma_f32_16x16x32_bf16 a[36:39], v[112:115], v[84:87], a[36:39]
    ds_read_b128 v[200:203], v71 offset:2048
    v_exp_f32 v44, v44
    v_cvt_pk_bf16_f32 v93, v42, v43
    v_mfma_f32_16x16x32_bf16 a[12:15], a[68:71], v[84:87], a[12:15]
    buffer_load_dwordx4 v119, s[32:35], s3 offen offset:3072 lds
    v_exp_f32 v45, v45
    v_exp_f32 v46, v46
    v_mfma_f32_16x16x32_bf16 a[8:11], a[64:67], v[84:87], a[8:11]
    ds_read_b128 v[204:207], v71 offset:3072
    v_exp_f32 v47, v47
    v_cvt_pk_bf16_f32 v94, v44, v45
    v_cvt_pk_bf16_f32 v95, v46, v47
    v_mfma_f32_16x16x32_bf16 v[32:35], a[56:59], a[248:251], v[56:59]
    ds_read_b128 v[208:211], v71 offset:4096
    v_exp_f32 v16, v16
    v_exp_f32 v17, v17
    v_mfma_f32_16x16x32_bf16 v[40:43], a[56:59], a[252:255], v[60:63]
    ds_read_b128 v[212:215], v71 offset:5120
    v_exp_f32 v18, v18
    v_cvt_pk_bf16_f32 v80, v16, v17
    v_mfma_f32_16x16x32_bf16 v[44:47], a[60:63], a[252:255], v[60:63]
    ds_read_b128 v[216:219], v71 offset:6144
    v_exp_f32 v19, v19
    v_exp_f32 v20, v20
    v_mfma_f32_16x16x32_bf16 v[36:39], a[60:63], a[248:251], v[56:59]
    ds_read_b128 v[220:223], v71 offset:7168
    v_cvt_pk_bf16_f32 v81, v18, v19
    v_exp_f32 v21, v21
    v_mfma_f32_16x16x32_bf16 a[16:19], a[64:67], v[88:91], a[16:19]
    v_exp_f32 v22, v22
    v_cvt_pk_bf16_f32 v82, v20, v21
    v_exp_f32 v23, v23
    v_mfma_f32_16x16x32_bf16 a[20:23], a[68:71], v[88:91], a[20:23]
    ds_read_b128 a[72:75], v4 offset:14336
    v_exp_f32 v24, v24
    v_cvt_pk_bf16_f32 v83, v22, v23
    v_mfma_f32_16x16x32_bf16 a[40:43], v[112:115], v[88:91], a[40:43]
    v_exp_f32 v25, v25
    v_exp_f32 v26, v26
    v_cvt_pk_bf16_f32 v84, v24, v25
    v_mfma_f32_16x16x32_bf16 a[44:47], v[112:115], v[92:95], a[44:47]
    ds_read_b128 a[76:79], v4 offset:15360
    v_exp_f32 v27, v27
    v_exp_f32 v28, v28
    v_mfma_f32_16x16x32_bf16 a[28:31], a[68:71], v[92:95], a[28:31]
    v_cvt_pk_bf16_f32 v85, v26, v27
    v_exp_f32 v29, v29
    v_exp_f32 v30, v30
    v_mfma_f32_16x16x32_bf16 a[24:27], a[64:67], v[92:95], a[24:27]
    v_exp_f32 v31, v31
    v_cvt_pk_bf16_f32 v86, v28, v29
    v_cvt_pk_bf16_f32 v87, v30, v31
    s_waitcnt lgkmcnt(0)
    v_mfma_f32_16x16x32_bf16 a[0:3], a[72:75], v[80:83], a[0:3]
    s_nop 0
    v_exp_f32 v32, v32
    v_exp_f32 v33, v33
    v_exp_f32 v34, v34
    v_cvt_pk_bf16_f32 v88, v32, v33
    v_mfma_f32_16x16x32_bf16 a[4:7], a[76:79], v[80:83], a[4:7]
    s_barrier
    v_exp_f32 v35, v35
    v_exp_f32 v36, v36
    v_cvt_pk_bf16_f32 v89, v34, v35
    v_exp_f32 v37, v37
    v_mfma_f32_16x16x32_bf16 a[32:35], v[112:115], v[80:83], a[32:35]
    v_exp_f32 v38, v38
    v_cvt_pk_bf16_f32 v90, v36, v37
    v_exp_f32 v39, v39
    v_exp_f32 v40, v40
    v_mfma_f32_16x16x32_bf16 a[36:39], v[112:115], v[84:87], a[36:39]
    v_cvt_pk_bf16_f32 v91, v38, v39
    v_exp_f32 v41, v41
    v_exp_f32 v42, v42
    v_cvt_pk_bf16_f32 v92, v40, v41
    v_mfma_f32_16x16x32_bf16 a[12:15], a[76:79], v[84:87], a[12:15]
    v_exp_f32 v43, v43
    v_exp_f32 v44, v44
    v_cvt_pk_bf16_f32 v93, v42, v43
    v_exp_f32 v45, v45
    v_mfma_f32_16x16x32_bf16 a[8:11], a[72:75], v[84:87], a[8:11]
    v_exp_f32 v46, v46
    v_exp_f32 v47, v47
    v_cvt_pk_bf16_f32 v94, v44, v45
    v_cvt_pk_bf16_f32 v95, v46, v47
    s_mov_b32 s71, 0
    s_nop 0
    v_mfma_f32_16x16x32_bf16 a[16:19], a[72:75], v[88:91], a[16:19]
    v_mfma_f32_16x16x32_bf16 a[20:23], a[76:79], v[88:91], a[20:23]
    v_mfma_f32_16x16x32_bf16 a[40:43], v[112:115], v[88:91], a[40:43]
    v_mfma_f32_16x16x32_bf16 a[44:47], v[112:115], v[92:95], a[44:47]
    v_mfma_f32_16x16x32_bf16 a[28:31], a[76:79], v[92:95], a[28:31]
    v_mfma_f32_16x16x32_bf16 a[24:27], a[72:75], v[92:95], a[24:27]
L_k2_out:
    v_accvgpr_read_b32 v6, a32
    v_accvgpr_read_b32 v7, a36
    v_accvgpr_read_b32 v16, a0
    v_rcp_f32 v10, v6
    v_accvgpr_read_b32 v17, a1
    v_rcp_f32 v11, v7
    v_accvgpr_read_b32 v18, a2
    v_accvgpr_read_b32 v19, a3
    v_accvgpr_read_b32 v20, a4
    v_accvgpr_read_b32 v21, a5
    v_accvgpr_read_b32 v22, a6
    v_accvgpr_read_b32 v23, a7
    v_accvgpr_read_b32 v24, a8
    v_accvgpr_read_b32 v25, a9
    v_accvgpr_read_b32 v26, a10
    v_accvgpr_read_b32 v27, a11
    v_accvgpr_read_b32 v28, a12
    v_accvgpr_read_b32 v29, a13
    v_accvgpr_read_b32 v30, a14
    v_accvgpr_read_b32 v31, a15
    v_mul_f32 v16, v16, v10
    v_mul_f32 v17, v17, v10
    v_mul_f32 v18, v18, v10
    v_mul_f32 v19, v19, v10
    v_mul_f32 v20, v20, v10
    v_mul_f32 v21, v21, v10
    v_mul_f32 v22, v22, v10
    v_mul_f32 v23, v23, v10
    v_mul_f32 v24, v24, v11
    v_mul_f32 v25, v25, v11
    v_mul_f32 v26, v26, v11
    v_mul_f32 v27, v27, v11
    v_mul_f32 v28, v28, v11
    v_mul_f32 v29, v29, v11
    v_mul_f32 v30, v30, v11
    v_mul_f32 v31, v31, v11
    v_cvt_pk_bf16_f32 v80, v16, v17
    v_cvt_pk_bf16_f32 v81, v18, v19
    v_cvt_pk_bf16_f32 v82, v20, v21
    v_cvt_pk_bf16_f32 v83, v22, v23
    v_cvt_pk_bf16_f32 v84, v24, v25
    v_cvt_pk_bf16_f32 v85, v26, v27
    v_cvt_pk_bf16_f32 v86, v28, v29
    v_cvt_pk_bf16_f32 v87, v30, v31
    v_accvgpr_read_b32 v8, a40
    v_accvgpr_read_b32 v9, a44
    v_mov_b32 v2, 0x4e800000
    v_mov_b32 v3, 0x35800000
    v_add_f32 v10, v6, v7
    v_add_f32 v11, v8, v9
    v_add_f32 v10, v10, v11
    v_min3_f32 v11, v6, v7, v8
    v_min_f32 v11, v11, v9
    v_cmp_nlt_f32 vcc, v10, v2
    v_cmp_ngt_f32 s[6:7], v11, v3
    s_cmp_lg_u32 s71, 0
    s_cbranch_scc1 L_k2_safe
    s_or_b64 vcc, vcc, s[6:7]
    s_cbranch_vccnz L_k2_fallback
L_k2_safe:
    buffer_store_dwordx4 v[80:83], v1, s[20:23], 0 offen offset:0 sc1
    buffer_store_dwordx4 v[84:87], v1, s[20:23], 0 offen offset:1024 sc1
    v_accvgpr_read_b32 v8, a40
    v_accvgpr_read_b32 v9, a44
    v_accvgpr_read_b32 v32, a16
    v_rcp_f32 v10, v8
    v_accvgpr_read_b32 v33, a17
    v_rcp_f32 v11, v9
    v_accvgpr_read_b32 v34, a18
    v_accvgpr_read_b32 v35, a19
    v_accvgpr_read_b32 v36, a20
    v_accvgpr_read_b32 v37, a21
    v_accvgpr_read_b32 v38, a22
    v_accvgpr_read_b32 v39, a23
    v_accvgpr_read_b32 v40, a24
    v_accvgpr_read_b32 v41, a25
    v_accvgpr_read_b32 v42, a26
    v_accvgpr_read_b32 v43, a27
    v_accvgpr_read_b32 v44, a28
    v_accvgpr_read_b32 v45, a29
    v_accvgpr_read_b32 v46, a30
    v_accvgpr_read_b32 v47, a31
    v_mul_f32 v32, v32, v10
    v_mul_f32 v33, v33, v10
    v_mul_f32 v34, v34, v10
    v_mul_f32 v35, v35, v10
    v_mul_f32 v36, v36, v10
    v_mul_f32 v37, v37, v10
    v_mul_f32 v38, v38, v10
    v_mul_f32 v39, v39, v10
    v_mul_f32 v40, v40, v11
    v_mul_f32 v41, v41, v11
    v_mul_f32 v42, v42, v11
    v_mul_f32 v43, v43, v11
    v_mul_f32 v44, v44, v11
    v_mul_f32 v45, v45, v11
    v_mul_f32 v46, v46, v11
    v_mul_f32 v47, v47, v11
    v_cvt_pk_bf16_f32 v88, v32, v33
    v_cvt_pk_bf16_f32 v89, v34, v35
    v_cvt_pk_bf16_f32 v90, v36, v37
    v_cvt_pk_bf16_f32 v91, v38, v39
    v_cvt_pk_bf16_f32 v92, v40, v41
    v_cvt_pk_bf16_f32 v93, v42, v43
    v_cvt_pk_bf16_f32 v94, v44, v45
    v_cvt_pk_bf16_f32 v95, v46, v47
    buffer_store_dwordx4 v[88:91], v1, s[20:23], s50 offen offset:0 sc1
    buffer_store_dwordx4 v[92:95], v1, s[20:23], s50 offen offset:1024 sc1
    s_lshl_b32 s3, s46, 2
    s_add_u32 s3, s3, s45
    s_mul_i32 s3, s3, 69888
    s_add_u32 s3, s3, 0x2000000
    s_add_u32 s28, s4, s3
    s_addc_u32 s29, s5, 0
    s_and_b32 s29, s29, 0xffff
    s_mov_b32 s30, 0x10000
    s_mov_b32 s31, 0x20000
    v_and_b32 v64, 0xfff, v64
    v_and_b32 v65, 0xfff, v65
    v_and_b32 v66, 0xfff, v66
    v_and_b32 v67, 0xfff, v67
    s_lshl_b32 s3, s46, 18
    s_lshl_b32 s6, s45, 16
    s_add_u32 s3, s3, s6
    s_lshl_b32 s6, s47, 7
    s_add_u32 s3, s3, s6
    s_sub_u32 s7, 0x10000, s6
    s_add_u32 s20, s10, s3
    s_addc_u32 s21, s11, 0
    s_and_b32 s21, s21, 0xffff
    s_mov_b32 s22, s7
    s_mov_b32 s23, 0x20000
    s_add_u32 s24, s62, s3
    s_addc_u32 s25, s63, 0
    s_and_b32 s25, s25, 0xffff
    s_mov_b32 s26, s7
    s_mov_b32 s27, 0x20000
    s_mul_i32 s6, s45, 4608
    s_add_u32 s6, s6, 0x20000
    v_lshrrev_b32 v2, 3, v0
    v_and_b32 v4, 7, v0
    v_lshlrev_b32 v3, 4, v4
    v_lshl_add_u32 v3, v2, 11, v3
    v_and_b32 v10, 15, v0
    v_mul_u32_u24 v10, 144, v10
    v_lshrrev_b32 v11, 4, v0
    v_lshl_add_u32 v10, v11, 3, v10
    v_add_u32 v10, s6, v10
    v_mul_u32_u24 v11, 144, v2
    v_lshl_add_u32 v11, v4, 4, v11
    v_add_u32 v11, s6, v11
    s_mov_b32 s61, 0x4000
    s_mov_b32 s62, 0x8000
    s_mov_b32 s63, 0xc000
    buffer_load_dwordx4 v[96:99], v3, s[20:23], 0 offen
    buffer_load_dwordx4 v[100:103], v3, s[20:23], s61 offen
    buffer_load_dwordx4 v[104:107], v3, s[20:23], s62 offen
    buffer_load_dwordx4 v[108:111], v3, s[20:23], s63 offen
    ds_write_b128 v70, a[176:179] offset:0
    v_accvgpr_read_b32 v224, a80
    v_accvgpr_read_b32 v225, a81
    v_accvgpr_read_b32 v226, a82
    v_accvgpr_read_b32 v227, a83
    v_accvgpr_read_b32 v228, a84
    v_accvgpr_read_b32 v229, a85
    v_accvgpr_read_b32 v230, a86
    v_accvgpr_read_b32 v231, a87
    ds_write_b128 v70, a[180:183] offset:1024
    v_accvgpr_read_b32 v232, a88
    v_accvgpr_read_b32 v233, a89
    v_accvgpr_read_b32 v234, a90
    v_accvgpr_read_b32 v235, a91
    v_accvgpr_read_b32 v236, a92
    v_accvgpr_read_b32 v237, a93
    v_accvgpr_read_b32 v238, a94
    v_accvgpr_read_b32 v239, a95
    ds_write_b128 v70, a[184:187] offset:2048
    v_accvgpr_read_b32 v240, a96
    v_accvgpr_read_b32 v241, a97
    v_accvgpr_read_b32 v242, a98
    v_accvgpr_read_b32 v243, a99
    v_accvgpr_read_b32 v244, a100
    v_accvgpr_read_b32 v245, a101
    v_accvgpr_read_b32 v246, a102
    v_accvgpr_read_b32 v247, a103
    ds_write_b128 v70, a[188:191] offset:3072
    v_accvgpr_read_b32 v248, a104
    v_accvgpr_read_b32 v249, a105
    v_accvgpr_read_b32 v250, a106
    v_accvgpr_read_b32 v251, a107
    v_accvgpr_read_b32 v252, a108
    v_accvgpr_read_b32 v253, a109
    v_accvgpr_read_b32 v254, a110
    v_accvgpr_read_b32 v255, a111
    ds_write_b128 v70, a[192:195] offset:4096
    v_pk_add_f32 v[224:225], v[224:225], v[128:129]
    v_pk_add_f32 v[226:227], v[226:227], v[130:131]
    v_pk_add_f32 v[228:229], v[228:229], v[132:133]
    v_pk_add_f32 v[230:231], v[230:231], v[134:135]
    v_pk_add_f32 v[232:233], v[232:233], v[136:137]
    v_pk_add_f32 v[234:235], v[234:235], v[138:139]
    v_pk_add_f32 v[236:237], v[236:237], v[140:141]
    v_pk_add_f32 v[238:239], v[238:239], v[142:143]
    ds_write_b128 v70, a[196:199] offset:5120
    v_pk_add_f32 v[240:241], v[240:241], v[144:145]
    v_pk_add_f32 v[242:243], v[242:243], v[146:147]
    v_pk_add_f32 v[244:245], v[244:245], v[148:149]
    v_pk_add_f32 v[246:247], v[246:247], v[150:151]
    v_pk_add_f32 v[248:249], v[248:249], v[152:153]
    v_pk_add_f32 v[250:251], v[250:251], v[154:155]
    v_pk_add_f32 v[252:253], v[252:253], v[156:157]
    v_pk_add_f32 v[254:255], v[254:255], v[158:159]
    ds_write_b128 v70, a[200:203] offset:6144
    v_pk_add_f32 v[224:225], v[224:225], v[192:193]
    v_pk_add_f32 v[226:227], v[226:227], v[194:195]
    v_pk_add_f32 v[228:229], v[228:229], v[196:197]
    v_pk_add_f32 v[230:231], v[230:231], v[198:199]
    v_pk_add_f32 v[232:233], v[232:233], v[200:201]
    v_pk_add_f32 v[234:235], v[234:235], v[202:203]
    v_pk_add_f32 v[236:237], v[236:237], v[204:205]
    v_pk_add_f32 v[238:239], v[238:239], v[206:207]
    ds_write_b128 v70, a[204:207] offset:7168
    v_pk_add_f32 v[240:241], v[240:241], v[208:209]
    v_pk_add_f32 v[242:243], v[242:243], v[210:211]
    v_pk_add_f32 v[244:245], v[244:245], v[212:213]
    v_pk_add_f32 v[246:247], v[246:247], v[214:215]
    v_pk_add_f32 v[248:249], v[248:249], v[216:217]
    v_pk_add_f32 v[250:251], v[250:251], v[218:219]
    v_pk_add_f32 v[252:253], v[252:253], v[220:221]
    v_pk_add_f32 v[254:255], v[254:255], v[222:223]
    s_waitcnt vmcnt(4) lgkmcnt(0)
    s_barrier
    s_cmp_lg_u32 s45, 0
    s_cbranch_scc1 L_c4_ns
    v_mov_b32 v6, 4
    v_mov_b32 v7, 0
    s_mov_b64 exec, 1
    buffer_store_dword v6, v7, s[76:79], s73 offen sc1
    s_mov_b64 exec, -1
L_c4_ns:
    ds_read_b128 v[160:163], v71 offset:0
    ds_read_b128 v[164:167], v71 offset:1024
    ds_read_b128 v[168:171], v71 offset:2048
    ds_read_b128 v[172:175], v71 offset:3072
    ds_read_b128 v[176:179], v71 offset:4096
    ds_read_b128 v[180:183], v71 offset:5120
    ds_read_b128 v[184:187], v71 offset:6144
    ds_read_b128 v[188:191], v71 offset:7168
    s_add_u32 s3, s68, 0x1c0000
    s_add_u32 m0, s49, 0xc000
    s_nop 0
    buffer_load_dwordx4 v116, s[32:35], s3 offen offset:0 lds
    buffer_load_dwordx4 v117, s[32:35], s3 offen offset:1024 lds
    buffer_load_dwordx4 v118, s[32:35], s3 offen offset:2048 lds
    buffer_load_dwordx4 v119, s[32:35], s3 offen offset:3072 lds
    s_waitcnt lgkmcnt(0)
    v_pk_add_f32 v[224:225], v[224:225], v[160:161]
    v_pk_add_f32 v[226:227], v[226:227], v[162:163]
    v_pk_add_f32 v[228:229], v[228:229], v[164:165]
    v_pk_add_f32 v[230:231], v[230:231], v[166:167]
    v_pk_add_f32 v[232:233], v[232:233], v[168:169]
    v_pk_add_f32 v[234:235], v[234:235], v[170:171]
    v_pk_add_f32 v[236:237], v[236:237], v[172:173]
    v_pk_add_f32 v[238:239], v[238:239], v[174:175]
    v_pk_add_f32 v[240:241], v[240:241], v[176:177]
    v_pk_add_f32 v[242:243], v[242:243], v[178:179]
    v_pk_add_f32 v[244:245], v[244:245], v[180:181]
    v_pk_add_f32 v[246:247], v[246:247], v[182:183]
    v_pk_add_f32 v[248:249], v[248:249], v[184:185]
    v_pk_add_f32 v[250:251], v[250:251], v[186:187]
    v_pk_add_f32 v[252:253], v[252:253], v[188:189]
    v_pk_add_f32 v[254:255], v[254:255], v[190:191]
    v_pk_mul_f32 v[128:129], v[224:225], s[58:59]
    v_pk_mul_f32 v[130:131], v[226:227], s[58:59]
    v_pk_mul_f32 v[132:133], v[228:229], s[58:59]
    v_pk_mul_f32 v[134:135], v[230:231], s[58:59]
    v_pk_mul_f32 v[136:137], v[232:233], s[58:59]
    v_pk_mul_f32 v[138:139], v[234:235], s[58:59]
    v_pk_mul_f32 v[140:141], v[236:237], s[58:59]
    v_pk_mul_f32 v[142:143], v[238:239], s[58:59]
    v_pk_mul_f32 v[144:145], v[240:241], s[58:59]
    v_pk_mul_f32 v[146:147], v[242:243], s[58:59]
    v_pk_mul_f32 v[148:149], v[244:245], s[58:59]
    v_pk_mul_f32 v[150:151], v[246:247], s[58:59]
    v_pk_mul_f32 v[152:153], v[248:249], s[58:59]
    v_pk_mul_f32 v[154:155], v[250:251], s[58:59]
    v_pk_mul_f32 v[156:157], v[252:253], s[58:59]
    v_pk_mul_f32 v[158:159], v[254:255], s[58:59]
    v_exp_f32 v128, v128
    v_exp_f32 v129, v129
    v_exp_f32 v130, v130
    v_exp_f32 v131, v131
    v_exp_f32 v132, v132
    v_exp_f32 v133, v133
    v_exp_f32 v134, v134
    v_exp_f32 v135, v135
    v_exp_f32 v136, v136
    v_exp_f32 v137, v137
    v_exp_f32 v138, v138
    v_exp_f32 v139, v139
    v_exp_f32 v140, v140
    v_exp_f32 v141, v141
    v_exp_f32 v142, v142
    v_exp_f32 v143, v143
    v_exp_f32 v144, v144
    v_exp_f32 v145, v145
    v_exp_f32 v146, v146
    v_exp_f32 v147, v147
    v_exp_f32 v148, v148
    v_exp_f32 v149, v149
    v_exp_f32 v150, v150
    v_exp_f32 v151, v151
    v_exp_f32 v152, v152
    v_exp_f32 v153, v153
    v_exp_f32 v154, v154
    v_exp_f32 v155, v155
    v_exp_f32 v156, v156
    v_exp_f32 v157, v157
    v_exp_f32 v158, v158
    v_exp_f32 v159, v159
    ds_read_b64_tr_b16 v[192:193], v64 offset:0
    ds_read_b64_tr_b16 v[194:195], v64 offset:2048
    ds_read_b64_tr_b16 v[196:197], v65 offset:0
    ds_read_b64_tr_b16 v[198:199], v65 offset:2048
    ds_read_b64_tr_b16 v[200:201], v66 offset:0
    ds_read_b64_tr_b16 v[202:203], v66 offset:2048
    ds_read_b64_tr_b16 v[204:205], v67 offset:0
    ds_read_b64_tr_b16 v[206:207], v67 offset:2048
    ds_read_b64_tr_b16 v[208:209], v64 offset:4096
    ds_read_b64_tr_b16 v[210:211], v64 offset:6144
    ds_read_b64_tr_b16 v[212:213], v65 offset:4096
    ds_read_b64_tr_b16 v[214:215], v65 offset:6144
    ds_read_b64_tr_b16 v[216:217], v66 offset:4096
    ds_read_b64_tr_b16 v[218:219], v66 offset:6144
    ds_read_b64_tr_b16 v[220:221], v67 offset:4096
    ds_read_b64_tr_b16 v[222:223], v67 offset:6144
    s_mov_b32 s39, 0
    s_cmp_lg_u32 s45, 0
    s_cbranch_scc1 L_c_ok
    s_mov_b32 s70, 0x40000
    s_branch L_c_ld
L_c_ck:
    v_cmp_gt_u32 vcc, 4, v13
    s_sub_u32 s70, s70, 1
    s_cmp_eq_u32 s70, 0
    s_cbranch_scc1 L_c_ok
    s_nop 1
    s_cbranch_vccz L_c_ok
L_c_ld:
    buffer_load_dword v13, v12, s[76:79], s69 offen sc1
    s_waitcnt vmcnt(0)
    s_branch L_c_ck
L_c_ok:
    s_waitcnt vmcnt(0)
    s_barrier
    buffer_load_dwordx4 a[112:115], v1, s[28:31], s39 offen offset:0 sc1
    buffer_load_dwordx4 a[116:119], v1, s[28:31], s39 offen offset:1024 sc1
    buffer_load_dwordx4 a[120:123], v1, s[28:31], s39 offen offset:2048 sc1
    ds_write_b128 v11, v[96:99] offset:0
L_pw8:
    s_cbranch_execz L_pw11
    ds_write_b128 v11, v[100:103] offset:1152
    ds_write_b128 v11, v[104:107] offset:2304
    ds_write_b128 v11, v[108:111] offset:3456
    v_pk_add_f32 v[128:129], v[128:129], 1.0 op_sel_hi:[1,0]
    v_pk_add_f32 v[130:131], v[130:131], 1.0 op_sel_hi:[1,0]
    v_pk_add_f32 v[132:133], v[132:133], 1.0 op_sel_hi:[1,0]
    v_pk_add_f32 v[134:135], v[134:135], 1.0 op_sel_hi:[1,0]
    v_pk_add_f32 v[136:137], v[136:137], 1.0 op_sel_hi:[1,0]
    v_pk_add_f32 v[138:139], v[138:139], 1.0 op_sel_hi:[1,0]
    v_pk_add_f32 v[140:141], v[140:141], 1.0 op_sel_hi:[1,0]
    buffer_load_dwordx4 a[124:127], v1, s[28:31], s39 offen offset:3072 sc1
    v_pk_add_f32 v[142:143], v[142:143], 1.0 op_sel_hi:[1,0]
    v_pk_add_f32 v[144:145], v[144:145], 1.0 op_sel_hi:[1,0]
    v_pk_add_f32 v[146:147], v[146:147], 1.0 op_sel_hi:[1,0]
    v_pk_add_f32 v[148:149], v[148:149], 1.0 op_sel_hi:[1,0]
    v_pk_add_f32 v[150:151], v[150:151], 1.0 op_sel_hi:[1,0]
    v_pk_add_f32 v[152:153], v[152:153], 1.0 op_sel_hi:[1,0]
    v_pk_add_f32 v[154:155], v[154:155], 1.0 op_sel_hi:[1,0]
    v_pk_add_f32 v[156:157], v[156:157], 1.0 op_sel_hi:[1,0]
    v_pk_add_f32 v[158:159], v[158:159], 1.0 op_sel_hi:[1,0]
    s_waitcnt lgkmcnt(0)
    ds_read_b64 v[80:81], v10 offset:0
    s_add_u32 s39, s39, 0x1000
    buffer_load_dwordx4 a[128:131], v1, s[28:31], s39 offen offset:0 sc1
    ds_read_b64 v[82:83], v10 offset:32
    ds_read_b64 v[84:85], v10 offset:64
    ds_read_b64 v[86:87], v10 offset:96
    ds_read_b64 v[88:89], v10 offset:2304
    ds_read_b64 v[90:91], v10 offset:2336
    ds_read_b64 v[92:93], v10 offset:2368
    ds_read_b64 v[94:95], v10 offset:2400
    v_rcp_f32 v128, v128
    v_rcp_f32 v129, v129
    v_rcp_f32 v130, v130
    v_rcp_f32 v131, v131
    buffer_load_dwordx4 a[132:135], v1, s[28:31], s39 offen offset:1024 sc1
    v_rcp_f32 v132, v132
    v_rcp_f32 v133, v133
    v_rcp_f32 v134, v134
    v_rcp_f32 v135, v135
    v_rcp_f32 v136, v136
    v_rcp_f32 v137, v137
    v_rcp_f32 v138, v138
    v_rcp_f32 v139, v139
    v_rcp_f32 v140, v140
    v_rcp_f32 v141, v141
    v_rcp_f32 v142, v142
    buffer_load_dwordx4 a[136:139], v1, s[28:31], s39 offen offset:2048 sc1
    v_rcp_f32 v143, v143
    v_rcp_f32 v144, v144
    v_rcp_f32 v145, v145
    v_rcp_f32 v146, v146
    v_rcp_f32 v147, v147
    v_rcp_f32 v148, v148
    v_rcp_f32 v149, v149
    v_rcp_f32 v150, v150
    v_rcp_f32 v151, v151
    v_rcp_f32 v152, v152
    v_rcp_f32 v153, v153
    buffer_load_dwordx4 a[140:143], v1, s[28:31], s39 offen offset:3072 sc1
    v_rcp_f32 v154, v154
    v_rcp_f32 v155, v155
    v_rcp_f32 v156, v156
    v_rcp_f32 v157, v157
    v_rcp_f32 v158, v158
    v_rcp_f32 v159, v159
    v_pk_mul_f32 v[128:129], v[128:129], v[224:225]
    v_pk_mul_f32 v[130:131], v[130:131], v[226:227]
    v_pk_mul_f32 v[132:133], v[132:133], v[228:229]
    v_pk_mul_f32 v[134:135], v[134:135], v[230:231]
    v_pk_mul_f32 v[136:137], v[136:137], v[232:233]
    s_add_u32 s39, s39, 0x1000
    buffer_load_dwordx4 a[144:147], v1, s[28:31], s39 offen offset:0 sc1
    v_pk_mul_f32 v[138:139], v[138:139], v[234:235]
    v_pk_mul_f32 v[140:141], v[140:141], v[236:237]
    v_pk_mul_f32 v[142:143], v[142:143], v[238:239]
    v_pk_mul_f32 v[144:145], v[144:145], v[240:241]
    v_pk_mul_f32 v[146:147], v[146:147], v[242:243]
    v_pk_mul_f32 v[148:149], v[148:149], v[244:245]
    v_pk_mul_f32 v[150:151], v[150:151], v[246:247]
    v_pk_mul_f32 v[152:153], v[152:153], v[248:249]
    v_pk_mul_f32 v[154:155], v[154:155], v[250:251]
    v_pk_mul_f32 v[156:157], v[156:157], v[252:253]
    v_pk_mul_f32 v[158:159], v[158:159], v[254:255]
    buffer_load_dwordx4 a[148:151], v1, s[28:31], s39 offen offset:1024 sc1
    s_waitcnt lgkmcnt(0)
    v_lshlrev_b32 v160, 16, v80
    v_and_b32 v161, s51, v80
    v_lshlrev_b32 v162, 16, v81
    v_and_b32 v163, s51, v81
    v_lshlrev_b32 v164, 16, v82
    v_and_b32 v165, s51, v82
    v_lshlrev_b32 v166, 16, v83
    v_and_b32 v167, s51, v83
    v_lshlrev_b32 v168, 16, v84
    v_and_b32 v169, s51, v84
    buffer_load_dwordx4 a[152:155], v1, s[28:31], s39 offen offset:2048 sc1
    v_lshlrev_b32 v170, 16, v85
    v_and_b32 v171, s51, v85
    v_lshlrev_b32 v172, 16, v86
    v_and_b32 v173, s51, v86
    v_lshlrev_b32 v174, 16, v87
    v_and_b32 v175, s51, v87
    v_lshlrev_b32 v176, 16, v88
    v_and_b32 v177, s51, v88
    v_lshlrev_b32 v178, 16, v89
    v_and_b32 v179, s51, v89
    v_lshlrev_b32 v180, 16, v90
    buffer_load_dwordx4 a[156:159], v1, s[28:31], s39 offen offset:3072 sc1
    v_and_b32 v181, s51, v90
    v_lshlrev_b32 v182, 16, v91
    v_and_b32 v183, s51, v91
    v_lshlrev_b32 v184, 16, v92
    v_and_b32 v185, s51, v92
    v_lshlrev_b32 v186, 16, v93
    v_and_b32 v187, s51, v93
    v_lshlrev_b32 v188, 16, v94
    v_and_b32 v189, s51, v94
    v_lshlrev_b32 v190, 16, v95
    v_and_b32 v191, s51, v95
    s_waitcnt vmcnt(11)
    v_mfma_f32_16x16x32_bf16 v[16:19], v[192:195], a[112:115], 0
    ds_read_b64_tr_b16 v[48:49], v64 offset:8192
    v_mfma_f32_16x16x32_bf16 v[20:23], v[196:199], a[112:115], 0
    s_add_u32 s39, s39, 0x1000
    buffer_load_dwordx4 a[160:163], v1, s[28:31], s39 offen offset:0 sc1
    ds_read_b64_tr_b16 v[50:51], v64 offset:10240
    v_mfma_f32_16x16x32_bf16 v[24:27], v[200:203], a[112:115], 0
    ds_read_b64_tr_b16 v[52:53], v65 offset:8192
    v_mfma_f32_16x16x32_bf16 v[28:31], v[204:207], a[112:115], 0
    ds_read_b64_tr_b16 v[54:55], v65 offset:10240
    s_waitcnt vmcnt(11)
    v_mfma_f32_16x16x32_bf16 v[44:47], v[204:207], a[116:119], 0
    ds_read_b64_tr_b16 v[56:57], v66 offset:8192
    v_mfma_f32_16x16x32_bf16 v[40:43], v[200:203], a[116:119], 0
    buffer_load_dwordx4 a[164:167], v1, s[28:31], s39 offen offset:1024 sc1
    ds_read_b64_tr_b16 v[58:59], v66 offset:10240
    v_mfma_f32_16x16x32_bf16 v[36:39], v[196:199], a[116:119], 0
    ds_read_b64_tr_b16 v[60:61], v67 offset:8192
    v_mfma_f32_16x16x32_bf16 v[32:35], v[192:195], a[116:119], 0
    ds_read_b64_tr_b16 v[62:63], v67 offset:10240
    s_waitcnt vmcnt(11)
    v_mfma_f32_16x16x32_bf16 v[16:19], v[208:211], a[120:123], v[16:19]
    ds_read_b64_tr_b16 v[192:193], v64 offset:12288
    v_mfma_f32_16x16x32_bf16 v[20:23], v[212:215], a[120:123], v[20:23]
    buffer_load_dwordx4 a[168:171], v1, s[28:31], s39 offen offset:2048 sc1
    ds_read_b64_tr_b16 v[194:195], v64 offset:14336
    v_mfma_f32_16x16x32_bf16 v[24:27], v[216:219], a[120:123], v[24:27]
    ds_read_b64_tr_b16 v[196:197], v65 offset:12288
    v_mfma_f32_16x16x32_bf16 v[28:31], v[220:223], a[120:123], v[28:31]
    ds_read_b64_tr_b16 v[198:199], v65 offset:14336
    s_waitcnt vmcnt(11)
    v_mfma_f32_16x16x32_bf16 v[44:47], v[220:223], a[124:127], v[44:47]
    ds_read_b64_tr_b16 v[200:201], v66 offset:12288
    v_mfma_f32_16x16x32_bf16 v[40:43], v[216:219], a[124:127], v[40:43]
    buffer_load_dwordx4 a[172:175], v1, s[28:31], s39 offen offset:3072 sc1
    ds_read_b64_tr_b16 v[202:203], v66 offset:14336
    v_mfma_f32_16x16x32_bf16 v[36:39], v[212:215], a[124:127], v[36:39]
    ds_read_b64_tr_b16 v[204:205], v67 offset:12288
    v_mfma_f32_16x16x32_bf16 v[32:35], v[208:211], a[124:127], v[32:35]
    ds_read_b64_tr_b16 v[206:207], v67 offset:14336
    s_waitcnt vmcnt(11) lgkmcnt(8)
    v_mfma_f32_16x16x32_bf16 v[16:19], v[48:51], a[128:131], v[16:19]
    ds_read_b64_tr_b16 v[208:209], v64 offset:16384
    v_mfma_f32_16x16x32_bf16 v[20:23], v[52:55], a[128:131], v[20:23]
    s_add_u32 s39, s39, 0x1000
    buffer_load_dwordx4 a[176:179], v1, s[28:31], s39 offen offset:0 sc1
    ds_read_b64_tr_b16 v[210:211], v64 offset:18432
    v_mfma_f32_16x16x32_bf16 v[24:27], v[56:59], a[128:131], v[24:27]
    ds_read_b64_tr_b16 v[212:213], v65 offset:16384
    v_mfma_f32_16x16x32_bf16 v[28:31], v[60:63], a[128:131], v[28:31]
    ds_read_b64_tr_b16 v[214:215], v65 offset:18432
    s_waitcnt vmcnt(11)
    v_mfma_f32_16x16x32_bf16 v[44:47], v[60:63], a[132:135], v[44:47]
    ds_read_b64_tr_b16 v[216:217], v66 offset:16384
    v_mfma_f32_16x16x32_bf16 v[40:43], v[56:59], a[132:135], v[40:43]
    buffer_load_dwordx4 a[180:183], v1, s[28:31], s39 offen offset:1024 sc1
    ds_read_b64_tr_b16 v[218:219], v66 offset:18432
    v_mfma_f32_16x16x32_bf16 v[36:39], v[52:55], a[132:135], v[36:39]
    ds_read_b64_tr_b16 v[220:221], v67 offset:16384
    v_mfma_f32_16x16x32_bf16 v[32:35], v[48:51], a[132:135], v[32:35]
    ds_read_b64_tr_b16 v[222:223], v67 offset:18432
    s_waitcnt vmcnt(11) lgkmcnt(8)
    v_mfma_f32_16x16x32_bf16 v[16:19], v[192:195], a[136:139], v[16:19]
    ds_read_b64_tr_b16 v[48:49], v64 offset:20480
    v_mfma_f32_16x16x32_bf16 v[20:23], v[196:199], a[136:139], v[20:23]
    buffer_load_dwordx4 a[184:187], v1, s[28:31], s39 offen offset:2048 sc1
    ds_read_b64_tr_b16 v[50:51], v64 offset:22528
    v_mfma_f32_16x16x32_bf16 v[24:27], v[200:203], a[136:139], v[24:27]
    ds_read_b64_tr_b16 v[52:53], v65 offset:20480
    v_mfma_f32_16x16x32_bf16 v[28:31], v[204:207], a[136:139], v[28:31]
    ds_read_b64_tr_b16 v[54:55], v65 offset:22528
    s_waitcnt vmcnt(11)
    v_mfma_f32_16x16x32_bf16 v[44:47], v[204:207], a[140:143], v[44:47]
    ds_read_b64_tr_b16 v[56:57], v66 offset:20480
    v_mfma_f32_16x16x32_bf16 v[40:43], v[200:203], a[140:143], v[40:43]
    buffer_load_dwordx4 a[188:191], v1, s[28:31], s39 offen offset:3072 sc1
    ds_read_b64_tr_b16 v[58:59], v66 offset:22528
    v_mfma_f32_16x16x32_bf16 v[36:39], v[196:199], a[140:143], v[36:39]
    ds_read_b64_tr_b16 v[60:61], v67 offset:20480
    v_mfma_f32_16x16x32_bf16 v[32:35], v[192:195], a[140:143], v[32:35]
    ds_read_b64_tr_b16 v[62:63], v67 offset:22528
    s_waitcnt vmcnt(11) lgkmcnt(8)
    v_mfma_f32_16x16x32_bf16 v[16:19], v[208:211], a[144:147], v[16:19]
    ds_read_b64_tr_b16 v[192:193], v64 offset:24576
    v_mfma_f32_16x16x32_bf16 v[20:23], v[212:215], a[144:147], v[20:23]
    s_add_u32 s39, s39, 0x1000
    buffer_load_dwordx4 a[192:195], v1, s[28:31], s39 offen offset:0 sc1
    ds_read_b64_tr_b16 v[194:195], v64 offset:26624
    v_mfma_f32_16x16x32_bf16 v[24:27], v[216:219], a[144:147], v[24:27]
    ds_read_b64_tr_b16 v[196:197], v65 offset:24576
    v_mfma_f32_16x16x32_bf16 v[28:31], v[220:223], a[144:147], v[28:31]
    ds_read_b64_tr_b16 v[198:199], v65 offset:26624
    s_waitcnt vmcnt(11)
    v_mfma_f32_16x16x32_bf16 v[44:47], v[220:223], a[148:151], v[44:47]
    ds_read_b64_tr_b16 v[200:201], v66 offset:24576
    v_mfma_f32_16x16x32_bf16 v[40:43], v[216:219], a[148:151], v[40:43]
    buffer_load_dwordx4 a[196:199], v1, s[28:31], s39 offen offset:1024 sc1
    ds_read_b64_tr_b16 v[202:203], v66 offset:26624
    v_mfma_f32_16x16x32_bf16 v[36:39], v[212:215], a[148:151], v[36:39]
    ds_read_b64_tr_b16 v[204:205], v67 offset:24576
    v_mfma_f32_16x16x32_bf16 v[32:35], v[208:211], a[148:151], v[32:35]
    ds_read_b64_tr_b16 v[206:207], v67 offset:26624
    s_waitcnt vmcnt(11) lgkmcnt(8)
    v_mfma_f32_16x16x32_bf16 v[16:19], v[48:51], a[152:155], v[16:19]
    ds_read_b64_tr_b16 v[208:209], v64 offset:28672
    v_mfma_f32_16x16x32_bf16 v[20:23], v[52:55], a[152:155], v[20:23]
    buffer_load_dwordx4 a[200:203], v1, s[28:31], s39 offen offset:2048 sc1
    ds_read_b64_tr_b16 v[210:211], v64 offset:30720
    v_mfma_f32_16x16x32_bf16 v[24:27], v[56:59], a[152:155], v[24:27]
    ds_read_b64_tr_b16 v[212:213], v65 offset:28672
    v_mfma_f32_16x16x32_bf16 v[28:31], v[60:63], a[152:155], v[28:31]
    ds_read_b64_tr_b16 v[214:215], v65 offset:30720
    s_waitcnt vmcnt(11)
    v_mfma_f32_16x16x32_bf16 v[44:47], v[60:63], a[156:159], v[44:47]
    ds_read_b64_tr_b16 v[216:217], v66 offset:28672
    v_mfma_f32_16x16x32_bf16 v[40:43], v[56:59], a[156:159], v[40:43]
    buffer_load_dwordx4 a[204:207], v1, s[28:31], s39 offen offset:3072 sc1
    ds_read_b64_tr_b16 v[218:219], v66 offset:30720
    v_mfma_f32_16x16x32_bf16 v[36:39], v[52:55], a[156:159], v[36:39]
    ds_read_b64_tr_b16 v[220:221], v67 offset:28672
    v_mfma_f32_16x16x32_bf16 v[32:35], v[48:51], a[156:159], v[32:35]
    ds_read_b64_tr_b16 v[222:223], v67 offset:30720
    s_waitcnt vmcnt(11) lgkmcnt(8)
    v_mfma_f32_16x16x32_bf16 v[16:19], v[192:195], a[160:163], v[16:19]
    ds_read_b64_tr_b16 v[48:49], v64 offset:32768
    v_mfma_f32_16x16x32_bf16 v[20:23], v[196:199], a[160:163], v[20:23]
    s_add_u32 s39, s39, 0x1000
    buffer_load_dwordx4 a[208:211], v1, s[28:31], s39 offen offset:0 sc1
    ds_read_b64_tr_b16 v[50:51], v64 offset:34816
    v_mfma_f32_16x16x32_bf16 v[24:27], v[200:203], a[160:163], v[24:27]
    ds_read_b64_tr_b16 v[52:53], v65 offset:32768
    v_mfma_f32_16x16x32_bf16 v[28:31], v[204:207], a[160:163], v[28:31]
    ds_read_b64_tr_b16 v[54:55], v65 offset:34816
    s_waitcnt vmcnt(11)
    v_mfma_f32_16x16x32_bf16 v[44:47], v[204:207], a[164:167], v[44:47]
    ds_read_b64_tr_b16 v[56:57], v66 offset:32768
    v_mfma_f32_16x16x32_bf16 v[40:43], v[200:203], a[164:167], v[40:43]
    buffer_load_dwordx4 a[212:215], v1, s[28:31], s39 offen offset:1024 sc1
    ds_read_b64_tr_b16 v[58:59], v66 offset:34816
    v_mfma_f32_16x16x32_bf16 v[36:39], v[196:199], a[164:167], v[36:39]
    ds_read_b64_tr_b16 v[60:61], v67 offset:32768
    v_mfma_f32_16x16x32_bf16 v[32:35], v[192:195], a[164:167], v[32:35]
    ds_read_b64_tr_b16 v[62:63], v67 offset:34816
    s_waitcnt vmcnt(11) lgkmcnt(8)
    v_mfma_f32_16x16x32_bf16 v[16:19], v[208:211], a[168:171], v[16:19]
    ds_read_b64_tr_b16 v[192:193], v64 offset:36864
    v_mfma_f32_16x16x32_bf16 v[20:23], v[212:215], a[168:171], v[20:23]
    buffer_load_dwordx4 a[216:219], v1, s[28:31], s39 offen offset:2048 sc1
    ds_read_b64_tr_b16 v[194:195], v64 offset:38912
    v_mfma_f32_16x16x32_bf16 v[24:27], v[216:219], a[168:171], v[24:27]
    ds_read_b64_tr_b16 v[196:197], v65 offset:36864
    v_mfma_f32_16x16x32_bf16 v[28:31], v[220:223], a[168:171], v[28:31]
    ds_read_b64_tr_b16 v[198:199], v65 offset:38912
    s_waitcnt vmcnt(11)
    v_mfma_f32_16x16x32_bf16 v[44:47], v[220:223], a[172:175], v[44:47]
    ds_read_b64_tr_b16 v[200:201], v66 offset:36864
    v_mfma_f32_16x16x32_bf16 v[40:43], v[216:219], a[172:175], v[40:43]
    buffer_load_dwordx4 a[220:223], v1, s[28:31], s39 offen offset:3072 sc1
    ds_read_b64_tr_b16 v[202:203], v66 offset:38912
    v_mfma_f32_16x16x32_bf16 v[36:39], v[212:215], a[172:175], v[36:39]
    ds_read_b64_tr_b16 v[204:205], v67 offset:36864
    v_mfma_f32_16x16x32_bf16 v[32:35], v[208:211], a[172:175], v[32:35]
    ds_read_b64_tr_b16 v[206:207], v67 offset:38912
    s_waitcnt vmcnt(11) lgkmcnt(8)
    v_mfma_f32_16x16x32_bf16 v[16:19], v[48:51], a[176:179], v[16:19]
    ds_read_b64_tr_b16 v[208:209], v64 offset:40960
    v_mfma_f32_16x16x32_bf16 v[20:23], v[52:55], a[176:179], v[20:23]
    s_add_u32 s39, s39, 0x1000
    buffer_load_dwordx4 a[224:227], v1, s[28:31], s39 offen offset:0 sc1
    ds_read_b64_tr_b16 v[210:211], v64 offset:43008
    v_mfma_f32_16x16x32_bf16 v[24:27], v[56:59], a[176:179], v[24:27]
    ds_read_b64_tr_b16 v[212:213], v65 offset:40960
    v_mfma_f32_16x16x32_bf16 v[28:31], v[60:63], a[176:179], v[28:31]
    ds_read_b64_tr_b16 v[214:215], v65 offset:43008
    s_waitcnt vmcnt(11)
    v_mfma_f32_16x16x32_bf16 v[44:47], v[60:63], a[180:183], v[44:47]
    ds_read_b64_tr_b16 v[216:217], v66 offset:40960
    v_mfma_f32_16x16x32_bf16 v[40:43], v[56:59], a[180:183], v[40:43]
    buffer_load_dwordx4 a[228:231], v1, s[28:31], s39 offen offset:1024 sc1
    ds_read_b64_tr_b16 v[218:219], v66 offset:43008
    v_mfma_f32_16x16x32_bf16 v[36:39], v[52:55], a[180:183], v[36:39]
    ds_read_b64_tr_b16 v[220:221], v67 offset:40960
    v_mfma_f32_16x16x32_bf16 v[32:35], v[48:51], a[180:183], v[32:35]
    ds_read_b64_tr_b16 v[222:223], v67 offset:43008
    s_waitcnt vmcnt(11) lgkmcnt(8)
    v_mfma_f32_16x16x32_bf16 v[16:19], v[192:195], a[184:187], v[16:19]
    ds_read_b64_tr_b16 v[48:49], v64 offset:45056
    v_mfma_f32_16x16x32_bf16 v[20:23], v[196:199], a[184:187], v[20:23]
    buffer_load_dwordx4 a[232:235], v1, s[28:31], s39 offen offset:2048 sc1
    ds_read_b64_tr_b16 v[50:51], v64 offset:47104
    v_mfma_f32_16x16x32_bf16 v[24:27], v[200:203], a[184:187], v[24:27]
    ds_read_b64_tr_b16 v[52:53], v65 offset:45056
    v_mfma_f32_16x16x32_bf16 v[28:31], v[204:207], a[184:187], v[28:31]
    ds_read_b64_tr_b16 v[54:55], v65 offset:47104
    s_waitcnt vmcnt(11)
    v_mfma_f32_16x16x32_bf16 v[44:47], v[204:207], a[188:191], v[44:47]
    ds_read_b64_tr_b16 v[56:57], v66 offset:45056
    v_mfma_f32_16x16x32_bf16 v[40:43], v[200:203], a[188:191], v[40:43]
    buffer_load_dwordx4 a[236:239], v1, s[28:31], s39 offen offset:3072 sc1
    ds_read_b64_tr_b16 v[58:59], v66 offset:47104
    v_mfma_f32_16x16x32_bf16 v[36:39], v[196:199], a[188:191], v[36:39]
    ds_read_b64_tr_b16 v[60:61], v67 offset:45056
    v_mfma_f32_16x16x32_bf16 v[32:35], v[192:195], a[188:191], v[32:35]
    ds_read_b64_tr_b16 v[62:63], v67 offset:47104
    v_xor_b32 v64, 0x10000, v64
    v_xor_b32 v65, 0x10000, v65
    v_xor_b32 v66, 0x10000, v66
    v_xor_b32 v67, 0x10000, v67
    s_waitcnt vmcnt(11) lgkmcnt(8)
    v_mfma_f32_16x16x32_bf16 v[16:19], v[208:211], a[192:195], v[16:19]
    ds_read_b64_tr_b16 v[192:193], v64 offset:0
    v_mfma_f32_16x16x32_bf16 v[20:23], v[212:215], a[192:195], v[20:23]
    s_add_u32 s39, s39, 0x1000
    buffer_load_dwordx4 a[112:115], v1, s[28:31], s39 offen offset:0 sc1
    ds_read_b64_tr_b16 v[194:195], v64 offset:2048
    v_mfma_f32_16x16x32_bf16 v[24:27], v[216:219], a[192:195], v[24:27]
    ds_read_b64_tr_b16 v[196:197], v65 offset:0
    v_mfma_f32_16x16x32_bf16 v[28:31], v[220:223], a[192:195], v[28:31]
    ds_read_b64_tr_b16 v[198:199], v65 offset:2048
    s_waitcnt vmcnt(11)
    v_mfma_f32_16x16x32_bf16 v[44:47], v[220:223], a[196:199], v[44:47]
    ds_read_b64_tr_b16 v[200:201], v66 offset:0
    v_mfma_f32_16x16x32_bf16 v[40:43], v[216:219], a[196:199], v[40:43]
    buffer_load_dwordx4 a[116:119], v1, s[28:31], s39 offen offset:1024 sc1
    ds_read_b64_tr_b16 v[202:203], v66 offset:2048
    v_mfma_f32_16x16x32_bf16 v[36:39], v[212:215], a[196:199], v[36:39]
    ds_read_b64_tr_b16 v[204:205], v67 offset:0
    v_mfma_f32_16x16x32_bf16 v[32:35], v[208:211], a[196:199], v[32:35]
    ds_read_b64_tr_b16 v[206:207], v67 offset:2048
    s_waitcnt vmcnt(11) lgkmcnt(8)
    v_mfma_f32_16x16x32_bf16 v[16:19], v[48:51], a[200:203], v[16:19]
    ds_read_b64_tr_b16 v[208:209], v64 offset:4096
    v_mfma_f32_16x16x32_bf16 v[20:23], v[52:55], a[200:203], v[20:23]
    buffer_load_dwordx4 a[120:123], v1, s[28:31], s39 offen offset:2048 sc1
    ds_read_b64_tr_b16 v[210:211], v64 offset:6144
    v_mfma_f32_16x16x32_bf16 v[24:27], v[56:59], a[200:203], v[24:27]
    ds_read_b64_tr_b16 v[212:213], v65 offset:4096
    v_mfma_f32_16x16x32_bf16 v[28:31], v[60:63], a[200:203], v[28:31]
    ds_read_b64_tr_b16 v[214:215], v65 offset:6144
    s_waitcnt vmcnt(11)
    v_mfma_f32_16x16x32_bf16 v[44:47], v[60:63], a[204:207], v[44:47]
    ds_read_b64_tr_b16 v[216:217], v66 offset:4096
    v_mfma_f32_16x16x32_bf16 v[40:43], v[56:59], a[204:207], v[40:43]
    buffer_load_dwordx4 a[124:127], v1, s[28:31], s39 offen offset:3072 sc1
    ds_read_b64_tr_b16 v[218:219], v66 offset:6144
    v_mfma_f32_16x16x32_bf16 v[36:39], v[52:55], a[204:207], v[36:39]
    ds_read_b64_tr_b16 v[220:221], v67 offset:4096
    v_mfma_f32_16x16x32_bf16 v[32:35], v[48:51], a[204:207], v[32:35]
    ds_read_b64_tr_b16 v[222:223], v67 offset:6144
    s_waitcnt vmcnt(11) lgkmcnt(8)
    v_mfma_f32_16x16x32_bf16 v[16:19], v[192:195], a[208:211], v[16:19]
    ds_read_b64_tr_b16 v[48:49], v64 offset:8192
    v_mfma_f32_16x16x32_bf16 v[20:23], v[196:199], a[208:211], v[20:23]
    s_add_u32 s39, s39, 0x1000
    buffer_load_dwordx4 a[128:131], v1, s[28:31], s39 offen offset:0 sc1
    ds_read_b64_tr_b16 v[50:51], v64 offset:10240
    v_mfma_f32_16x16x32_bf16 v[24:27], v[200:203], a[208:211], v[24:27]
    ds_read_b64_tr_b16 v[52:53], v65 offset:8192
    v_mfma_f32_16x16x32_bf16 v[28:31], v[204:207], a[208:211], v[28:31]
    ds_read_b64_tr_b16 v[54:55], v65 offset:10240
    s_waitcnt vmcnt(11)
    v_mfma_f32_16x16x32_bf16 v[44:47], v[204:207], a[212:215], v[44:47]
    ds_read_b64_tr_b16 v[56:57], v66 offset:8192
    v_mfma_f32_16x16x32_bf16 v[40:43], v[200:203], a[212:215], v[40:43]
    buffer_load_dwordx4 a[132:135], v1, s[28:31], s39 offen offset:1024 sc1
    ds_read_b64_tr_b16 v[58:59], v66 offset:10240
    v_mfma_f32_16x16x32_bf16 v[36:39], v[196:199], a[212:215], v[36:39]
    ds_read_b64_tr_b16 v[60:61], v67 offset:8192
    v_mfma_f32_16x16x32_bf16 v[32:35], v[192:195], a[212:215], v[32:35]
    ds_read_b64_tr_b16 v[62:63], v67 offset:10240
    s_waitcnt vmcnt(11) lgkmcnt(8)
    v_mfma_f32_16x16x32_bf16 v[16:19], v[208:211], a[216:219], v[16:19]
    ds_read_b64_tr_b16 v[192:193], v64 offset:12288
    v_mfma_f32_16x16x32_bf16 v[20:23], v[212:215], a[216:219], v[20:23]
    buffer_load_dwordx4 a[136:139], v1, s[28:31], s39 offen offset:2048 sc1
    ds_read_b64_tr_b16 v[194:195], v64 offset:14336
    v_mfma_f32_16x16x32_bf16 v[24:27], v[216:219], a[216:219], v[24:27]
    ds_read_b64_tr_b16 v[196:197], v65 offset:12288
    v_mfma_f32_16x16x32_bf16 v[28:31], v[220:223], a[216:219], v[28:31]
    ds_read_b64_tr_b16 v[198:199], v65 offset:14336
    s_waitcnt vmcnt(11)
    v_mfma_f32_16x16x32_bf16 v[44:47], v[220:223], a[220:223], v[44:47]
    ds_read_b64_tr_b16 v[200:201], v66 offset:12288
    v_mfma_f32_16x16x32_bf16 v[40:43], v[216:219], a[220:223], v[40:43]
    buffer_load_dwordx4 a[140:143], v1, s[28:31], s39 offen offset:3072 sc1
    ds_read_b64_tr_b16 v[202:203], v66 offset:14336
    v_mfma_f32_16x16x32_bf16 v[36:39], v[212:215], a[220:223], v[36:39]
    ds_read_b64_tr_b16 v[204:205], v67 offset:12288
    v_mfma_f32_16x16x32_bf16 v[32:35], v[208:211], a[220:223], v[32:35]
    ds_read_b64_tr_b16 v[206:207], v67 offset:14336
    s_waitcnt vmcnt(11) lgkmcnt(8)
    v_mfma_f32_16x16x32_bf16 v[16:19], v[48:51], a[224:227], v[16:19]
    ds_read_b64_tr_b16 v[208:209], v64 offset:16384
    v_mfma_f32_16x16x32_bf16 v[20:23], v[52:55], a[224:227], v[20:23]
    s_add_u32 s39, s39, 0x1000
    buffer_load_dwordx4 a[144:147], v1, s[28:31], s39 offen offset:0 sc1
    ds_read_b64_tr_b16 v[210:211], v64 offset:18432
    v_mfma_f32_16x16x32_bf16 v[24:27], v[56:59], a[224:227], v[24:27]
    ds_read_b64_tr_b16 v[212:213], v65 offset:16384
    v_mfma_f32_16x16x32_bf16 v[28:31], v[60:63], a[224:227], v[28:31]
    ds_read_b64_tr_b16 v[214:215], v65 offset:18432
    s_waitcnt vmcnt(11)
    v_mfma_f32_16x16x32_bf16 v[44:47], v[60:63], a[228:231], v[44:47]
    ds_read_b64_tr_b16 v[216:217], v66 offset:16384
    v_mfma_f32_16x16x32_bf16 v[40:43], v[56:59], a[228:231], v[40:43]
    buffer_load_dwordx4 a[148:151], v1, s[28:31], s39 offen offset:1024 sc1
    ds_read_b64_tr_b16 v[218:219], v66 offset:18432
    v_mfma_f32_16x16x32_bf16 v[36:39], v[52:55], a[228:231], v[36:39]
    ds_read_b64_tr_b16 v[220:221], v67 offset:16384
    v_mfma_f32_16x16x32_bf16 v[32:35], v[48:51], a[228:231], v[32:35]
    ds_read_b64_tr_b16 v[222:223], v67 offset:18432
    s_waitcnt vmcnt(11) lgkmcnt(8)
    v_mfma_f32_16x16x32_bf16 v[16:19], v[192:195], a[232:235], v[16:19]
    ds_read_b64_tr_b16 v[48:49], v64 offset:20480
    v_mfma_f32_16x16x32_bf16 v[20:23], v[196:199], a[232:235], v[20:23]
    buffer_load_dwordx4 a[152:155], v1, s[28:31], s39 offen offset:2048 sc1
    ds_read_b64_tr_b16 v[50:51], v64 offset:22528
    v_mfma_f32_16x16x32_bf16 v[24:27], v[200:203], a[232:235], v[24:27]
    ds_read_b64_tr_b16 v[52:53], v65 offset:20480
    v_mfma_f32_16x16x32_bf16 v[28:31], v[204:207], a[232:235], v[28:31]
    ds_read_b64_tr_b16 v[54:55], v65 offset:22528
    s_waitcnt vmcnt(11)
    v_mfma_f32_16x16x32_bf16 v[44:47], v[204:207], a[236:239], v[44:47]
    ds_read_b64_tr_b16 v[56:57], v66 offset:20480
    v_mfma_f32_16x16x32_bf16 v[40:43], v[200:203], a[236:239], v[40:43]
    buffer_load_dwordx4 a[156:159], v1, s[28:31], s39 offen offset:3072 sc1
    ds_read_b64_tr_b16 v[58:59], v66 offset:22528
    v_mfma_f32_16x16x32_bf16 v[36:39], v[196:199], a[236:239], v[36:39]
    ds_read_b64_tr_b16 v[60:61], v67 offset:20480
    v_mfma_f32_16x16x32_bf16 v[32:35], v[192:195], a[236:239], v[32:35]
    ds_read_b64_tr_b16 v[62:63], v67 offset:22528
    s_waitcnt vmcnt(11) lgkmcnt(8)
    v_mfma_f32_16x16x32_bf16 v[16:19], v[208:211], a[112:115], v[16:19]
    ds_read_b64_tr_b16 v[192:193], v64 offset:24576
    v_mfma_f32_16x16x32_bf16 v[20:23], v[212:215], a[112:115], v[20:23]
    s_add_u32 s39, s39, 0x1000
    buffer_load_dwordx4 a[160:163], v1, s[28:31], s39 offen offset:0 sc1
    ds_read_b64_tr_b16 v[194:195], v64 offset:26624
    v_mfma_f32_16x16x32_bf16 v[24:27], v[216:219], a[112:115], v[24:27]
    ds_read_b64_tr_b16 v[196:197], v65 offset:24576
    v_mfma_f32_16x16x32_bf16 v[28:31], v[220:223], a[112:115], v[28:31]
    ds_read_b64_tr_b16 v[198:199], v65 offset:26624
    s_waitcnt vmcnt(11)
    v_mfma_f32_16x16x32_bf16 v[44:47], v[220:223], a[116:119], v[44:47]
    ds_read_b64_tr_b16 v[200:201], v66 offset:24576
    v_mfma_f32_16x16x32_bf16 v[40:43], v[216:219], a[116:119], v[40:43]
    buffer_load_dwordx4 a[164:167], v1, s[28:31], s39 offen offset:1024 sc1
    ds_read_b64_tr_b16 v[202:203], v66 offset:26624
    v_mfma_f32_16x16x32_bf16 v[36:39], v[212:215], a[116:119], v[36:39]
    ds_read_b64_tr_b16 v[204:205], v67 offset:24576
    v_mfma_f32_16x16x32_bf16 v[32:35], v[208:211], a[116:119], v[32:35]
    ds_read_b64_tr_b16 v[206:207], v67 offset:26624
    s_waitcnt vmcnt(11) lgkmcnt(8)
    v_mfma_f32_16x16x32_bf16 v[16:19], v[48:51], a[120:123], v[16:19]
    ds_read_b64_tr_b16 v[208:209], v64 offset:28672
    v_mfma_f32_16x16x32_bf16 v[20:23], v[52:55], a[120:123], v[20:23]
    buffer_load_dwordx4 a[168:171], v1, s[28:31], s39 offen offset:2048 sc1
    ds_read_b64_tr_b16 v[210:211], v64 offset:30720
    v_mfma_f32_16x16x32_bf16 v[24:27], v[56:59], a[120:123], v[24:27]
    ds_read_b64_tr_b16 v[212:213], v65 offset:28672
    v_mfma_f32_16x16x32_bf16 v[28:31], v[60:63], a[120:123], v[28:31]
    ds_read_b64_tr_b16 v[214:215], v65 offset:30720
    s_waitcnt vmcnt(11)
    v_mfma_f32_16x16x32_bf16 v[44:47], v[60:63], a[124:127], v[44:47]
    ds_read_b64_tr_b16 v[216:217], v66 offset:28672
    v_mfma_f32_16x16x32_bf16 v[40:43], v[56:59], a[124:127], v[40:43]
    buffer_load_dwordx4 a[172:175], v1, s[28:31], s39 offen offset:3072 sc1
    ds_read_b64_tr_b16 v[218:219], v66 offset:30720
    v_mfma_f32_16x16x32_bf16 v[36:39], v[52:55], a[124:127], v[36:39]
    ds_read_b64_tr_b16 v[220:221], v67 offset:28672
    v_mfma_f32_16x16x32_bf16 v[32:35], v[48:51], a[124:127], v[32:35]
    ds_read_b64_tr_b16 v[222:223], v67 offset:30720
    s_waitcnt vmcnt(11) lgkmcnt(8)
    v_mfma_f32_16x16x32_bf16 v[16:19], v[192:195], a[128:131], v[16:19]
    ds_read_b64_tr_b16 v[48:49], v64 offset:32768
    v_mfma_f32_16x16x32_bf16 v[20:23], v[196:199], a[128:131], v[20:23]
    s_add_u32 s39, s39, 0x1000
    buffer_load_dwordx4 a[176:179], v1, s[28:31], s39 offen offset:0 sc1
    ds_read_b64_tr_b16 v[50:51], v64 offset:34816
    v_mfma_f32_16x16x32_bf16 v[24:27], v[200:203], a[128:131], v[24:27]
    ds_read_b64_tr_b16 v[52:53], v65 offset:32768
    v_mfma_f32_16x16x32_bf16 v[28:31], v[204:207], a[128:131], v[28:31]
    ds_read_b64_tr_b16 v[54:55], v65 offset:34816
    s_waitcnt vmcnt(11)
    v_mfma_f32_16x16x32_bf16 v[44:47], v[204:207], a[132:135], v[44:47]
    ds_read_b64_tr_b16 v[56:57], v66 offset:32768
    v_mfma_f32_16x16x32_bf16 v[40:43], v[200:203], a[132:135], v[40:43]
    buffer_load_dwordx4 a[180:183], v1, s[28:31], s39 offen offset:1024 sc1
    ds_read_b64_tr_b16 v[58:59], v66 offset:34816
    v_mfma_f32_16x16x32_bf16 v[36:39], v[196:199], a[132:135], v[36:39]
    ds_read_b64_tr_b16 v[60:61], v67 offset:32768
    v_mfma_f32_16x16x32_bf16 v[32:35], v[192:195], a[132:135], v[32:35]
    ds_read_b64_tr_b16 v[62:63], v67 offset:34816
    s_waitcnt vmcnt(11) lgkmcnt(8)
    v_mfma_f32_16x16x32_bf16 v[16:19], v[208:211], a[136:139], v[16:19]
    ds_read_b64_tr_b16 v[192:193], v64 offset:36864
    v_mfma_f32_16x16x32_bf16 v[20:23], v[212:215], a[136:139], v[20:23]
    buffer_load_dwordx4 a[184:187], v1, s[28:31], s39 offen offset:2048 sc1
    ds_read_b64_tr_b16 v[194:195], v64 offset:38912
    v_mfma_f32_16x16x32_bf16 v[24:27], v[216:219], a[136:139], v[24:27]
    ds_read_b64_tr_b16 v[196:197], v65 offset:36864
    v_mfma_f32_16x16x32_bf16 v[28:31], v[220:223], a[136:139], v[28:31]
    ds_read_b64_tr_b16 v[198:199], v65 offset:38912
    s_waitcnt vmcnt(11)
    v_mfma_f32_16x16x32_bf16 v[44:47], v[220:223], a[140:143], v[44:47]
    ds_read_b64_tr_b16 v[200:201], v66 offset:36864
    v_mfma_f32_16x16x32_bf16 v[40:43], v[216:219], a[140:143], v[40:43]
    buffer_load_dwordx4 a[188:191], v1, s[28:31], s39 offen offset:3072 sc1
    ds_read_b64_tr_b16 v[202:203], v66 offset:38912
    v_mfma_f32_16x16x32_bf16 v[36:39], v[212:215], a[140:143], v[36:39]
    ds_read_b64_tr_b16 v[204:205], v67 offset:36864
    v_mfma_f32_16x16x32_bf16 v[32:35], v[208:211], a[140:143], v[32:35]
    ds_read_b64_tr_b16 v[206:207], v67 offset:38912
    s_waitcnt vmcnt(11) lgkmcnt(8)
    v_mfma_f32_16x16x32_bf16 v[16:19], v[48:51], a[144:147], v[16:19]
    ds_read_b64_tr_b16 v[208:209], v64 offset:40960
    v_mfma_f32_16x16x32_bf16 v[20:23], v[52:55], a[144:147], v[20:23]
    s_add_u32 s39, s39, 0x1000
    buffer_load_dwordx4 a[192:195], v1, s[28:31], s39 offen offset:0 sc1
    ds_read_b64_tr_b16 v[210:211], v64 offset:43008
    v_mfma_f32_16x16x32_bf16 v[24:27], v[56:59], a[144:147], v[24:27]
    ds_read_b64_tr_b16 v[212:213], v65 offset:40960
    v_mfma_f32_16x16x32_bf16 v[28:31], v[60:63], a[144:147], v[28:31]
    ds_read_b64_tr_b16 v[214:215], v65 offset:43008
    s_waitcnt vmcnt(11)
    v_mfma_f32_16x16x32_bf16 v[44:47], v[60:63], a[148:151], v[44:47]
    ds_read_b64_tr_b16 v[216:217], v66 offset:40960
    v_mfma_f32_16x16x32_bf16 v[40:43], v[56:59], a[148:151], v[40:43]
    buffer_load_dwordx4 a[196:199], v1, s[28:31], s39 offen offset:1024 sc1
    ds_read_b64_tr_b16 v[218:219], v66 offset:43008
    v_mfma_f32_16x16x32_bf16 v[36:39], v[52:55], a[148:151], v[36:39]
    ds_read_b64_tr_b16 v[220:221], v67 offset:40960
    v_mfma_f32_16x16x32_bf16 v[32:35], v[48:51], a[148:151], v[32:35]
    ds_read_b64_tr_b16 v[222:223], v67 offset:43008
    s_waitcnt vmcnt(11) lgkmcnt(8)
    v_mfma_f32_16x16x32_bf16 v[16:19], v[192:195], a[152:155], v[16:19]
    ds_read_b64_tr_b16 v[48:49], v64 offset:45056
    v_mfma_f32_16x16x32_bf16 v[20:23], v[196:199], a[152:155], v[20:23]
    buffer_load_dwordx4 a[200:203], v1, s[28:31], s39 offen offset:2048 sc1
    ds_read_b64_tr_b16 v[50:51], v64 offset:47104
    v_mfma_f32_16x16x32_bf16 v[24:27], v[200:203], a[152:155], v[24:27]
    ds_read_b64_tr_b16 v[52:53], v65 offset:45056
    v_mfma_f32_16x16x32_bf16 v[28:31], v[204:207], a[152:155], v[28:31]
    ds_read_b64_tr_b16 v[54:55], v65 offset:47104
    s_waitcnt vmcnt(11)
L_pw9:
    s_cbranch_execz L_pw12
    v_mfma_f32_16x16x32_bf16 v[44:47], v[204:207], a[156:159], v[44:47]
    ds_read_b64_tr_b16 v[56:57], v66 offset:45056
    v_mfma_f32_16x16x32_bf16 v[40:43], v[200:203], a[156:159], v[40:43]
    buffer_load_dwordx4 a[204:207], v1, s[28:31], s39 offen offset:3072 sc1
    ds_read_b64_tr_b16 v[58:59], v66 offset:47104
    v_mfma_f32_16x16x32_bf16 v[36:39], v[196:199], a[156:159], v[36:39]
    ds_read_b64_tr_b16 v[60:61], v67 offset:45056
    v_mfma_f32_16x16x32_bf16 v[32:35], v[192:195], a[156:159], v[32:35]
    ds_read_b64_tr_b16 v[62:63], v67 offset:47104
    s_waitcnt vmcnt(11) lgkmcnt(8)
    v_mfma_f32_16x16x32_bf16 v[16:19], v[208:211], a[160:163], v[16:19]
    ds_read_b64_tr_b16 v[192:193], v64 offset:49152
    v_mfma_f32_16x16x32_bf16 v[20:23], v[212:215], a[160:163], v[20:23]
    s_add_u32 s39, s39, 0x1000
    buffer_load_dwordx4 a[208:211], v1, s[28:31], s39 offen offset:0 sc1
    ds_read_b64_tr_b16 v[194:195], v64 offset:51200
    v_mfma_f32_16x16x32_bf16 v[24:27], v[216:219], a[160:163], v[24:27]
    ds_read_b64_tr_b16 v[196:197], v65 offset:49152
    v_mfma_f32_16x16x32_bf16 v[28:31], v[220:223], a[160:163], v[28:31]
    ds_read_b64_tr_b16 v[198:199], v65 offset:51200
    s_waitcnt vmcnt(11)
    v_mfma_f32_16x16x32_bf16 v[44:47], v[220:223], a[164:167], v[44:47]
    ds_read_b64_tr_b16 v[200:201], v66 offset:49152
    v_mfma_f32_16x16x32_bf16 v[40:43], v[216:219], a[164:167], v[40:43]
    buffer_load_dwordx4 a[212:215], v1, s[28:31], s39 offen offset:1024 sc1
    ds_read_b64_tr_b16 v[202:203], v66 offset:51200
    v_mfma_f32_16x16x32_bf16 v[36:39], v[212:215], a[164:167], v[36:39]
    ds_read_b64_tr_b16 v[204:205], v67 offset:49152
    v_mfma_f32_16x16x32_bf16 v[32:35], v[208:211], a[164:167], v[32:35]
    ds_read_b64_tr_b16 v[206:207], v67 offset:51200
    s_waitcnt vmcnt(11) lgkmcnt(8)
    v_mfma_f32_16x16x32_bf16 v[16:19], v[48:51], a[168:171], v[16:19]
    ds_read_b64_tr_b16 v[208:209], v64 offset:53248
    v_mfma_f32_16x16x32_bf16 v[20:23], v[52:55], a[168:171], v[20:23]
    buffer_load_dwordx4 a[216:219], v1, s[28:31], s39 offen offset:2048 sc1
    ds_read_b64_tr_b16 v[210:211], v64 offset:55296
    v_mfma_f32_16x16x32_bf16 v[24:27], v[56:59], a[168:171], v[24:27]
    ds_read_b64_tr_b16 v[212:213], v65 offset:53248
    v_mfma_f32_16x16x32_bf16 v[28:31], v[60:63], a[168:171], v[28:31]
    ds_read_b64_tr_b16 v[214:215], v65 offset:55296
    s_waitcnt vmcnt(11)
    v_mfma_f32_16x16x32_bf16 v[44:47], v[60:63], a[172:175], v[44:47]
    ds_read_b64_tr_b16 v[216:217], v66 offset:53248
    v_mfma_f32_16x16x32_bf16 v[40:43], v[56:59], a[172:175], v[40:43]
    buffer_load_dwordx4 a[220:223], v1, s[28:31], s39 offen offset:3072 sc1
    ds_read_b64_tr_b16 v[218:219], v66 offset:55296
    v_mfma_f32_16x16x32_bf16 v[36:39], v[52:55], a[172:175], v[36:39]
    ds_read_b64_tr_b16 v[220:221], v67 offset:53248
    v_mfma_f32_16x16x32_bf16 v[32:35], v[48:51], a[172:175], v[32:35]
    ds_read_b64_tr_b16 v[222:223], v67 offset:55296
    s_waitcnt vmcnt(11) lgkmcnt(8)
    v_mfma_f32_16x16x32_bf16 v[16:19], v[192:195], a[176:179], v[16:19]
    ds_read_b64_tr_b16 v[48:49], v64 offset:57344
    v_mfma_f32_16x16x32_bf16 v[20:23], v[196:199], a[176:179], v[20:23]
    s_add_u32 s39, s39, 0x1000
    buffer_load_dwordx4 a[224:227], v1, s[28:31], s39 offen offset:0 sc1
    ds_read_b64_tr_b16 v[50:51], v64 offset:59392
    v_mfma_f32_16x16x32_bf16 v[24:27], v[200:203], a[176:179], v[24:27]
    ds_read_b64_tr_b16 v[52:53], v65 offset:57344
    v_mfma_f32_16x16x32_bf16 v[28:31], v[204:207], a[176:179], v[28:31]
    ds_read_b64_tr_b16 v[54:55], v65 offset:59392
    s_waitcnt vmcnt(11)
    v_mfma_f32_16x16x32_bf16 v[44:47], v[204:207], a[180:183], v[44:47]
    ds_read_b64_tr_b16 v[56:57], v66 offset:57344
    v_mfma_f32_16x16x32_bf16 v[40:43], v[200:203], a[180:183], v[40:43]
    buffer_load_dwordx4 a[228:231], v1, s[28:31], s39 offen offset:1024 sc1
    ds_read_b64_tr_b16 v[58:59], v66 offset:59392
    v_mfma_f32_16x16x32_bf16 v[36:39], v[196:199], a[180:183], v[36:39]
    ds_read_b64_tr_b16 v[60:61], v67 offset:57344
    v_mfma_f32_16x16x32_bf16 v[32:35], v[192:195], a[180:183], v[32:35]
    ds_read_b64_tr_b16 v[62:63], v67 offset:59392
    s_waitcnt vmcnt(11) lgkmcnt(8)
    v_mfma_f32_16x16x32_bf16 v[16:19], v[208:211], a[184:187], v[16:19]
    ds_read_b64_tr_b16 v[192:193], v64 offset:61440
    v_mfma_f32_16x16x32_bf16 v[20:23], v[212:215], a[184:187], v[20:23]
    buffer_load_dwordx4 a[232:235], v1, s[28:31], s39 offen offset:2048 sc1
    ds_read_b64_tr_b16 v[194:195], v64 offset:63488
    v_mfma_f32_16x16x32_bf16 v[24:27], v[216:219], a[184:187], v[24:27]
    ds_read_b64_tr_b16 v[196:197], v65 offset:61440
    v_mfma_f32_16x16x32_bf16 v[28:31], v[220:223], a[184:187], v[28:31]
    ds_read_b64_tr_b16 v[198:199], v65 offset:63488
    s_waitcnt vmcnt(11)
    v_mfma_f32_16x16x32_bf16 v[44:47], v[220:223], a[188:191], v[44:47]
    ds_read_b64_tr_b16 v[200:201], v66 offset:61440
    v_mfma_f32_16x16x32_bf16 v[40:43], v[216:219], a[188:191], v[40:43]
    buffer_load_dwordx4 a[236:239], v1, s[28:31], s39 offen offset:3072 sc1
    ds_read_b64_tr_b16 v[202:203], v66 offset:63488
    v_mfma_f32_16x16x32_bf16 v[36:39], v[212:215], a[188:191], v[36:39]
    ds_read_b64_tr_b16 v[204:205], v67 offset:61440
    v_mfma_f32_16x16x32_bf16 v[32:35], v[208:211], a[188:191], v[32:35]
    ds_read_b64_tr_b16 v[206:207], v67 offset:63488
    v_xor_b32 v64, 0x10000, v64
    v_xor_b32 v65, 0x10000, v65
    v_xor_b32 v66, 0x10000, v66
    v_xor_b32 v67, 0x10000, v67
    s_waitcnt vmcnt(11) lgkmcnt(8)
    v_mfma_f32_16x16x32_bf16 v[16:19], v[48:51], a[192:195], v[16:19]
    ds_read_b64_tr_b16 v[208:209], v64 offset:49152
    v_mfma_f32_16x16x32_bf16 v[20:23], v[52:55], a[192:195], v[20:23]
    ds_read_b64_tr_b16 v[210:211], v64 offset:51200
    v_mfma_f32_16x16x32_bf16 v[24:27], v[56:59], a[192:195], v[24:27]
    ds_read_b64_tr_b16 v[212:213], v65 offset:49152
    v_mfma_f32_16x16x32_bf16 v[28:31], v[60:63], a[192:195], v[28:31]
    ds_read_b64_tr_b16 v[214:215], v65 offset:51200
    s_waitcnt vmcnt(10)
    v_mfma_f32_16x16x32_bf16 v[44:47], v[60:63], a[196:199], v[44:47]
    ds_read_b64_tr_b16 v[216:217], v66 offset:49152
    v_mfma_f32_16x16x32_bf16 v[40:43], v[56:59], a[196:199], v[40:43]
    ds_read_b64_tr_b16 v[218:219], v66 offset:51200
    v_mfma_f32_16x16x32_bf16 v[36:39], v[52:55], a[196:199], v[36:39]
    ds_read_b64_tr_b16 v[220:221], v67 offset:49152
    v_mfma_f32_16x16x32_bf16 v[32:35], v[48:51], a[196:199], v[32:35]
    ds_read_b64_tr_b16 v[222:223], v67 offset:51200
    s_waitcnt vmcnt(9) lgkmcnt(8)
    v_mfma_f32_16x16x32_bf16 v[16:19], v[192:195], a[200:203], v[16:19]
    ds_read_b64_tr_b16 v[48:49], v64 offset:53248
    v_mfma_f32_16x16x32_bf16 v[20:23], v[196:199], a[200:203], v[20:23]
    ds_read_b64_tr_b16 v[50:51], v64 offset:55296
    v_mfma_f32_16x16x32_bf16 v[24:27], v[200:203], a[200:203], v[24:27]
    ds_read_b64_tr_b16 v[52:53], v65 offset:53248
    v_mfma_f32_16x16x32_bf16 v[28:31], v[204:207], a[200:203], v[28:31]
    ds_read_b64_tr_b16 v[54:55], v65 offset:55296
    s_waitcnt vmcnt(8)
    v_mfma_f32_16x16x32_bf16 v[44:47], v[204:207], a[204:207], v[44:47]
    ds_read_b64_tr_b16 v[56:57], v66 offset:53248
    v_mfma_f32_16x16x32_bf16 v[40:43], v[200:203], a[204:207], v[40:43]
    ds_read_b64_tr_b16 v[58:59], v66 offset:55296
    v_mfma_f32_16x16x32_bf16 v[36:39], v[196:199], a[204:207], v[36:39]
    ds_read_b64_tr_b16 v[60:61], v67 offset:53248
    v_mfma_f32_16x16x32_bf16 v[32:35], v[192:195], a[204:207], v[32:35]
    ds_read_b64_tr_b16 v[62:63], v67 offset:55296
    s_waitcnt vmcnt(7) lgkmcnt(8)
    v_mfma_f32_16x16x32_bf16 v[16:19], v[208:211], a[208:211], v[16:19]
    ds_read_b64_tr_b16 v[192:193], v64 offset:57344
    v_mfma_f32_16x16x32_bf16 v[20:23], v[212:215], a[208:211], v[20:23]
    ds_read_b64_tr_b16 v[194:195], v64 offset:59392
    v_mfma_f32_16x16x32_bf16 v[24:27], v[216:219], a[208:211], v[24:27]
    ds_read_b64_tr_b16 v[196:197], v65 offset:57344
    v_mfma_f32_16x16x32_bf16 v[28:31], v[220:223], a[208:211], v[28:31]
    ds_read_b64_tr_b16 v[198:199], v65 offset:59392
    s_waitcnt vmcnt(6)
    v_mfma_f32_16x16x32_bf16 v[44:47], v[220:223], a[212:215], v[44:47]
    ds_read_b64_tr_b16 v[200:201], v66 offset:57344
    v_mfma_f32_16x16x32_bf16 v[40:43], v[216:219], a[212:215], v[40:43]
    ds_read_b64_tr_b16 v[202:203], v66 offset:59392
    v_mfma_f32_16x16x32_bf16 v[36:39], v[212:215], a[212:215], v[36:39]
    ds_read_b64_tr_b16 v[204:205], v67 offset:57344
    v_mfma_f32_16x16x32_bf16 v[32:35], v[208:211], a[212:215], v[32:35]
    ds_read_b64_tr_b16 v[206:207], v67 offset:59392
    s_waitcnt vmcnt(5) lgkmcnt(8)
    v_mfma_f32_16x16x32_bf16 v[16:19], v[48:51], a[216:219], v[16:19]
    ds_read_b64_tr_b16 v[208:209], v64 offset:61440
    v_mfma_f32_16x16x32_bf16 v[20:23], v[52:55], a[216:219], v[20:23]
    ds_read_b64_tr_b16 v[210:211], v64 offset:63488
    v_mfma_f32_16x16x32_bf16 v[24:27], v[56:59], a[216:219], v[24:27]
    ds_read_b64_tr_b16 v[212:213], v65 offset:61440
    v_mfma_f32_16x16x32_bf16 v[28:31], v[60:63], a[216:219], v[28:31]
    ds_read_b64_tr_b16 v[214:215], v65 offset:63488
    s_waitcnt vmcnt(4)
    v_mfma_f32_16x16x32_bf16 v[44:47], v[60:63], a[220:223], v[44:47]
    ds_read_b64_tr_b16 v[216:217], v66 offset:61440
    v_mfma_f32_16x16x32_bf16 v[40:43], v[56:59], a[220:223], v[40:43]
    ds_read_b64_tr_b16 v[218:219], v66 offset:63488
    v_mfma_f32_16x16x32_bf16 v[36:39], v[52:55], a[220:223], v[36:39]
    ds_read_b64_tr_b16 v[220:221], v67 offset:61440
    v_mfma_f32_16x16x32_bf16 v[32:35], v[48:51], a[220:223], v[32:35]
    ds_read_b64_tr_b16 v[222:223], v67 offset:63488
    s_waitcnt vmcnt(3) lgkmcnt(8)
    v_mfma_f32_16x16x32_bf16 v[16:19], v[192:195], a[224:227], v[16:19]
    v_mfma_f32_16x16x32_bf16 v[20:23], v[196:199], a[224:227], v[20:23]
    v_mfma_f32_16x16x32_bf16 v[24:27], v[200:203], a[224:227], v[24:27]
    v_mfma_f32_16x16x32_bf16 v[28:31], v[204:207], a[224:227], v[28:31]
    s_waitcnt vmcnt(2)
    v_mfma_f32_16x16x32_bf16 v[44:47], v[204:207], a[228:231], v[44:47]
    v_mfma_f32_16x16x32_bf16 v[40:43], v[200:203], a[228:231], v[40:43]
    v_mfma_f32_16x16x32_bf16 v[36:39], v[196:199], a[228:231], v[36:39]
    v_mfma_f32_16x16x32_bf16 v[32:35], v[192:195], a[228:231], v[32:35]
    s_waitcnt vmcnt(1) lgkmcnt(0)
    v_mfma_f32_16x16x32_bf16 v[16:19], v[208:211], a[232:235], v[16:19]
    v_mfma_f32_16x16x32_bf16 v[20:23], v[212:215], a[232:235], v[20:23]
    v_mfma_f32_16x16x32_bf16 v[24:27], v[216:219], a[232:235], v[24:27]
    v_mfma_f32_16x16x32_bf16 v[28:31], v[220:223], a[232:235], v[28:31]
    s_waitcnt vmcnt(0)
    v_mfma_f32_16x16x32_bf16 v[44:47], v[220:223], a[236:239], v[44:47]
    v_mfma_f32_16x16x32_bf16 v[40:43], v[216:219], a[236:239], v[40:43]
    v_mfma_f32_16x16x32_bf16 v[36:39], v[212:215], a[236:239], v[36:39]
    v_mfma_f32_16x16x32_bf16 v[32:35], v[208:211], a[236:239], v[32:35]
    s_nop 7
    v_pk_fma_f32 v[16:17], v[16:17], v[128:129], v[160:161]
    v_pk_fma_f32 v[18:19], v[18:19], v[130:131], v[162:163]
    v_pk_fma_f32 v[20:21], v[20:21], v[132:133], v[164:165]
    v_pk_fma_f32 v[22:23], v[22:23], v[134:135], v[166:167]
    v_pk_fma_f32 v[24:25], v[24:25], v[136:137], v[168:169]
    v_pk_fma_f32 v[26:27], v[26:27], v[138:139], v[170:171]
    v_pk_fma_f32 v[28:29], v[28:29], v[140:141], v[172:173]
    v_pk_fma_f32 v[30:31], v[30:31], v[142:143], v[174:175]
    v_cvt_pk_bf16_f32 v80, v16, v17
    v_cvt_pk_bf16_f32 v81, v18, v19
    ds_write_b64 v10, v[80:81] offset:0
    v_cvt_pk_bf16_f32 v82, v20, v21
    v_cvt_pk_bf16_f32 v83, v22, v23
    ds_write_b64 v10, v[82:83] offset:32
    v_cvt_pk_bf16_f32 v84, v24, v25
    v_cvt_pk_bf16_f32 v85, v26, v27
    ds_write_b64 v10, v[84:85] offset:64
    v_cvt_pk_bf16_f32 v86, v28, v29
    v_cvt_pk_bf16_f32 v87, v30, v31
    ds_write_b64 v10, v[86:87] offset:96
    v_pk_fma_f32 v[32:33], v[32:33], v[144:145], v[176:177]
    v_pk_fma_f32 v[34:35], v[34:35], v[146:147], v[178:179]
    v_pk_fma_f32 v[36:37], v[36:37], v[148:149], v[180:181]
    v_pk_fma_f32 v[38:39], v[38:39], v[150:151], v[182:183]
    v_pk_fma_f32 v[40:41], v[40:41], v[152:153], v[184:185]
    v_pk_fma_f32 v[42:43], v[42:43], v[154:155], v[186:187]
    v_pk_fma_f32 v[44:45], v[44:45], v[156:157], v[188:189]
    v_pk_fma_f32 v[46:47], v[46:47], v[158:159], v[190:191]
    v_cvt_pk_bf16_f32 v88, v32, v33
    v_cvt_pk_bf16_f32 v89, v34, v35
    ds_write_b64 v10, v[88:89] offset:2304
    v_cvt_pk_bf16_f32 v90, v36, v37
    v_cvt_pk_bf16_f32 v91, v38, v39
    ds_write_b64 v10, v[90:91] offset:2336
    v_cvt_pk_bf16_f32 v92, v40, v41
    v_cvt_pk_bf16_f32 v93, v42, v43
    ds_write_b64 v10, v[92:93] offset:2368
    v_cvt_pk_bf16_f32 v94, v44, v45
    v_cvt_pk_bf16_f32 v95, v46, v47
    ds_write_b64 v10, v[94:95] offset:2400
    s_waitcnt lgkmcnt(0)
    ds_read_b128 v[96:99], v11 offset:0
    ds_read_b128 v[100:103], v11 offset:1152
    ds_read_b128 v[104:107], v11 offset:2304
    ds_read_b128 v[108:111], v11 offset:3456
    s_waitcnt lgkmcnt(3)
    buffer_store_dwordx4 v[96:99], v3, s[24:27], 0 offen sc1
    s_waitcnt lgkmcnt(2)
    buffer_store_dwordx4 v[100:103], v3, s[24:27], s61 offen sc1
    s_waitcnt lgkmcnt(1)
    buffer_store_dwordx4 v[104:107], v3, s[24:27], s62 offen sc1
    s_waitcnt lgkmcnt(0)
    buffer_store_dwordx4 v[108:111], v3, s[24:27], s63 offen sc1
    s_endpgm
L_k2_fallback:
    s_waitcnt vmcnt(0) lgkmcnt(0)
    v_mov_b32 v72, 0xff800000
    v_mov_b32 v73, 0xff800000
    v_mov_b32 v74, 0xff800000
    v_mov_b32 v75, 0xff800000
    s_mov_b32 s36, 0
L_k2_fb1:
    buffer_load_dwordx4 a[48:51], v1, s[12:15], s36 offen offset:0 sc1
    buffer_load_dwordx4 a[52:55], v1, s[12:15], s36 offen offset:1024 sc1
    s_waitcnt vmcnt(0)
    v_mfma_f32_16x16x32_bf16 v[16:19], a[48:51], a[240:243], 0
    v_mfma_f32_16x16x32_bf16 v[24:27], a[48:51], a[244:247], 0
    v_mfma_f32_16x16x32_bf16 v[28:31], a[52:55], a[244:247], 0
    v_mfma_f32_16x16x32_bf16 v[20:23], a[52:55], a[240:243], 0
    v_mfma_f32_16x16x32_bf16 v[32:35], a[48:51], a[248:251], 0
    v_mfma_f32_16x16x32_bf16 v[40:43], a[48:51], a[252:255], 0
    v_mfma_f32_16x16x32_bf16 v[44:47], a[52:55], a[252:255], 0
    v_mfma_f32_16x16x32_bf16 v[36:39], a[52:55], a[248:251], 0
    s_nop 15
    v_max3_f32 v72, v72, v16, v17
    v_max3_f32 v73, v73, v24, v25
    v_max3_f32 v74, v74, v32, v33
    v_max3_f32 v75, v75, v40, v41
    v_max3_f32 v72, v72, v18, v19
    v_max3_f32 v73, v73, v26, v27
    v_max3_f32 v74, v74, v34, v35
    v_max3_f32 v75, v75, v42, v43
    v_max3_f32 v72, v72, v20, v21
    v_max3_f32 v73, v73, v28, v29
    v_max3_f32 v74, v74, v36, v37
    v_max3_f32 v75, v75, v44, v45
    v_max3_f32 v72, v72, v22, v23
    v_max3_f32 v73, v73, v30, v31
    v_max3_f32 v74, v74, v38, v39
    v_max3_f32 v75, v75, v46, v47
    s_add_u32 s36, s36, 0x1000
    s_cmp_lt_u32 s36, 0x40000
    s_cbranch_scc1 L_k2_fb1
    v_mov_b32 v76, v72
    v_mov_b32 v77, v73
    v_mov_b32 v78, v74
    v_mov_b32 v79, v75
    s_nop 0
    v_permlane16_swap_b32 v72, v76
    v_permlane16_swap_b32 v73, v77
    v_permlane16_swap_b32 v74, v78
    v_permlane16_swap_b32 v75, v79
    v_max_f32 v72, v72, v76
    v_max_f32 v73, v73, v77
    v_max_f32 v74, v74, v78
    v_max_f32 v75, v75, v79
    v_mov_b32 v76, v72
    v_mov_b32 v77, v73
    v_mov_b32 v78, v74
    v_mov_b32 v79, v75
    s_nop 0
    v_permlane32_swap_b32 v72, v76
    v_permlane32_swap_b32 v73, v77
    v_permlane32_swap_b32 v74, v78
    v_permlane32_swap_b32 v75, v79
    v_max_f32 v72, v72, v76
    v_max_f32 v73, v73, v77
    v_max_f32 v74, v74, v78
    v_max_f32 v75, v75, v79
    v_sub_f32 v48, 0, v72
    v_sub_f32 v49, 0, v72
    v_sub_f32 v50, 0, v72
    v_sub_f32 v51, 0, v72
    v_sub_f32 v52, 0, v73
    v_sub_f32 v53, 0, v73
    v_sub_f32 v54, 0, v73
    v_sub_f32 v55, 0, v73
    v_sub_f32 v56, 0, v74
    v_sub_f32 v57, 0, v74
    v_sub_f32 v58, 0, v74
    v_sub_f32 v59, 0, v74
    v_sub_f32 v60, 0, v75
    v_sub_f32 v61, 0, v75
    v_sub_f32 v62, 0, v75
    v_sub_f32 v63, 0, v75
    v_accvgpr_write_b32 a0, 0
    v_accvgpr_write_b32 a1, 0
    v_accvgpr_write_b32 a2, 0
    v_accvgpr_write_b32 a3, 0
    v_accvgpr_write_b32 a4, 0
    v_accvgpr_write_b32 a5, 0
    v_accvgpr_write_b32 a6, 0
    v_accvgpr_write_b32 a7, 0
    v_accvgpr_write_b32 a8, 0
    v_accvgpr_write_b32 a9, 0
    v_accvgpr_write_b32 a10, 0
    v_accvgpr_write_b32 a11, 0
    v_accvgpr_write_b32 a12, 0
    v_accvgpr_write_b32 a13, 0
    v_accvgpr_write_b32 a14, 0
    v_accvgpr_write_b32 a15, 0
    v_accvgpr_write_b32 a16, 0
    v_accvgpr_write_b32 a17, 0
    v_accvgpr_write_b32 a18, 0
    v_accvgpr_write_b32 a19, 0
    v_accvgpr_write_b32 a20, 0
    v_accvgpr_write_b32 a21, 0
    v_accvgpr_write_b32 a22, 0
    v_accvgpr_write_b32 a23, 0
    v_accvgpr_write_b32 a24, 0
    v_accvgpr_write_b32 a25, 0
    v_accvgpr_write_b32 a26, 0
    v_accvgpr_write_b32 a27, 0
    v_accvgpr_write_b32 a28, 0
    v_accvgpr_write_b32 a29, 0
    v_accvgpr_write_b32 a30, 0
    v_accvgpr_write_b32 a31, 0
    v_accvgpr_write_b32 a32, 0
    v_accvgpr_write_b32 a33, 0
    v_accvgpr_write_b32 a34, 0
    v_accvgpr_write_b32 a35, 0
    v_accvgpr_write_b32 a36, 0
    v_accvgpr_write_b32 a37, 0
    v_accvgpr_write_b32 a38, 0
    v_accvgpr_write_b32 a39, 0
    v_accvgpr_write_b32 a40, 0
    v_accvgpr_write_b32 a41, 0
    v_accvgpr_write_b32 a42, 0
    v_accvgpr_write_b32 a43, 0
    v_accvgpr_write_b32 a44, 0
    v_accvgpr_write_b32 a45, 0
    v_accvgpr_write_b32 a46, 0
    v_accvgpr_write_b32 a47, 0
    s_mov_b32 s36, 0
L_k2_fb2:
    buffer_load_dwordx4 a[48:51], v1, s[12:15], s36 offen offset:0 sc1
    buffer_load_dwordx4 a[64:67], v1, s[12:15], s36 offen offset:2048 sc1
    buffer_load_dwordx4 a[52:55], v1, s[12:15], s36 offen offset:1024 sc1
    buffer_load_dwordx4 a[68:71], v1, s[12:15], s36 offen offset:3072 sc1
    s_waitcnt vmcnt(0)
    v_mfma_f32_16x16x32_bf16 v[16:19], a[48:51], a[240:243], v[48:51]
    v_mfma_f32_16x16x32_bf16 v[24:27], a[48:51], a[244:247], v[52:55]
    v_mfma_f32_16x16x32_bf16 v[28:31], a[52:55], a[244:247], v[52:55]
    v_mfma_f32_16x16x32_bf16 v[20:23], a[52:55], a[240:243], v[48:51]
    v_mfma_f32_16x16x32_bf16 v[32:35], a[48:51], a[248:251], v[56:59]
    v_mfma_f32_16x16x32_bf16 v[40:43], a[48:51], a[252:255], v[60:63]
    v_mfma_f32_16x16x32_bf16 v[44:47], a[52:55], a[252:255], v[60:63]
    v_mfma_f32_16x16x32_bf16 v[36:39], a[52:55], a[248:251], v[56:59]
    s_nop 15
    v_exp_f32 v16, v16
    v_exp_f32 v17, v17
    v_exp_f32 v18, v18
    v_cvt_pk_bf16_f32 v80, v16, v17
    v_exp_f32 v19, v19
    v_exp_f32 v20, v20
    v_cvt_pk_bf16_f32 v81, v18, v19
    v_exp_f32 v21, v21
    v_exp_f32 v22, v22
    v_cvt_pk_bf16_f32 v82, v20, v21
    v_exp_f32 v23, v23
    v_exp_f32 v24, v24
    v_cvt_pk_bf16_f32 v83, v22, v23
    v_exp_f32 v25, v25
    v_exp_f32 v26, v26
    v_cvt_pk_bf16_f32 v84, v24, v25
    v_exp_f32 v27, v27
    v_exp_f32 v28, v28
    v_cvt_pk_bf16_f32 v85, v26, v27
    v_exp_f32 v29, v29
    v_exp_f32 v30, v30
    v_exp_f32 v31, v31
    v_cvt_pk_bf16_f32 v86, v28, v29
    v_cvt_pk_bf16_f32 v87, v30, v31
    v_exp_f32 v32, v32
    v_exp_f32 v33, v33
    v_exp_f32 v34, v34
    v_cvt_pk_bf16_f32 v88, v32, v33
    v_exp_f32 v35, v35
    v_exp_f32 v36, v36
    v_cvt_pk_bf16_f32 v89, v34, v35
    v_exp_f32 v37, v37
    v_exp_f32 v38, v38
    v_cvt_pk_bf16_f32 v90, v36, v37
    v_exp_f32 v39, v39
    v_exp_f32 v40, v40
    v_cvt_pk_bf16_f32 v91, v38, v39
    v_exp_f32 v41, v41
    v_exp_f32 v42, v42
    v_cvt_pk_bf16_f32 v92, v40, v41
    v_exp_f32 v43, v43
    v_exp_f32 v44, v44
    v_cvt_pk_bf16_f32 v93, v42, v43
    v_exp_f32 v45, v45
    v_exp_f32 v46, v46
    v_exp_f32 v47, v47
    v_cvt_pk_bf16_f32 v94, v44, v45
    v_cvt_pk_bf16_f32 v95, v46, v47
    s_nop 1
    v_mfma_f32_16x16x32_bf16 a[0:3], a[64:67], v[80:83], a[0:3]
    v_mfma_f32_16x16x32_bf16 a[4:7], a[68:71], v[80:83], a[4:7]
    v_mfma_f32_16x16x32_bf16 a[32:35], v[112:115], v[80:83], a[32:35]
    v_mfma_f32_16x16x32_bf16 a[36:39], v[112:115], v[84:87], a[36:39]
    v_mfma_f32_16x16x32_bf16 a[12:15], a[68:71], v[84:87], a[12:15]
    v_mfma_f32_16x16x32_bf16 a[8:11], a[64:67], v[84:87], a[8:11]
    v_mfma_f32_16x16x32_bf16 a[16:19], a[64:67], v[88:91], a[16:19]
    v_mfma_f32_16x16x32_bf16 a[20:23], a[68:71], v[88:91], a[20:23]
    v_mfma_f32_16x16x32_bf16 a[40:43], v[112:115], v[88:91], a[40:43]
    v_mfma_f32_16x16x32_bf16 a[44:47], v[112:115], v[92:95], a[44:47]
    v_mfma_f32_16x16x32_bf16 a[28:31], a[68:71], v[92:95], a[28:31]
    v_mfma_f32_16x16x32_bf16 a[24:27], a[64:67], v[92:95], a[24:27]
    s_add_u32 s36, s36, 0x1000
    s_cmp_lt_u32 s36, 0x40000
    s_nop 15
    s_cbranch_scc1 L_k2_fb2
    s_mov_b32 s71, 1
    s_branch L_k2_out
L_k2_end:
    s_endpgm
.p2align 12
L_k1_v:
L_pw10:
    s_cbranch_execz L_pw13
    v_mfma_f32_16x16x32_bf16 v[48:51], a[0:3], a[32:35], 0
    v_mfma_f32_16x16x32_bf16 v[48:51], a[4:7], a[36:39], v[48:51]
    s_add_u32 m0, s40, 32768
    ds_read_b64_tr_b16 a[136:137], v10 offset:0
    v_mfma_f32_16x16x32_bf16 v[52:55], a[4:7], a[44:47], 0
    ds_read_b64_tr_b16 a[138:139], v10 offset:512
    buffer_load_dwordx4 v1, s[12:15], s36 offen offset:0 sc1 lds
    v_mfma_f32_16x16x32_bf16 v[52:55], a[0:3], a[40:43], v[52:55]
    ds_read_b64_tr_b16 a[140:141], v10 offset:4096
    v_mfma_f32_16x16x32_bf16 v[56:59], a[0:3], a[48:51], 0
    ds_read_b64_tr_b16 a[142:143], v10 offset:4608
    v_mfma_f32_16x16x32_bf16 v[56:59], a[4:7], a[52:55], v[56:59]
    ds_read_b128 a[8:11], v4 offset:1024
    v_mfma_f32_16x16x32_bf16 v[60:63], a[4:7], a[60:63], 0
    ds_read_b128 a[12:15], v4 offset:17408
    buffer_load_dwordx4 v17, s[12:15], s36 offen offset:1024 sc1 lds
    v_mfma_f32_16x16x32_bf16 v[60:63], a[0:3], a[56:59], v[60:63]
    v_mfma_f32_16x16x32_bf16 v[176:179], a[0:3], a[96:99], 0
    v_mfma_f32_16x16x32_bf16 v[176:179], a[4:7], a[100:103], v[176:179]
    ds_read_b128 a[16:19], v4 offset:2048
    v_mfma_f32_16x16x32_bf16 v[180:183], a[4:7], a[108:111], 0
    buffer_load_dwordx4 v18, s[12:15], s36 offen offset:2048 sc1 lds
    v_mfma_f32_16x16x32_bf16 v[180:183], a[0:3], a[104:107], v[180:183]
    v_mfma_f32_16x16x32_bf16 v[184:187], a[0:3], a[112:115], 0
    v_mfma_f32_16x16x32_bf16 v[184:187], a[4:7], a[116:119], v[184:187]
    ds_read_b128 a[20:23], v4 offset:18432
    v_mfma_f32_16x16x32_bf16 v[188:191], a[4:7], a[124:127], 0
    buffer_load_dwordx4 v19, s[12:15], s36 offen offset:3072 sc1 lds
    v_mfma_f32_16x16x32_bf16 v[188:191], a[0:3], a[120:123], v[188:191]
    s_add_u32 s36, s36, 0x80
    v_mfma_f32_16x16x32_bf16 a[192:195], a[128:131], a[0:3], 0
    v_mfma_f32_16x16x32_bf16 a[192:195], a[132:135], a[4:7], a[192:195]
    s_waitcnt lgkmcnt(4)
    s_add_u32 m0, s40, 49152
    v_mfma_f32_16x16x32_bf16 a[196:199], a[140:143], a[4:7], 0
    buffer_load_dwordx4 v1, s[12:15], s36 offen offset:0 sc1 lds
    v_mfma_f32_16x16x32_bf16 a[196:199], a[136:139], a[0:3], a[196:199]
    s_waitcnt lgkmcnt(2)
    v_mfma_f32_16x16x32_bf16 a[204:207], a[136:139], a[8:11], 0
    v_mfma_f32_16x16x32_bf16 a[204:207], a[140:143], a[12:15], a[204:207]
    s_barrier
    v_mfma_f32_16x16x32_bf16 a[200:203], a[132:135], a[12:15], 0
    buffer_load_dwordx4 v17, s[12:15], s36 offen offset:1024 sc1 lds
    v_mfma_f32_16x16x32_bf16 a[200:203], a[128:131], a[8:11], a[200:203]
    v_mfma_f32_16x16x32_bf16 v[204:207], a[8:11], a[120:123], 0
    v_mfma_f32_16x16x32_bf16 v[204:207], a[12:15], a[124:127], v[204:207]
    v_mfma_f32_16x16x32_bf16 v[200:203], a[12:15], a[116:119], 0
    buffer_load_dwordx4 v18, s[12:15], s36 offen offset:2048 sc1 lds
    v_mfma_f32_16x16x32_bf16 v[200:203], a[8:11], a[112:115], v[200:203]
    v_mfma_f32_16x16x32_bf16 v[196:199], a[8:11], a[104:107], 0
    v_mfma_f32_16x16x32_bf16 v[196:199], a[12:15], a[108:111], v[196:199]
    ds_read_b128 a[24:27], v4 offset:3072
    v_mfma_f32_16x16x32_bf16 v[192:195], a[12:15], a[100:103], 0
    buffer_load_dwordx4 v19, s[12:15], s36 offen offset:3072 sc1 lds
    v_mfma_f32_16x16x32_bf16 v[192:195], a[8:11], a[96:99], v[192:195]
    v_mfma_f32_16x16x32_bf16 v[76:79], a[8:11], a[56:59], 0
    v_mfma_f32_16x16x32_bf16 v[76:79], a[12:15], a[60:63], v[76:79]
    s_add_u32 m0, s41, 12288
    ds_read_b128 a[28:31], v4 offset:19456
    v_mfma_f32_16x16x32_bf16 v[72:75], a[12:15], a[52:55], 0
    buffer_load_dwordx4 v2, s[16:19], s37 offen offset:0 lds
    v_mfma_f32_16x16x32_bf16 v[72:75], a[8:11], a[48:51], v[72:75]
    v_mfma_f32_16x16x32_bf16 v[68:71], a[8:11], a[40:43], 0
    v_mfma_f32_16x16x32_bf16 v[68:71], a[12:15], a[44:47], v[68:71]
    s_add_u32 m0, s41, 28544
    v_mfma_f32_16x16x32_bf16 v[64:67], a[12:15], a[36:39], 0
    buffer_load_dwordx4 v2, s[16:19], s37 offen offset:128 lds
    v_mfma_f32_16x16x32_bf16 v[64:67], a[8:11], a[32:35], v[64:67]
    s_waitcnt lgkmcnt(2)
    v_mfma_f32_16x16x32_bf16 v[80:83], a[16:19], a[32:35], 0
    v_mfma_f32_16x16x32_bf16 v[80:83], a[20:23], a[36:39], v[80:83]
    s_add_u32 m0, s41, 45056
    v_mfma_f32_16x16x32_bf16 v[84:87], a[20:23], a[44:47], 0
    buffer_load_dwordx4 v2, s[20:23], s37 offen offset:0 lds
    v_mfma_f32_16x16x32_bf16 v[84:87], a[16:19], a[40:43], v[84:87]
    v_mfma_f32_16x16x32_bf16 v[88:91], a[16:19], a[48:51], 0
    v_mfma_f32_16x16x32_bf16 v[88:91], a[20:23], a[52:55], v[88:91]
    s_add_u32 m0, s41, 61312
    v_mfma_f32_16x16x32_bf16 v[92:95], a[20:23], a[60:63], 0
    buffer_load_dwordx4 v2, s[20:23], s37 offen offset:128 lds
    v_mfma_f32_16x16x32_bf16 v[92:95], a[16:19], a[56:59], v[92:95]
    v_mfma_f32_16x16x32_bf16 v[208:211], a[16:19], a[96:99], 0
    v_mfma_f32_16x16x32_bf16 v[208:211], a[20:23], a[100:103], v[208:211]
    s_add_u32 m0, s41, 77824
    ds_read_b128 a[0:3], v4 offset:4096
    v_mfma_f32_16x16x32_bf16 v[212:215], a[20:23], a[108:111], 0
    buffer_load_dwordx4 v3, s[24:27], s38 offen offset:0 lds
    v_mfma_f32_16x16x32_bf16 v[212:215], a[16:19], a[104:107], v[212:215]
    s_add_u32 s36, s36, 0x80
    v_mfma_f32_16x16x32_bf16 v[216:219], a[16:19], a[112:115], 0
    s_add_u32 s37, s37, s39
    v_mfma_f32_16x16x32_bf16 v[216:219], a[20:23], a[116:119], v[216:219]
    s_add_u32 s38, s38, 196608
    ds_read_b128 a[4:7], v4 offset:20480
    v_mfma_f32_16x16x32_bf16 v[220:223], a[20:23], a[124:127], 0
    v_mfma_f32_16x16x32_bf16 v[220:223], a[16:19], a[120:123], v[220:223]
    v_mfma_f32_16x16x32_bf16 a[208:211], a[128:131], a[16:19], 0
    s_add_u32 m0, s41, 0
    v_mfma_f32_16x16x32_bf16 a[208:211], a[132:135], a[20:23], a[208:211]
    buffer_load_dwordx4 v2, s[16:19], s37 offen offset:0 lds
    v_mfma_f32_16x16x32_bf16 a[212:215], a[140:143], a[20:23], 0
    v_mfma_f32_16x16x32_bf16 a[212:215], a[136:139], a[16:19], a[212:215]
    s_waitcnt lgkmcnt(2)
    v_mfma_f32_16x16x32_bf16 a[220:223], a[136:139], a[24:27], 0
    v_mfma_f32_16x16x32_bf16 a[220:223], a[140:143], a[28:31], a[220:223]
    s_add_u32 m0, s41, 16256
    v_mfma_f32_16x16x32_bf16 a[216:219], a[132:135], a[28:31], 0
    buffer_load_dwordx4 v2, s[16:19], s37 offen offset:128 lds
    v_mfma_f32_16x16x32_bf16 a[216:219], a[128:131], a[24:27], a[216:219]
    v_mfma_f32_16x16x32_bf16 v[236:239], a[24:27], a[120:123], 0
    v_mfma_f32_16x16x32_bf16 v[236:239], a[28:31], a[124:127], v[236:239]
    v_mfma_f32_16x16x32_bf16 v[232:235], a[28:31], a[116:119], 0
    v_mfma_f32_16x16x32_bf16 v[232:235], a[24:27], a[112:115], v[232:235]
    s_add_u32 m0, s41, 32768
    v_mfma_f32_16x16x32_bf16 v[228:231], a[24:27], a[104:107], 0
    buffer_load_dwordx4 v2, s[20:23], s37 offen offset:0 lds
    v_mfma_f32_16x16x32_bf16 v[228:231], a[28:31], a[108:111], v[228:231]
    ds_read_b128 a[8:11], v4 offset:5120
    v_mfma_f32_16x16x32_bf16 v[224:227], a[28:31], a[100:103], 0
    v_mfma_f32_16x16x32_bf16 v[224:227], a[24:27], a[96:99], v[224:227]
    v_mfma_f32_16x16x32_bf16 v[108:111], a[24:27], a[56:59], 0
    s_add_u32 m0, s41, 49024
    v_mfma_f32_16x16x32_bf16 v[108:111], a[28:31], a[60:63], v[108:111]
    ds_read_b128 a[12:15], v4 offset:21504
    buffer_load_dwordx4 v2, s[20:23], s37 offen offset:128 lds
    v_mfma_f32_16x16x32_bf16 v[104:107], a[28:31], a[52:55], 0
    v_mfma_f32_16x16x32_bf16 v[104:107], a[24:27], a[48:51], v[104:107]
    v_mfma_f32_16x16x32_bf16 v[100:103], a[24:27], a[40:43], 0
    v_mfma_f32_16x16x32_bf16 v[100:103], a[28:31], a[44:47], v[100:103]
    v_mfma_f32_16x16x32_bf16 v[96:99], a[28:31], a[36:39], 0
    s_add_u32 m0, s41, 65536
    v_mfma_f32_16x16x32_bf16 v[96:99], a[24:27], a[32:35], v[96:99]
    s_waitcnt lgkmcnt(2)
    buffer_load_dwordx4 v3, s[24:27], s38 offen offset:0 lds
    v_mfma_f32_16x16x32_bf16 v[112:115], a[0:3], a[32:35], 0
    s_add_u32 s37, s37, s39
    v_mfma_f32_16x16x32_bf16 v[112:115], a[4:7], a[36:39], v[112:115]
    s_add_u32 s38, s38, 196608
    v_mfma_f32_16x16x32_bf16 v[116:119], a[4:7], a[44:47], 0
    v_mfma_f32_16x16x32_bf16 v[116:119], a[0:3], a[40:43], v[116:119]
    s_add_u32 m0, s41, 4096
    v_mfma_f32_16x16x32_bf16 v[120:123], a[0:3], a[48:51], 0
    buffer_load_dwordx4 v2, s[16:19], s37 offen offset:0 lds
    v_mfma_f32_16x16x32_bf16 v[120:123], a[4:7], a[52:55], v[120:123]
    v_mfma_f32_16x16x32_bf16 v[124:127], a[4:7], a[60:63], 0
    v_mfma_f32_16x16x32_bf16 v[124:127], a[0:3], a[56:59], v[124:127]
    v_mfma_f32_16x16x32_bf16 v[240:243], a[0:3], a[96:99], 0
    v_mfma_f32_16x16x32_bf16 v[240:243], a[4:7], a[100:103], v[240:243]
    s_add_u32 m0, s41, 20352
    ds_read_b128 a[16:19], v4 offset:6144
    v_mfma_f32_16x16x32_bf16 v[244:247], a[4:7], a[108:111], 0
    buffer_load_dwordx4 v2, s[16:19], s37 offen offset:128 lds
    v_mfma_f32_16x16x32_bf16 v[244:247], a[0:3], a[104:107], v[244:247]
    v_mfma_f32_16x16x32_bf16 v[248:251], a[0:3], a[112:115], 0
    v_mfma_f32_16x16x32_bf16 v[248:251], a[4:7], a[116:119], v[248:251]
    ds_read_b128 a[20:23], v4 offset:22528
    v_mfma_f32_16x16x32_bf16 v[252:255], a[4:7], a[124:127], 0
    s_add_u32 m0, s41, 36864
    v_mfma_f32_16x16x32_bf16 v[252:255], a[0:3], a[120:123], v[252:255]
    buffer_load_dwordx4 v2, s[20:23], s37 offen offset:0 lds
    v_mfma_f32_16x16x32_bf16 a[224:227], a[128:131], a[0:3], 0
    v_mfma_f32_16x16x32_bf16 a[224:227], a[132:135], a[4:7], a[224:227]
    v_mfma_f32_16x16x32_bf16 a[228:231], a[140:143], a[4:7], 0
    v_mfma_f32_16x16x32_bf16 a[228:231], a[136:139], a[0:3], a[228:231]
    s_waitcnt lgkmcnt(2)
    v_mfma_f32_16x16x32_bf16 a[236:239], a[136:139], a[8:11], 0
    s_add_u32 m0, s41, 53120
    v_mfma_f32_16x16x32_bf16 a[236:239], a[140:143], a[12:15], a[236:239]
    buffer_load_dwordx4 v2, s[20:23], s37 offen offset:128 lds
    v_mfma_f32_16x16x32_bf16 a[232:235], a[132:135], a[12:15], 0
    v_mfma_f32_16x16x32_bf16 a[232:235], a[128:131], a[8:11], a[232:235]
    ds_read_b128 a[24:27], v4 offset:7168
    v_mfma_f32_16x16x32_bf16 a[156:159], a[8:11], a[120:123], 0
    v_mfma_f32_16x16x32_bf16 a[156:159], a[12:15], a[124:127], a[156:159]
    s_add_u32 m0, s41, 69632
    v_mfma_f32_16x16x32_bf16 a[152:155], a[12:15], a[116:119], 0
    buffer_load_dwordx4 v3, s[24:27], s38 offen offset:0 lds
    v_mfma_f32_16x16x32_bf16 a[152:155], a[8:11], a[112:115], a[152:155]
    s_add_u32 s37, s37, s39
    ds_read_b128 a[28:31], v4 offset:23552
    v_mfma_f32_16x16x32_bf16 a[148:151], a[8:11], a[104:107], 0
    s_add_u32 s38, s38, 196608
    v_mfma_f32_16x16x32_bf16 a[148:151], a[12:15], a[108:111], a[148:151]
    v_mfma_f32_16x16x32_bf16 a[144:147], a[12:15], a[100:103], 0
    v_mfma_f32_16x16x32_bf16 a[144:147], a[8:11], a[96:99], a[144:147]
    v_mfma_f32_16x16x32_bf16 v[140:143], a[8:11], a[56:59], 0
    v_mfma_f32_16x16x32_bf16 v[140:143], a[12:15], a[60:63], v[140:143]
    v_mfma_f32_16x16x32_bf16 v[136:139], a[12:15], a[52:55], 0
    buffer_load_dword v46, v44, s[64:67], s49 offen
    v_mfma_f32_16x16x32_bf16 v[136:139], a[8:11], a[48:51], v[136:139]
    s_add_u32 s49, s49, s72
    v_mfma_f32_16x16x32_bf16 v[132:135], a[8:11], a[40:43], 0
    v_mfma_f32_16x16x32_bf16 v[132:135], a[12:15], a[44:47], v[132:135]
    v_mfma_f32_16x16x32_bf16 v[128:131], a[12:15], a[36:39], 0
    buffer_load_dword v46, v44, s[64:67], s49 offen
    v_mfma_f32_16x16x32_bf16 v[128:131], a[8:11], a[32:35], v[128:131]
    s_waitcnt lgkmcnt(2)
    s_add_u32 s49, s49, s72
    v_mfma_f32_16x16x32_bf16 v[144:147], a[16:19], a[32:35], 0
    v_mfma_f32_16x16x32_bf16 v[144:147], a[20:23], a[36:39], v[144:147]
    s_waitcnt vmcnt(12) lgkmcnt(0)
    v_mfma_f32_16x16x32_bf16 v[148:151], a[20:23], a[44:47], 0
    s_barrier
    v_mfma_f32_16x16x32_bf16 v[148:151], a[16:19], a[40:43], v[148:151]
    ds_read_b64_tr_b16 a[64:65], v5 offset:8192
    v_mfma_f32_16x16x32_bf16 v[152:155], a[16:19], a[48:51], 0
    ds_read_b64_tr_b16 a[66:67], v5 offset:8704
    v_mfma_f32_16x16x32_bf16 v[152:155], a[20:23], a[52:55], v[152:155]
    ds_read_b64_tr_b16 a[68:69], v5 offset:12288
    v_mfma_f32_16x16x32_bf16 v[156:159], a[20:23], a[60:63], 0
    ds_read_b64_tr_b16 a[70:71], v5 offset:12800
    v_mfma_f32_16x16x32_bf16 v[156:159], a[16:19], a[56:59], v[156:159]
    ds_read_b64_tr_b16 a[72:73], v6 offset:8192
    v_mfma_f32_16x16x32_bf16 a[160:163], a[16:19], a[96:99], 0
    ds_read_b64_tr_b16 a[74:75], v6 offset:8704
    v_mfma_f32_16x16x32_bf16 a[160:163], a[20:23], a[100:103], a[160:163]
    ds_read_b64_tr_b16 a[76:77], v6 offset:12288
    v_mfma_f32_16x16x32_bf16 a[164:167], a[20:23], a[108:111], 0
    ds_read_b64_tr_b16 a[78:79], v6 offset:12800
    v_mfma_f32_16x16x32_bf16 a[164:167], a[16:19], a[104:107], a[164:167]
    ds_read_b64_tr_b16 a[80:81], v7 offset:8192
    v_mfma_f32_16x16x32_bf16 a[168:171], a[16:19], a[112:115], 0
    ds_read_b64_tr_b16 a[82:83], v7 offset:8704
    v_mfma_f32_16x16x32_bf16 a[168:171], a[20:23], a[116:119], a[168:171]
    ds_read_b64_tr_b16 a[84:85], v7 offset:12288
    v_mfma_f32_16x16x32_bf16 a[172:175], a[20:23], a[124:127], 0
    ds_read_b64_tr_b16 a[86:87], v7 offset:12800
    v_mfma_f32_16x16x32_bf16 a[172:175], a[16:19], a[120:123], a[172:175]
    ds_read_b64_tr_b16 a[88:89], v8 offset:8192
    v_mfma_f32_16x16x32_bf16 a[240:243], a[128:131], a[16:19], 0
    ds_read_b64_tr_b16 a[90:91], v8 offset:8704
    v_mfma_f32_16x16x32_bf16 a[240:243], a[132:135], a[20:23], a[240:243]
    ds_read_b64_tr_b16 a[92:93], v8 offset:12288
    v_mfma_f32_16x16x32_bf16 a[244:247], a[140:143], a[20:23], 0
    ds_read_b64_tr_b16 a[94:95], v8 offset:12800
    v_mfma_f32_16x16x32_bf16 a[244:247], a[136:139], a[16:19], a[244:247]
    ds_read_b128 a[0:3], v4 offset:32768
    v_mfma_f32_16x16x32_bf16 a[176:179], a[24:27], a[96:99], 0
    ds_read_b128 a[4:7], v4 offset:49152
    v_mfma_f32_16x16x32_bf16 a[176:179], a[28:31], a[100:103], a[176:179]
    ds_read_b64_tr_b16 a[96:97], v5 offset:40960
    v_mfma_f32_16x16x32_bf16 a[180:183], a[28:31], a[108:111], 0
    ds_read_b64_tr_b16 a[98:99], v5 offset:41472
    v_mfma_f32_16x16x32_bf16 a[180:183], a[24:27], a[104:107], a[180:183]
    ds_read_b64_tr_b16 a[100:101], v5 offset:45056
    v_mfma_f32_16x16x32_bf16 a[184:187], a[24:27], a[112:115], 0
    ds_read_b64_tr_b16 a[102:103], v5 offset:45568
    v_mfma_f32_16x16x32_bf16 a[184:187], a[28:31], a[116:119], a[184:187]
    ds_read_b64_tr_b16 a[104:105], v6 offset:40960
    v_mfma_f32_16x16x32_bf16 a[188:191], a[28:31], a[124:127], 0
    ds_read_b64_tr_b16 a[106:107], v6 offset:41472
    v_mfma_f32_16x16x32_bf16 a[188:191], a[24:27], a[120:123], a[188:191]
    ds_read_b64_tr_b16 a[108:109], v6 offset:45056
    v_mfma_f32_16x16x32_bf16 a[248:251], a[128:131], a[24:27], 0
    ds_read_b64_tr_b16 a[110:111], v6 offset:45568
    v_mfma_f32_16x16x32_bf16 a[248:251], a[132:135], a[28:31], a[248:251]
    ds_read_b64_tr_b16 a[112:113], v7 offset:40960
    v_mfma_f32_16x16x32_bf16 a[252:255], a[140:143], a[28:31], 0
    ds_read_b64_tr_b16 a[114:115], v7 offset:41472
    v_mfma_f32_16x16x32_bf16 a[252:255], a[136:139], a[24:27], a[252:255]
    ds_read_b64_tr_b16 a[116:117], v7 offset:45056
    v_mfma_f32_16x16x32_bf16 v[160:163], a[24:27], a[32:35], 0
    ds_read_b64_tr_b16 a[118:119], v7 offset:45568
    v_mfma_f32_16x16x32_bf16 v[160:163], a[28:31], a[36:39], v[160:163]
    ds_read_b64_tr_b16 a[120:121], v8 offset:40960
    v_mfma_f32_16x16x32_bf16 v[164:167], a[28:31], a[44:47], 0
    ds_read_b64_tr_b16 a[122:123], v8 offset:41472
    v_mfma_f32_16x16x32_bf16 v[164:167], a[24:27], a[40:43], v[164:167]
    ds_read_b64_tr_b16 a[124:125], v8 offset:45056
    v_mfma_f32_16x16x32_bf16 v[168:171], a[24:27], a[48:51], 0
    ds_read_b64_tr_b16 a[126:127], v8 offset:45568
    v_mfma_f32_16x16x32_bf16 v[168:171], a[28:31], a[52:55], v[168:171]
    ds_read_b64_tr_b16 a[128:129], v9 offset:8192
    v_mfma_f32_16x16x32_bf16 v[172:175], a[28:31], a[60:63], 0
    ds_read_b64_tr_b16 a[130:131], v9 offset:8704
    v_mfma_f32_16x16x32_bf16 v[172:175], a[24:27], a[56:59], v[172:175]
    s_waitcnt lgkmcnt(15)
    ds_read_b64_tr_b16 a[132:133], v9 offset:12288
.p2align 6
L_k1_loop_v:
    v_mfma_f32_16x16x32_bf16 v[48:51], a[0:3], a[64:67], v[48:51]
    ds_read_b64_tr_b16 a[134:135], v9 offset:12800
    v_mfma_f32_16x16x32_bf16 v[48:51], a[4:7], a[68:71], v[48:51]
    ds_read_b64_tr_b16 a[136:137], v10 offset:8192
    v_mfma_f32_16x16x32_bf16 v[52:55], a[4:7], a[76:79], v[52:55]
    ds_read_b64_tr_b16 a[138:139], v10 offset:8704
    v_mfma_f32_16x16x32_bf16 v[52:55], a[0:3], a[72:75], v[52:55]
    ds_read_b64_tr_b16 a[140:141], v10 offset:12288
    v_mfma_f32_16x16x32_bf16 v[56:59], a[0:3], a[80:83], v[56:59]
    ds_read_b64_tr_b16 a[142:143], v10 offset:12800
    v_mfma_f32_16x16x32_bf16 v[56:59], a[4:7], a[84:87], v[56:59]
    ds_read_b128 a[8:11], v4 offset:33792
    v_mfma_f32_16x16x32_bf16 v[60:63], a[4:7], a[92:95], v[60:63]
    s_add_u32 m0, s40, 0
    ds_read_b128 a[12:15], v4 offset:50176
    v_mfma_f32_16x16x32_bf16 v[60:63], a[0:3], a[88:91], v[60:63]
    s_waitcnt lgkmcnt(15)
    buffer_load_dwordx4 v1, s[12:15], s36 offen offset:0 sc1 lds
    v_mfma_f32_16x16x32_bf16 v[176:179], a[0:3], a[96:99], v[176:179]
    v_mfma_f32_16x16x32_bf16 v[176:179], a[4:7], a[100:103], v[176:179]
    ds_read_b128 a[16:19], v4 offset:34816
    v_mfma_f32_16x16x32_bf16 v[180:183], a[4:7], a[108:111], v[180:183]
    v_mfma_f32_16x16x32_bf16 v[180:183], a[0:3], a[104:107], v[180:183]
    s_waitcnt lgkmcnt(15)
    v_mfma_f32_16x16x32_bf16 v[184:187], a[0:3], a[112:115], v[184:187]
    buffer_load_dwordx4 v17, s[12:15], s36 offen offset:1024 sc1 lds
    v_mfma_f32_16x16x32_bf16 v[184:187], a[4:7], a[116:119], v[184:187]
    s_waitcnt lgkmcnt(11)
    ds_read_b128 a[20:23], v4 offset:51200
    v_mfma_f32_16x16x32_bf16 v[188:191], a[4:7], a[124:127], v[188:191]
    v_mfma_f32_16x16x32_bf16 v[188:191], a[0:3], a[120:123], v[188:191]
    s_waitcnt lgkmcnt(8)
    v_mfma_f32_16x16x32_bf16 a[192:195], a[128:131], a[0:3], a[192:195]
    v_mfma_f32_16x16x32_bf16 a[192:195], a[132:135], a[4:7], a[192:195]
    s_waitcnt lgkmcnt(4)
    buffer_load_dwordx4 v18, s[12:15], s36 offen offset:2048 sc1 lds
    v_mfma_f32_16x16x32_bf16 a[196:199], a[140:143], a[4:7], a[196:199]
    v_mfma_f32_16x16x32_bf16 a[196:199], a[136:139], a[0:3], a[196:199]
    s_waitcnt lgkmcnt(2)
    v_mfma_f32_16x16x32_bf16 a[204:207], a[136:139], a[8:11], a[204:207]
    v_mfma_f32_16x16x32_bf16 a[204:207], a[140:143], a[12:15], a[204:207]
    s_barrier
    v_mfma_f32_16x16x32_bf16 a[200:203], a[132:135], a[12:15], a[200:203]
    buffer_load_dwordx4 v19, s[12:15], s36 offen offset:3072 sc1 lds
    v_mfma_f32_16x16x32_bf16 a[200:203], a[128:131], a[8:11], a[200:203]
    s_add_u32 s36, s36, 0x80
    v_mfma_f32_16x16x32_bf16 v[204:207], a[8:11], a[120:123], v[204:207]
    v_mfma_f32_16x16x32_bf16 v[204:207], a[12:15], a[124:127], v[204:207]
    v_mfma_f32_16x16x32_bf16 v[200:203], a[12:15], a[116:119], v[200:203]
    s_add_u32 m0, s40, 16384
    v_mfma_f32_16x16x32_bf16 v[200:203], a[8:11], a[112:115], v[200:203]
    buffer_load_dwordx4 v1, s[12:15], s36 offen offset:0 sc1 lds
    v_mfma_f32_16x16x32_bf16 v[196:199], a[8:11], a[104:107], v[196:199]
    v_mfma_f32_16x16x32_bf16 v[196:199], a[12:15], a[108:111], v[196:199]
    ds_read_b128 a[24:27], v4 offset:35840
    v_mfma_f32_16x16x32_bf16 v[192:195], a[12:15], a[100:103], v[192:195]
    v_mfma_f32_16x16x32_bf16 v[192:195], a[8:11], a[96:99], v[192:195]
    v_mfma_f32_16x16x32_bf16 v[76:79], a[8:11], a[88:91], v[76:79]
    buffer_load_dwordx4 v17, s[12:15], s36 offen offset:1024 sc1 lds
    v_mfma_f32_16x16x32_bf16 v[76:79], a[12:15], a[92:95], v[76:79]
    ds_read_b128 a[28:31], v4 offset:52224
    v_mfma_f32_16x16x32_bf16 v[72:75], a[12:15], a[84:87], v[72:75]
    v_mfma_f32_16x16x32_bf16 v[72:75], a[8:11], a[80:83], v[72:75]
    v_mfma_f32_16x16x32_bf16 v[68:71], a[8:11], a[72:75], v[68:71]
    v_mfma_f32_16x16x32_bf16 v[68:71], a[12:15], a[76:79], v[68:71]
    buffer_load_dwordx4 v18, s[12:15], s36 offen offset:2048 sc1 lds
    v_mfma_f32_16x16x32_bf16 v[64:67], a[12:15], a[68:71], v[64:67]
    v_mfma_f32_16x16x32_bf16 v[64:67], a[8:11], a[64:67], v[64:67]
    s_waitcnt lgkmcnt(2)
    v_mfma_f32_16x16x32_bf16 v[80:83], a[16:19], a[64:67], v[80:83]
    v_mfma_f32_16x16x32_bf16 v[80:83], a[20:23], a[68:71], v[80:83]
    v_mfma_f32_16x16x32_bf16 v[84:87], a[20:23], a[76:79], v[84:87]
    buffer_load_dwordx4 v19, s[12:15], s36 offen offset:3072 sc1 lds
    v_mfma_f32_16x16x32_bf16 v[84:87], a[16:19], a[72:75], v[84:87]
    s_add_u32 s36, s36, 0x80
    v_mfma_f32_16x16x32_bf16 v[88:91], a[16:19], a[80:83], v[88:91]
    v_mfma_f32_16x16x32_bf16 v[88:91], a[20:23], a[84:87], v[88:91]
    v_mfma_f32_16x16x32_bf16 v[92:95], a[20:23], a[92:95], v[92:95]
    v_mfma_f32_16x16x32_bf16 v[92:95], a[16:19], a[88:91], v[92:95]
    s_add_u32 m0, s41, 8192
    v_mfma_f32_16x16x32_bf16 v[208:211], a[16:19], a[96:99], v[208:211]
    buffer_load_dwordx4 v2, s[16:19], s37 offen offset:0 lds
    v_mfma_f32_16x16x32_bf16 v[208:211], a[20:23], a[100:103], v[208:211]
    ds_read_b128 a[0:3], v4 offset:36864
    v_mfma_f32_16x16x32_bf16 v[212:215], a[20:23], a[108:111], v[212:215]
    v_mfma_f32_16x16x32_bf16 v[212:215], a[16:19], a[104:107], v[212:215]
    v_mfma_f32_16x16x32_bf16 v[216:219], a[16:19], a[112:115], v[216:219]
    v_mfma_f32_16x16x32_bf16 v[216:219], a[20:23], a[116:119], v[216:219]
    ds_read_b128 a[4:7], v4 offset:53248
    v_mfma_f32_16x16x32_bf16 v[220:223], a[20:23], a[124:127], v[220:223]
    s_add_u32 m0, s41, 24448
    v_mfma_f32_16x16x32_bf16 v[220:223], a[16:19], a[120:123], v[220:223]
    buffer_load_dwordx4 v2, s[16:19], s37 offen offset:128 lds
    v_mfma_f32_16x16x32_bf16 a[208:211], a[128:131], a[16:19], a[208:211]
    v_mfma_f32_16x16x32_bf16 a[208:211], a[132:135], a[20:23], a[208:211]
    v_mfma_f32_16x16x32_bf16 a[212:215], a[140:143], a[20:23], a[212:215]
    v_mfma_f32_16x16x32_bf16 a[212:215], a[136:139], a[16:19], a[212:215]
    s_waitcnt lgkmcnt(2)
    v_mfma_f32_16x16x32_bf16 a[220:223], a[136:139], a[24:27], a[220:223]
    s_add_u32 m0, s41, 40960
    v_mfma_f32_16x16x32_bf16 a[220:223], a[140:143], a[28:31], a[220:223]
    buffer_load_dwordx4 v2, s[20:23], s37 offen offset:0 lds
    v_mfma_f32_16x16x32_bf16 a[216:219], a[132:135], a[28:31], a[216:219]
    v_mfma_f32_16x16x32_bf16 a[216:219], a[128:131], a[24:27], a[216:219]
    v_mfma_f32_16x16x32_bf16 v[236:239], a[24:27], a[120:123], v[236:239]
    v_mfma_f32_16x16x32_bf16 v[236:239], a[28:31], a[124:127], v[236:239]
    v_mfma_f32_16x16x32_bf16 v[232:235], a[28:31], a[116:119], v[232:235]
    s_add_u32 m0, s41, 57216
    v_mfma_f32_16x16x32_bf16 v[232:235], a[24:27], a[112:115], v[232:235]
    buffer_load_dwordx4 v2, s[20:23], s37 offen offset:128 lds
    v_mfma_f32_16x16x32_bf16 v[228:231], a[24:27], a[104:107], v[228:231]
    v_mfma_f32_16x16x32_bf16 v[228:231], a[28:31], a[108:111], v[228:231]
    ds_read_b128 a[8:11], v4 offset:37888
    v_mfma_f32_16x16x32_bf16 v[224:227], a[28:31], a[100:103], v[224:227]
    v_mfma_f32_16x16x32_bf16 v[224:227], a[24:27], a[96:99], v[224:227]
    v_mfma_f32_16x16x32_bf16 v[108:111], a[24:27], a[88:91], v[108:111]
    v_mfma_f32_16x16x32_bf16 v[108:111], a[28:31], a[92:95], v[108:111]
    s_add_u32 m0, s41, 73728
    ds_read_b128 a[12:15], v4 offset:54272
    v_mfma_f32_16x16x32_bf16 v[104:107], a[28:31], a[84:87], v[104:107]
    buffer_load_dwordx4 v3, s[24:27], s38 offen offset:0 lds
    v_mfma_f32_16x16x32_bf16 v[104:107], a[24:27], a[80:83], v[104:107]
    s_add_u32 s37, s37, s39
    v_mfma_f32_16x16x32_bf16 v[100:103], a[24:27], a[72:75], v[100:103]
    s_add_u32 s38, s38, 196608
    v_mfma_f32_16x16x32_bf16 v[100:103], a[28:31], a[76:79], v[100:103]
    v_mfma_f32_16x16x32_bf16 v[96:99], a[28:31], a[68:71], v[96:99]
    v_mfma_f32_16x16x32_bf16 v[96:99], a[24:27], a[64:67], v[96:99]
    s_waitcnt lgkmcnt(2)
    s_add_u32 m0, s41, 12288
    v_mfma_f32_16x16x32_bf16 v[112:115], a[0:3], a[64:67], v[112:115]
    buffer_load_dwordx4 v2, s[16:19], s37 offen offset:0 lds
    v_mfma_f32_16x16x32_bf16 v[112:115], a[4:7], a[68:71], v[112:115]
    v_mfma_f32_16x16x32_bf16 v[116:119], a[4:7], a[76:79], v[116:119]
    v_mfma_f32_16x16x32_bf16 v[116:119], a[0:3], a[72:75], v[116:119]
    v_mfma_f32_16x16x32_bf16 v[120:123], a[0:3], a[80:83], v[120:123]
    v_mfma_f32_16x16x32_bf16 v[120:123], a[4:7], a[84:87], v[120:123]
    s_add_u32 m0, s41, 28544
    v_mfma_f32_16x16x32_bf16 v[124:127], a[4:7], a[92:95], v[124:127]
    buffer_load_dwordx4 v2, s[16:19], s37 offen offset:128 lds
    v_mfma_f32_16x16x32_bf16 v[124:127], a[0:3], a[88:91], v[124:127]
    v_mfma_f32_16x16x32_bf16 v[240:243], a[0:3], a[96:99], v[240:243]
    v_mfma_f32_16x16x32_bf16 v[240:243], a[4:7], a[100:103], v[240:243]
    ds_read_b128 a[16:19], v4 offset:38912
    v_mfma_f32_16x16x32_bf16 v[244:247], a[4:7], a[108:111], v[244:247]
    v_mfma_f32_16x16x32_bf16 v[244:247], a[0:3], a[104:107], v[244:247]
    s_add_u32 m0, s41, 45056
    v_mfma_f32_16x16x32_bf16 v[248:251], a[0:3], a[112:115], v[248:251]
    buffer_load_dwordx4 v2, s[20:23], s37 offen offset:0 lds
    v_mfma_f32_16x16x32_bf16 v[248:251], a[4:7], a[116:119], v[248:251]
    ds_read_b128 a[20:23], v4 offset:55296
    v_mfma_f32_16x16x32_bf16 v[252:255], a[4:7], a[124:127], v[252:255]
    v_mfma_f32_16x16x32_bf16 v[252:255], a[0:3], a[120:123], v[252:255]
    v_mfma_f32_16x16x32_bf16 a[224:227], a[128:131], a[0:3], a[224:227]
    v_mfma_f32_16x16x32_bf16 a[224:227], a[132:135], a[4:7], a[224:227]
    s_add_u32 m0, s41, 61312
    v_mfma_f32_16x16x32_bf16 a[228:231], a[140:143], a[4:7], a[228:231]
    buffer_load_dwordx4 v2, s[20:23], s37 offen offset:128 lds
    v_mfma_f32_16x16x32_bf16 a[228:231], a[136:139], a[0:3], a[228:231]
    s_waitcnt lgkmcnt(2)
    v_mfma_f32_16x16x32_bf16 a[236:239], a[136:139], a[8:11], a[236:239]
    v_mfma_f32_16x16x32_bf16 a[236:239], a[140:143], a[12:15], a[236:239]
    v_mfma_f32_16x16x32_bf16 a[232:235], a[132:135], a[12:15], a[232:235]
    v_mfma_f32_16x16x32_bf16 a[232:235], a[128:131], a[8:11], a[232:235]
    ds_read_b128 a[24:27], v4 offset:39936
    v_mfma_f32_16x16x32_bf16 a[156:159], a[8:11], a[120:123], a[156:159]
    s_add_u32 m0, s41, 77824
    v_mfma_f32_16x16x32_bf16 a[156:159], a[12:15], a[124:127], a[156:159]
    buffer_load_dwordx4 v3, s[24:27], s38 offen offset:0 lds
    v_mfma_f32_16x16x32_bf16 a[152:155], a[12:15], a[116:119], a[152:155]
    s_add_u32 s37, s37, s39
    v_mfma_f32_16x16x32_bf16 a[152:155], a[8:11], a[112:115], a[152:155]
    s_add_u32 s38, s38, 196608
    ds_read_b128 a[28:31], v4 offset:56320
    v_mfma_f32_16x16x32_bf16 a[148:151], a[8:11], a[104:107], a[148:151]
    v_mfma_f32_16x16x32_bf16 a[148:151], a[12:15], a[108:111], a[148:151]
    v_mfma_f32_16x16x32_bf16 a[144:147], a[12:15], a[100:103], a[144:147]
    buffer_load_dword v46, v44, s[64:67], s49 offen
    v_mfma_f32_16x16x32_bf16 a[144:147], a[8:11], a[96:99], a[144:147]
    s_add_u32 s49, s49, s72
    v_mfma_f32_16x16x32_bf16 v[140:143], a[8:11], a[88:91], v[140:143]
    v_mfma_f32_16x16x32_bf16 v[140:143], a[12:15], a[92:95], v[140:143]
    v_mfma_f32_16x16x32_bf16 v[136:139], a[12:15], a[84:87], v[136:139]
    v_mfma_f32_16x16x32_bf16 v[136:139], a[8:11], a[80:83], v[136:139]
    buffer_load_dword v46, v44, s[64:67], s49 offen
    v_mfma_f32_16x16x32_bf16 v[132:135], a[8:11], a[72:75], v[132:135]
    s_add_u32 s49, s49, s72
    v_mfma_f32_16x16x32_bf16 v[132:135], a[12:15], a[76:79], v[132:135]
    v_mfma_f32_16x16x32_bf16 v[128:131], a[12:15], a[68:71], v[128:131]
    v_mfma_f32_16x16x32_bf16 v[128:131], a[8:11], a[64:67], v[128:131]
    s_waitcnt lgkmcnt(2)
    buffer_load_dword v46, v45, s[68:71], s51 offen
    v_mfma_f32_16x16x32_bf16 v[144:147], a[16:19], a[64:67], v[144:147]
    s_add_u32 s51, s51, 0x80000
    v_mfma_f32_16x16x32_bf16 v[144:147], a[20:23], a[68:71], v[144:147]
    s_waitcnt vmcnt(13) lgkmcnt(0)
    v_mfma_f32_16x16x32_bf16 v[148:151], a[20:23], a[76:79], v[148:151]
    s_barrier
    v_mfma_f32_16x16x32_bf16 v[148:151], a[16:19], a[72:75], v[148:151]
    ds_read_b64_tr_b16 a[32:33], v5 offset:0
    v_mfma_f32_16x16x32_bf16 v[152:155], a[16:19], a[80:83], v[152:155]
    ds_read_b64_tr_b16 a[34:35], v5 offset:512
    v_mfma_f32_16x16x32_bf16 v[152:155], a[20:23], a[84:87], v[152:155]
    ds_read_b64_tr_b16 a[36:37], v5 offset:4096
    v_mfma_f32_16x16x32_bf16 v[156:159], a[20:23], a[92:95], v[156:159]
    ds_read_b64_tr_b16 a[38:39], v5 offset:4608
    v_mfma_f32_16x16x32_bf16 v[156:159], a[16:19], a[88:91], v[156:159]
    ds_read_b64_tr_b16 a[40:41], v6 offset:0
    v_mfma_f32_16x16x32_bf16 a[160:163], a[16:19], a[96:99], a[160:163]
    ds_read_b64_tr_b16 a[42:43], v6 offset:512
    v_mfma_f32_16x16x32_bf16 a[160:163], a[20:23], a[100:103], a[160:163]
    ds_read_b64_tr_b16 a[44:45], v6 offset:4096
    v_mfma_f32_16x16x32_bf16 a[164:167], a[20:23], a[108:111], a[164:167]
    ds_read_b64_tr_b16 a[46:47], v6 offset:4608
    v_mfma_f32_16x16x32_bf16 a[164:167], a[16:19], a[104:107], a[164:167]
    ds_read_b64_tr_b16 a[48:49], v7 offset:0
    v_mfma_f32_16x16x32_bf16 a[168:171], a[16:19], a[112:115], a[168:171]
    ds_read_b64_tr_b16 a[50:51], v7 offset:512
    v_mfma_f32_16x16x32_bf16 a[168:171], a[20:23], a[116:119], a[168:171]
    ds_read_b64_tr_b16 a[52:53], v7 offset:4096
    v_mfma_f32_16x16x32_bf16 a[172:175], a[20:23], a[124:127], a[172:175]
    ds_read_b64_tr_b16 a[54:55], v7 offset:4608
    v_mfma_f32_16x16x32_bf16 a[172:175], a[16:19], a[120:123], a[172:175]
    ds_read_b64_tr_b16 a[56:57], v8 offset:0
    v_mfma_f32_16x16x32_bf16 a[240:243], a[128:131], a[16:19], a[240:243]
    ds_read_b64_tr_b16 a[58:59], v8 offset:512
    v_mfma_f32_16x16x32_bf16 a[240:243], a[132:135], a[20:23], a[240:243]
    ds_read_b64_tr_b16 a[60:61], v8 offset:4096
    v_mfma_f32_16x16x32_bf16 a[244:247], a[140:143], a[20:23], a[244:247]
    ds_read_b64_tr_b16 a[62:63], v8 offset:4608
    v_mfma_f32_16x16x32_bf16 a[244:247], a[136:139], a[16:19], a[244:247]
    ds_read_b128 a[0:3], v4 offset:0
    v_mfma_f32_16x16x32_bf16 a[176:179], a[24:27], a[96:99], a[176:179]
    ds_read_b128 a[4:7], v4 offset:16384
    v_mfma_f32_16x16x32_bf16 a[176:179], a[28:31], a[100:103], a[176:179]
    ds_read_b64_tr_b16 a[96:97], v5 offset:32768
    v_mfma_f32_16x16x32_bf16 a[180:183], a[28:31], a[108:111], a[180:183]
    ds_read_b64_tr_b16 a[98:99], v5 offset:33280
    v_mfma_f32_16x16x32_bf16 a[180:183], a[24:27], a[104:107], a[180:183]
    ds_read_b64_tr_b16 a[100:101], v5 offset:36864
    v_mfma_f32_16x16x32_bf16 a[184:187], a[24:27], a[112:115], a[184:187]
    ds_read_b64_tr_b16 a[102:103], v5 offset:37376
    v_mfma_f32_16x16x32_bf16 a[184:187], a[28:31], a[116:119], a[184:187]
    ds_read_b64_tr_b16 a[104:105], v6 offset:32768
    v_mfma_f32_16x16x32_bf16 a[188:191], a[28:31], a[124:127], a[188:191]
    ds_read_b64_tr_b16 a[106:107], v6 offset:33280
    v_mfma_f32_16x16x32_bf16 a[188:191], a[24:27], a[120:123], a[188:191]
    ds_read_b64_tr_b16 a[108:109], v6 offset:36864
    v_mfma_f32_16x16x32_bf16 a[248:251], a[128:131], a[24:27], a[248:251]
    ds_read_b64_tr_b16 a[110:111], v6 offset:37376
L_pw11:
    s_cbranch_execz L_pw_back
    v_mfma_f32_16x16x32_bf16 a[248:251], a[132:135], a[28:31], a[248:251]
    ds_read_b64_tr_b16 a[112:113], v7 offset:32768
    v_mfma_f32_16x16x32_bf16 a[252:255], a[140:143], a[28:31], a[252:255]
    ds_read_b64_tr_b16 a[114:115], v7 offset:33280
    v_mfma_f32_16x16x32_bf16 a[252:255], a[136:139], a[24:27], a[252:255]
    ds_read_b64_tr_b16 a[116:117], v7 offset:36864
    v_mfma_f32_16x16x32_bf16 v[160:163], a[24:27], a[64:67], v[160:163]
    ds_read_b64_tr_b16 a[118:119], v7 offset:37376
    v_mfma_f32_16x16x32_bf16 v[160:163], a[28:31], a[68:71], v[160:163]
    ds_read_b64_tr_b16 a[120:121], v8 offset:32768
    v_mfma_f32_16x16x32_bf16 v[164:167], a[28:31], a[76:79], v[164:167]
    ds_read_b64_tr_b16 a[122:123], v8 offset:33280
    v_mfma_f32_16x16x32_bf16 v[164:167], a[24:27], a[72:75], v[164:167]
    ds_read_b64_tr_b16 a[124:125], v8 offset:36864
    v_mfma_f32_16x16x32_bf16 v[168:171], a[24:27], a[80:83], v[168:171]
    ds_read_b64_tr_b16 a[126:127], v8 offset:37376
    v_mfma_f32_16x16x32_bf16 v[168:171], a[28:31], a[84:87], v[168:171]
    ds_read_b64_tr_b16 a[128:129], v9 offset:0
    v_mfma_f32_16x16x32_bf16 v[172:175], a[28:31], a[92:95], v[172:175]
    ds_read_b64_tr_b16 a[130:131], v9 offset:512
    v_mfma_f32_16x16x32_bf16 v[172:175], a[24:27], a[88:91], v[172:175]
    s_waitcnt lgkmcnt(15)
    ds_read_b64_tr_b16 a[132:133], v9 offset:4096
    v_mfma_f32_16x16x32_bf16 v[48:51], a[0:3], a[32:35], v[48:51]
    ds_read_b64_tr_b16 a[134:135], v9 offset:4608
    v_mfma_f32_16x16x32_bf16 v[48:51], a[4:7], a[36:39], v[48:51]
    ds_read_b64_tr_b16 a[136:137], v10 offset:0
    v_mfma_f32_16x16x32_bf16 v[52:55], a[4:7], a[44:47], v[52:55]
    ds_read_b64_tr_b16 a[138:139], v10 offset:512
    v_mfma_f32_16x16x32_bf16 v[52:55], a[0:3], a[40:43], v[52:55]
    ds_read_b64_tr_b16 a[140:141], v10 offset:4096
    v_mfma_f32_16x16x32_bf16 v[56:59], a[0:3], a[48:51], v[56:59]
    ds_read_b64_tr_b16 a[142:143], v10 offset:4608
    v_mfma_f32_16x16x32_bf16 v[56:59], a[4:7], a[52:55], v[56:59]
    ds_read_b128 a[8:11], v4 offset:1024
    v_mfma_f32_16x16x32_bf16 v[60:63], a[4:7], a[60:63], v[60:63]
    s_add_u32 m0, s40, 32768
    ds_read_b128 a[12:15], v4 offset:17408
    v_mfma_f32_16x16x32_bf16 v[60:63], a[0:3], a[56:59], v[60:63]
    s_waitcnt lgkmcnt(15)
    buffer_load_dwordx4 v1, s[12:15], s36 offen offset:0 sc1 lds
    v_mfma_f32_16x16x32_bf16 v[176:179], a[0:3], a[96:99], v[176:179]
    v_mfma_f32_16x16x32_bf16 v[176:179], a[4:7], a[100:103], v[176:179]
    ds_read_b128 a[16:19], v4 offset:2048
    v_mfma_f32_16x16x32_bf16 v[180:183], a[4:7], a[108:111], v[180:183]
    v_mfma_f32_16x16x32_bf16 v[180:183], a[0:3], a[104:107], v[180:183]
    s_waitcnt lgkmcnt(15)
    v_mfma_f32_16x16x32_bf16 v[184:187], a[0:3], a[112:115], v[184:187]
    buffer_load_dwordx4 v17, s[12:15], s36 offen offset:1024 sc1 lds
    v_mfma_f32_16x16x32_bf16 v[184:187], a[4:7], a[116:119], v[184:187]
    s_waitcnt lgkmcnt(11)
    ds_read_b128 a[20:23], v4 offset:18432
    v_mfma_f32_16x16x32_bf16 v[188:191], a[4:7], a[124:127], v[188:191]
    v_mfma_f32_16x16x32_bf16 v[188:191], a[0:3], a[120:123], v[188:191]
    s_waitcnt lgkmcnt(8)
    v_mfma_f32_16x16x32_bf16 a[192:195], a[128:131], a[0:3], a[192:195]
    v_mfma_f32_16x16x32_bf16 a[192:195], a[132:135], a[4:7], a[192:195]
    s_waitcnt lgkmcnt(4)
    buffer_load_dwordx4 v18, s[12:15], s36 offen offset:2048 sc1 lds
    v_mfma_f32_16x16x32_bf16 a[196:199], a[140:143], a[4:7], a[196:199]
    v_mfma_f32_16x16x32_bf16 a[196:199], a[136:139], a[0:3], a[196:199]
    s_waitcnt lgkmcnt(2)
    v_mfma_f32_16x16x32_bf16 a[204:207], a[136:139], a[8:11], a[204:207]
    v_mfma_f32_16x16x32_bf16 a[204:207], a[140:143], a[12:15], a[204:207]
    s_barrier
    v_mfma_f32_16x16x32_bf16 a[200:203], a[132:135], a[12:15], a[200:203]
    buffer_load_dwordx4 v19, s[12:15], s36 offen offset:3072 sc1 lds
    v_mfma_f32_16x16x32_bf16 a[200:203], a[128:131], a[8:11], a[200:203]
    s_add_u32 s36, s36, 0x80
    v_mfma_f32_16x16x32_bf16 v[204:207], a[8:11], a[120:123], v[204:207]
    v_mfma_f32_16x16x32_bf16 v[204:207], a[12:15], a[124:127], v[204:207]
    v_mfma_f32_16x16x32_bf16 v[200:203], a[12:15], a[116:119], v[200:203]
    s_add_u32 m0, s40, 49152
    v_mfma_f32_16x16x32_bf16 v[200:203], a[8:11], a[112:115], v[200:203]
    buffer_load_dwordx4 v1, s[12:15], s36 offen offset:0 sc1 lds
    v_mfma_f32_16x16x32_bf16 v[196:199], a[8:11], a[104:107], v[196:199]
    v_mfma_f32_16x16x32_bf16 v[196:199], a[12:15], a[108:111], v[196:199]
    ds_read_b128 a[24:27], v4 offset:3072
    v_mfma_f32_16x16x32_bf16 v[192:195], a[12:15], a[100:103], v[192:195]
    v_mfma_f32_16x16x32_bf16 v[192:195], a[8:11], a[96:99], v[192:195]
    v_mfma_f32_16x16x32_bf16 v[76:79], a[8:11], a[56:59], v[76:79]
    buffer_load_dwordx4 v17, s[12:15], s36 offen offset:1024 sc1 lds
    v_mfma_f32_16x16x32_bf16 v[76:79], a[12:15], a[60:63], v[76:79]
    ds_read_b128 a[28:31], v4 offset:19456
    v_mfma_f32_16x16x32_bf16 v[72:75], a[12:15], a[52:55], v[72:75]
    v_mfma_f32_16x16x32_bf16 v[72:75], a[8:11], a[48:51], v[72:75]
    v_mfma_f32_16x16x32_bf16 v[68:71], a[8:11], a[40:43], v[68:71]
    v_mfma_f32_16x16x32_bf16 v[68:71], a[12:15], a[44:47], v[68:71]
    buffer_load_dwordx4 v18, s[12:15], s36 offen offset:2048 sc1 lds
    v_mfma_f32_16x16x32_bf16 v[64:67], a[12:15], a[36:39], v[64:67]
    v_mfma_f32_16x16x32_bf16 v[64:67], a[8:11], a[32:35], v[64:67]
    s_waitcnt lgkmcnt(2)
    v_mfma_f32_16x16x32_bf16 v[80:83], a[16:19], a[32:35], v[80:83]
    v_mfma_f32_16x16x32_bf16 v[80:83], a[20:23], a[36:39], v[80:83]
    v_mfma_f32_16x16x32_bf16 v[84:87], a[20:23], a[44:47], v[84:87]
    buffer_load_dwordx4 v19, s[12:15], s36 offen offset:3072 sc1 lds
    v_mfma_f32_16x16x32_bf16 v[84:87], a[16:19], a[40:43], v[84:87]
    s_add_u32 s36, s36, 0x80
    v_mfma_f32_16x16x32_bf16 v[88:91], a[16:19], a[48:51], v[88:91]
    v_mfma_f32_16x16x32_bf16 v[88:91], a[20:23], a[52:55], v[88:91]
    v_mfma_f32_16x16x32_bf16 v[92:95], a[20:23], a[60:63], v[92:95]
    v_mfma_f32_16x16x32_bf16 v[92:95], a[16:19], a[56:59], v[92:95]
    s_add_u32 m0, s41, 0
    v_mfma_f32_16x16x32_bf16 v[208:211], a[16:19], a[96:99], v[208:211]
    buffer_load_dwordx4 v2, s[16:19], s37 offen offset:0 lds
    v_mfma_f32_16x16x32_bf16 v[208:211], a[20:23], a[100:103], v[208:211]
    ds_read_b128 a[0:3], v4 offset:4096
    v_mfma_f32_16x16x32_bf16 v[212:215], a[20:23], a[108:111], v[212:215]
    v_mfma_f32_16x16x32_bf16 v[212:215], a[16:19], a[104:107], v[212:215]
    v_mfma_f32_16x16x32_bf16 v[216:219], a[16:19], a[112:115], v[216:219]
    v_mfma_f32_16x16x32_bf16 v[216:219], a[20:23], a[116:119], v[216:219]
    ds_read_b128 a[4:7], v4 offset:20480
    v_mfma_f32_16x16x32_bf16 v[220:223], a[20:23], a[124:127], v[220:223]
    s_add_u32 m0, s41, 16256
    v_mfma_f32_16x16x32_bf16 v[220:223], a[16:19], a[120:123], v[220:223]
    buffer_load_dwordx4 v2, s[16:19], s37 offen offset:128 lds
    v_mfma_f32_16x16x32_bf16 a[208:211], a[128:131], a[16:19], a[208:211]
    v_mfma_f32_16x16x32_bf16 a[208:211], a[132:135], a[20:23], a[208:211]
    v_mfma_f32_16x16x32_bf16 a[212:215], a[140:143], a[20:23], a[212:215]
    v_mfma_f32_16x16x32_bf16 a[212:215], a[136:139], a[16:19], a[212:215]
    s_waitcnt lgkmcnt(2)
    v_mfma_f32_16x16x32_bf16 a[220:223], a[136:139], a[24:27], a[220:223]
    s_add_u32 m0, s41, 32768
    v_mfma_f32_16x16x32_bf16 a[220:223], a[140:143], a[28:31], a[220:223]
    buffer_load_dwordx4 v2, s[20:23], s37 offen offset:0 lds
    v_mfma_f32_16x16x32_bf16 a[216:219], a[132:135], a[28:31], a[216:219]
    v_mfma_f32_16x16x32_bf16 a[216:219], a[128:131], a[24:27], a[216:219]
    v_mfma_f32_16x16x32_bf16 v[236:239], a[24:27], a[120:123], v[236:239]
    v_mfma_f32_16x16x32_bf16 v[236:239], a[28:31], a[124:127], v[236:239]
    v_mfma_f32_16x16x32_bf16 v[232:235], a[28:31], a[116:119], v[232:235]
    s_add_u32 m0, s41, 49024
    v_mfma_f32_16x16x32_bf16 v[232:235], a[24:27], a[112:115], v[232:235]
    buffer_load_dwordx4 v2, s[20:23], s37 offen offset:128 lds
    v_mfma_f32_16x16x32_bf16 v[228:231], a[24:27], a[104:107], v[228:231]
    v_mfma_f32_16x16x32_bf16 v[228:231], a[28:31], a[108:111], v[228:231]
    ds_read_b128 a[8:11], v4 offset:5120
    v_mfma_f32_16x16x32_bf16 v[224:227], a[28:31], a[100:103], v[224:227]
    v_mfma_f32_16x16x32_bf16 v[224:227], a[24:27], a[96:99], v[224:227]
    v_mfma_f32_16x16x32_bf16 v[108:111], a[24:27], a[56:59], v[108:111]
    v_mfma_f32_16x16x32_bf16 v[108:111], a[28:31], a[60:63], v[108:111]
    s_add_u32 m0, s41, 65536
    ds_read_b128 a[12:15], v4 offset:21504
    v_mfma_f32_16x16x32_bf16 v[104:107], a[28:31], a[52:55], v[104:107]
    buffer_load_dwordx4 v3, s[24:27], s38 offen offset:0 lds
    v_mfma_f32_16x16x32_bf16 v[104:107], a[24:27], a[48:51], v[104:107]
    s_add_u32 s37, s37, s39
    v_mfma_f32_16x16x32_bf16 v[100:103], a[24:27], a[40:43], v[100:103]
    s_add_u32 s38, s38, 196608
    v_mfma_f32_16x16x32_bf16 v[100:103], a[28:31], a[44:47], v[100:103]
    v_mfma_f32_16x16x32_bf16 v[96:99], a[28:31], a[36:39], v[96:99]
    v_mfma_f32_16x16x32_bf16 v[96:99], a[24:27], a[32:35], v[96:99]
    s_waitcnt lgkmcnt(2)
    s_add_u32 m0, s41, 4096
    v_mfma_f32_16x16x32_bf16 v[112:115], a[0:3], a[32:35], v[112:115]
    buffer_load_dwordx4 v2, s[16:19], s37 offen offset:0 lds
    v_mfma_f32_16x16x32_bf16 v[112:115], a[4:7], a[36:39], v[112:115]
    v_mfma_f32_16x16x32_bf16 v[116:119], a[4:7], a[44:47], v[116:119]
    v_mfma_f32_16x16x32_bf16 v[116:119], a[0:3], a[40:43], v[116:119]
    v_mfma_f32_16x16x32_bf16 v[120:123], a[0:3], a[48:51], v[120:123]
    v_mfma_f32_16x16x32_bf16 v[120:123], a[4:7], a[52:55], v[120:123]
    s_add_u32 m0, s41, 20352
    v_mfma_f32_16x16x32_bf16 v[124:127], a[4:7], a[60:63], v[124:127]
    buffer_load_dwordx4 v2, s[16:19], s37 offen offset:128 lds
    v_mfma_f32_16x16x32_bf16 v[124:127], a[0:3], a[56:59], v[124:127]
    v_mfma_f32_16x16x32_bf16 v[240:243], a[0:3], a[96:99], v[240:243]
    v_mfma_f32_16x16x32_bf16 v[240:243], a[4:7], a[100:103], v[240:243]
    ds_read_b128 a[16:19], v4 offset:6144
    v_mfma_f32_16x16x32_bf16 v[244:247], a[4:7], a[108:111], v[244:247]
    v_mfma_f32_16x16x32_bf16 v[244:247], a[0:3], a[104:107], v[244:247]
    s_add_u32 m0, s41, 36864
    v_mfma_f32_16x16x32_bf16 v[248:251], a[0:3], a[112:115], v[248:251]
    buffer_load_dwordx4 v2, s[20:23], s37 offen offset:0 lds
    v_mfma_f32_16x16x32_bf16 v[248:251], a[4:7], a[116:119], v[248:251]
    ds_read_b128 a[20:23], v4 offset:22528
    v_mfma_f32_16x16x32_bf16 v[252:255], a[4:7], a[124:127], v[252:255]
    v_mfma_f32_16x16x32_bf16 v[252:255], a[0:3], a[120:123], v[252:255]
    v_mfma_f32_16x16x32_bf16 a[224:227], a[128:131], a[0:3], a[224:227]
    v_mfma_f32_16x16x32_bf16 a[224:227], a[132:135], a[4:7], a[224:227]
    s_add_u32 m0, s41, 53120
    v_mfma_f32_16x16x32_bf16 a[228:231], a[140:143], a[4:7], a[228:231]
    buffer_load_dwordx4 v2, s[20:23], s37 offen offset:128 lds
    v_mfma_f32_16x16x32_bf16 a[228:231], a[136:139], a[0:3], a[228:231]
    s_waitcnt lgkmcnt(2)
    v_mfma_f32_16x16x32_bf16 a[236:239], a[136:139], a[8:11], a[236:239]
    v_mfma_f32_16x16x32_bf16 a[236:239], a[140:143], a[12:15], a[236:239]
    v_mfma_f32_16x16x32_bf16 a[232:235], a[132:135], a[12:15], a[232:235]
    v_mfma_f32_16x16x32_bf16 a[232:235], a[128:131], a[8:11], a[232:235]
    ds_read_b128 a[24:27], v4 offset:7168
    v_mfma_f32_16x16x32_bf16 a[156:159], a[8:11], a[120:123], a[156:159]
    s_add_u32 m0, s41, 69632
    v_mfma_f32_16x16x32_bf16 a[156:159], a[12:15], a[124:127], a[156:159]
    buffer_load_dwordx4 v3, s[24:27], s38 offen offset:0 lds
    v_mfma_f32_16x16x32_bf16 a[152:155], a[12:15], a[116:119], a[152:155]
    s_add_u32 s37, s37, s39
    v_mfma_f32_16x16x32_bf16 a[152:155], a[8:11], a[112:115], a[152:155]
    s_add_u32 s38, s38, 196608
    ds_read_b128 a[28:31], v4 offset:23552
    v_mfma_f32_16x16x32_bf16 a[148:151], a[8:11], a[104:107], a[148:151]
    v_mfma_f32_16x16x32_bf16 a[148:151], a[12:15], a[108:111], a[148:151]
    v_mfma_f32_16x16x32_bf16 a[144:147], a[12:15], a[100:103], a[144:147]
    buffer_load_dword v46, v44, s[64:67], s49 offen
    v_mfma_f32_16x16x32_bf16 a[144:147], a[8:11], a[96:99], a[144:147]
    s_add_u32 s49, s49, s72
    v_mfma_f32_16x16x32_bf16 v[140:143], a[8:11], a[56:59], v[140:143]
    v_mfma_f32_16x16x32_bf16 v[140:143], a[12:15], a[60:63], v[140:143]
    v_mfma_f32_16x16x32_bf16 v[136:139], a[12:15], a[52:55], v[136:139]
    v_mfma_f32_16x16x32_bf16 v[136:139], a[8:11], a[48:51], v[136:139]
    buffer_load_dword v46, v44, s[64:67], s49 offen
    v_mfma_f32_16x16x32_bf16 v[132:135], a[8:11], a[40:43], v[132:135]
    s_add_u32 s49, s49, s72
    v_mfma_f32_16x16x32_bf16 v[132:135], a[12:15], a[44:47], v[132:135]
    v_mfma_f32_16x16x32_bf16 v[128:131], a[12:15], a[36:39], v[128:131]
    v_mfma_f32_16x16x32_bf16 v[128:131], a[8:11], a[32:35], v[128:131]
    s_waitcnt lgkmcnt(2)
    v_mfma_f32_16x16x32_bf16 v[144:147], a[16:19], a[32:35], v[144:147]
    v_mfma_f32_16x16x32_bf16 v[144:147], a[20:23], a[36:39], v[144:147]
    s_waitcnt vmcnt(12) lgkmcnt(0)
    v_mfma_f32_16x16x32_bf16 v[148:151], a[20:23], a[44:47], v[148:151]
    s_barrier
    v_mfma_f32_16x16x32_bf16 v[148:151], a[16:19], a[40:43], v[148:151]
    ds_read_b64_tr_b16 a[64:65], v5 offset:8192
    v_mfma_f32_16x16x32_bf16 v[152:155], a[16:19], a[48:51], v[152:155]
    ds_read_b64_tr_b16 a[66:67], v5 offset:8704
    v_mfma_f32_16x16x32_bf16 v[152:155], a[20:23], a[52:55], v[152:155]
    ds_read_b64_tr_b16 a[68:69], v5 offset:12288
    v_mfma_f32_16x16x32_bf16 v[156:159], a[20:23], a[60:63], v[156:159]
    ds_read_b64_tr_b16 a[70:71], v5 offset:12800
    v_mfma_f32_16x16x32_bf16 v[156:159], a[16:19], a[56:59], v[156:159]
    ds_read_b64_tr_b16 a[72:73], v6 offset:8192
    v_mfma_f32_16x16x32_bf16 a[160:163], a[16:19], a[96:99], a[160:163]
    ds_read_b64_tr_b16 a[74:75], v6 offset:8704
    v_mfma_f32_16x16x32_bf16 a[160:163], a[20:23], a[100:103], a[160:163]
    ds_read_b64_tr_b16 a[76:77], v6 offset:12288
    v_mfma_f32_16x16x32_bf16 a[164:167], a[20:23], a[108:111], a[164:167]
    ds_read_b64_tr_b16 a[78:79], v6 offset:12800
    v_mfma_f32_16x16x32_bf16 a[164:167], a[16:19], a[104:107], a[164:167]
    ds_read_b64_tr_b16 a[80:81], v7 offset:8192
    v_mfma_f32_16x16x32_bf16 a[168:171], a[16:19], a[112:115], a[168:171]
    ds_read_b64_tr_b16 a[82:83], v7 offset:8704
    v_mfma_f32_16x16x32_bf16 a[168:171], a[20:23], a[116:119], a[168:171]
    ds_read_b64_tr_b16 a[84:85], v7 offset:12288
    v_mfma_f32_16x16x32_bf16 a[172:175], a[20:23], a[124:127], a[172:175]
    ds_read_b64_tr_b16 a[86:87], v7 offset:12800
    v_mfma_f32_16x16x32_bf16 a[172:175], a[16:19], a[120:123], a[172:175]
    ds_read_b64_tr_b16 a[88:89], v8 offset:8192
    v_mfma_f32_16x16x32_bf16 a[240:243], a[128:131], a[16:19], a[240:243]
    ds_read_b64_tr_b16 a[90:91], v8 offset:8704
    v_mfma_f32_16x16x32_bf16 a[240:243], a[132:135], a[20:23], a[240:243]
    ds_read_b64_tr_b16 a[92:93], v8 offset:12288
    v_mfma_f32_16x16x32_bf16 a[244:247], a[140:143], a[20:23], a[244:247]
    ds_read_b64_tr_b16 a[94:95], v8 offset:12800
    v_mfma_f32_16x16x32_bf16 a[244:247], a[136:139], a[16:19], a[244:247]
    ds_read_b128 a[0:3], v4 offset:32768
    v_mfma_f32_16x16x32_bf16 a[176:179], a[24:27], a[96:99], a[176:179]
    ds_read_b128 a[4:7], v4 offset:49152
    v_mfma_f32_16x16x32_bf16 a[176:179], a[28:31], a[100:103], a[176:179]
    ds_read_b64_tr_b16 a[96:97], v5 offset:40960
    v_mfma_f32_16x16x32_bf16 a[180:183], a[28:31], a[108:111], a[180:183]
    ds_read_b64_tr_b16 a[98:99], v5 offset:41472
    v_mfma_f32_16x16x32_bf16 a[180:183], a[24:27], a[104:107], a[180:183]
    ds_read_b64_tr_b16 a[100:101], v5 offset:45056
    v_mfma_f32_16x16x32_bf16 a[184:187], a[24:27], a[112:115], a[184:187]
    ds_read_b64_tr_b16 a[102:103], v5 offset:45568
    v_mfma_f32_16x16x32_bf16 a[184:187], a[28:31], a[116:119], a[184:187]
    ds_read_b64_tr_b16 a[104:105], v6 offset:40960
    v_mfma_f32_16x16x32_bf16 a[188:191], a[28:31], a[124:127], a[188:191]
    ds_read_b64_tr_b16 a[106:107], v6 offset:41472
    v_mfma_f32_16x16x32_bf16 a[188:191], a[24:27], a[120:123], a[188:191]
    ds_read_b64_tr_b16 a[108:109], v6 offset:45056
    v_mfma_f32_16x16x32_bf16 a[248:251], a[128:131], a[24:27], a[248:251]
    ds_read_b64_tr_b16 a[110:111], v6 offset:45568
    v_mfma_f32_16x16x32_bf16 a[248:251], a[132:135], a[28:31], a[248:251]
    ds_read_b64_tr_b16 a[112:113], v7 offset:40960
    v_mfma_f32_16x16x32_bf16 a[252:255], a[140:143], a[28:31], a[252:255]
    ds_read_b64_tr_b16 a[114:115], v7 offset:41472
    v_mfma_f32_16x16x32_bf16 a[252:255], a[136:139], a[24:27], a[252:255]
    ds_read_b64_tr_b16 a[116:117], v7 offset:45056
    v_mfma_f32_16x16x32_bf16 v[160:163], a[24:27], a[32:35], v[160:163]
    ds_read_b64_tr_b16 a[118:119], v7 offset:45568
    v_mfma_f32_16x16x32_bf16 v[160:163], a[28:31], a[36:39], v[160:163]
    ds_read_b64_tr_b16 a[120:121], v8 offset:40960
    v_mfma_f32_16x16x32_bf16 v[164:167], a[28:31], a[44:47], v[164:167]
    ds_read_b64_tr_b16 a[122:123], v8 offset:41472
    v_mfma_f32_16x16x32_bf16 v[164:167], a[24:27], a[40:43], v[164:167]
    ds_read_b64_tr_b16 a[124:125], v8 offset:45056
    v_mfma_f32_16x16x32_bf16 v[168:171], a[24:27], a[48:51], v[168:171]
    s_sub_u32 s42, s42, 1
    ds_read_b64_tr_b16 a[126:127], v8 offset:45568
    v_mfma_f32_16x16x32_bf16 v[168:171], a[28:31], a[52:55], v[168:171]
    ds_read_b64_tr_b16 a[128:129], v9 offset:8192
    v_mfma_f32_16x16x32_bf16 v[172:175], a[28:31], a[60:63], v[172:175]
    ds_read_b64_tr_b16 a[130:131], v9 offset:8704
    v_mfma_f32_16x16x32_bf16 v[172:175], a[24:27], a[56:59], v[172:175]
    s_waitcnt lgkmcnt(15)
    s_cmp_lg_u32 s42, 0
    ds_read_b64_tr_b16 a[132:133], v9 offset:12288
    s_cbranch_scc1 L_k1_loop_v
    v_mfma_f32_16x16x32_bf16 v[48:51], a[0:3], a[64:67], v[48:51]
    s_add_u32 m0, s40, 0
    ds_read_b64_tr_b16 a[134:135], v9 offset:12800
    v_mfma_f32_16x16x32_bf16 v[48:51], a[4:7], a[68:71], v[48:51]
    buffer_load_dwordx4 v1, s[12:15], s36 offen offset:0 sc1 lds
    ds_read_b64_tr_b16 a[136:137], v10 offset:8192
    v_mfma_f32_16x16x32_bf16 v[52:55], a[4:7], a[76:79], v[52:55]
    ds_read_b64_tr_b16 a[138:139], v10 offset:8704
    v_mfma_f32_16x16x32_bf16 v[52:55], a[0:3], a[72:75], v[52:55]
    ds_read_b64_tr_b16 a[140:141], v10 offset:12288
    v_mfma_f32_16x16x32_bf16 v[56:59], a[0:3], a[80:83], v[56:59]
    ds_read_b64_tr_b16 a[142:143], v10 offset:12800
    v_mfma_f32_16x16x32_bf16 v[56:59], a[4:7], a[84:87], v[56:59]
    buffer_load_dwordx4 v17, s[12:15], s36 offen offset:1024 sc1 lds
    ds_read_b128 a[8:11], v4 offset:33792
    v_mfma_f32_16x16x32_bf16 v[60:63], a[4:7], a[92:95], v[60:63]
    ds_read_b128 a[12:15], v4 offset:50176
    v_mfma_f32_16x16x32_bf16 v[60:63], a[0:3], a[88:91], v[60:63]
    s_waitcnt lgkmcnt(15)
    v_mfma_f32_16x16x32_bf16 v[176:179], a[0:3], a[96:99], v[176:179]
    ds_read_b128 a[16:19], v4 offset:34816
    v_mfma_f32_16x16x32_bf16 v[176:179], a[4:7], a[100:103], v[176:179]
    buffer_load_dwordx4 v18, s[12:15], s36 offen offset:2048 sc1 lds
    v_mfma_f32_16x16x32_bf16 v[180:183], a[4:7], a[108:111], v[180:183]
    ds_read_b128 a[20:23], v4 offset:51200
    v_mfma_f32_16x16x32_bf16 v[180:183], a[0:3], a[104:107], v[180:183]
    s_waitcnt lgkmcnt(15)
    v_mfma_f32_16x16x32_bf16 v[184:187], a[0:3], a[112:115], v[184:187]
    ds_read_b128 a[24:27], v4 offset:35840
    v_mfma_f32_16x16x32_bf16 v[184:187], a[4:7], a[116:119], v[184:187]
    s_waitcnt lgkmcnt(13)
    buffer_load_dwordx4 v19, s[12:15], s36 offen offset:3072 sc1 lds
    v_mfma_f32_16x16x32_bf16 v[188:191], a[4:7], a[124:127], v[188:191]
    s_add_u32 s36, s36, 0x80
    ds_read_b128 a[28:31], v4 offset:52224
    v_mfma_f32_16x16x32_bf16 v[188:191], a[0:3], a[120:123], v[188:191]
    s_waitcnt lgkmcnt(10)
    v_mfma_f32_16x16x32_bf16 a[192:195], a[128:131], a[0:3], a[192:195]
    s_add_u32 m0, s40, 16384
    ds_read_b128 a[32:35], v4 offset:36864
    v_mfma_f32_16x16x32_bf16 a[192:195], a[132:135], a[4:7], a[192:195]
    s_waitcnt lgkmcnt(7)
    buffer_load_dwordx4 v1, s[12:15], s36 offen offset:0 sc1 lds
    v_mfma_f32_16x16x32_bf16 a[196:199], a[140:143], a[4:7], a[196:199]
    ds_read_b128 a[36:39], v4 offset:53248
    v_mfma_f32_16x16x32_bf16 a[196:199], a[136:139], a[0:3], a[196:199]
    s_waitcnt lgkmcnt(6)
    v_mfma_f32_16x16x32_bf16 a[204:207], a[136:139], a[8:11], a[204:207]
    ds_read_b128 a[40:43], v4 offset:37888
    v_mfma_f32_16x16x32_bf16 a[204:207], a[140:143], a[12:15], a[204:207]
    s_barrier
    buffer_load_dwordx4 v17, s[12:15], s36 offen offset:1024 sc1 lds
    v_mfma_f32_16x16x32_bf16 a[200:203], a[132:135], a[12:15], a[200:203]
    ds_read_b128 a[44:47], v4 offset:54272
    v_mfma_f32_16x16x32_bf16 a[200:203], a[128:131], a[8:11], a[200:203]
    v_mfma_f32_16x16x32_bf16 v[204:207], a[8:11], a[120:123], v[204:207]
    ds_read_b128 a[48:51], v4 offset:38912
    v_mfma_f32_16x16x32_bf16 v[204:207], a[12:15], a[124:127], v[204:207]
    buffer_load_dwordx4 v18, s[12:15], s36 offen offset:2048 sc1 lds
    v_mfma_f32_16x16x32_bf16 v[200:203], a[12:15], a[116:119], v[200:203]
    ds_read_b128 a[52:55], v4 offset:55296
    v_mfma_f32_16x16x32_bf16 v[200:203], a[8:11], a[112:115], v[200:203]
    v_mfma_f32_16x16x32_bf16 v[196:199], a[8:11], a[104:107], v[196:199]
    ds_read_b128 a[56:59], v4 offset:39936
    v_mfma_f32_16x16x32_bf16 v[196:199], a[12:15], a[108:111], v[196:199]
    buffer_load_dwordx4 v19, s[12:15], s36 offen offset:3072 sc1 lds
    v_mfma_f32_16x16x32_bf16 v[192:195], a[12:15], a[100:103], v[192:195]
    s_add_u32 s36, s36, 0x80
    ds_read_b128 a[60:63], v4 offset:56320
    v_mfma_f32_16x16x32_bf16 v[192:195], a[8:11], a[96:99], v[192:195]
    v_mfma_f32_16x16x32_bf16 v[76:79], a[8:11], a[88:91], v[76:79]
    v_mfma_f32_16x16x32_bf16 v[76:79], a[12:15], a[92:95], v[76:79]
    s_add_u32 m0, s41, 8192
    v_mfma_f32_16x16x32_bf16 v[72:75], a[12:15], a[84:87], v[72:75]
    buffer_load_dwordx4 v2, s[16:19], s37 offen offset:0 lds
    v_mfma_f32_16x16x32_bf16 v[72:75], a[8:11], a[80:83], v[72:75]
    v_mfma_f32_16x16x32_bf16 v[68:71], a[8:11], a[72:75], v[68:71]
    v_mfma_f32_16x16x32_bf16 v[68:71], a[12:15], a[76:79], v[68:71]
    s_add_u32 m0, s41, 24448
    v_mfma_f32_16x16x32_bf16 v[64:67], a[12:15], a[68:71], v[64:67]
    buffer_load_dwordx4 v2, s[16:19], s37 offen offset:128 lds
    v_mfma_f32_16x16x32_bf16 v[64:67], a[8:11], a[64:67], v[64:67]
    s_waitcnt lgkmcnt(10)
    v_mfma_f32_16x16x32_bf16 v[80:83], a[16:19], a[64:67], v[80:83]
    s_waitcnt lgkmcnt(0)
    v_mfma_f32_16x16x32_bf16 v[80:83], a[20:23], a[68:71], v[80:83]
    s_barrier
    s_add_u32 m0, s41, 40960
    v_mfma_f32_16x16x32_bf16 v[84:87], a[20:23], a[76:79], v[84:87]
    buffer_load_dwordx4 v2, s[20:23], s37 offen offset:0 lds
    v_mfma_f32_16x16x32_bf16 v[84:87], a[16:19], a[72:75], v[84:87]
    v_mfma_f32_16x16x32_bf16 v[88:91], a[16:19], a[80:83], v[88:91]
    v_mfma_f32_16x16x32_bf16 v[88:91], a[20:23], a[84:87], v[88:91]
    s_add_u32 m0, s41, 57216
    v_mfma_f32_16x16x32_bf16 v[92:95], a[20:23], a[92:95], v[92:95]
    buffer_load_dwordx4 v2, s[20:23], s37 offen offset:128 lds
    v_mfma_f32_16x16x32_bf16 v[92:95], a[16:19], a[88:91], v[92:95]
    v_mfma_f32_16x16x32_bf16 v[208:211], a[16:19], a[96:99], v[208:211]
    v_mfma_f32_16x16x32_bf16 v[208:211], a[20:23], a[100:103], v[208:211]
    s_add_u32 m0, s41, 73728
    v_mfma_f32_16x16x32_bf16 v[212:215], a[20:23], a[108:111], v[212:215]
    buffer_load_dwordx4 v3, s[24:27], s38 offen offset:0 lds
    v_mfma_f32_16x16x32_bf16 v[212:215], a[16:19], a[104:107], v[212:215]
    s_add_u32 s37, s37, s39
    v_mfma_f32_16x16x32_bf16 v[216:219], a[16:19], a[112:115], v[216:219]
    s_add_u32 s38, s38, 196608
    v_mfma_f32_16x16x32_bf16 v[216:219], a[20:23], a[116:119], v[216:219]
    s_add_u32 m0, s41, 12288
    v_mfma_f32_16x16x32_bf16 v[220:223], a[20:23], a[124:127], v[220:223]
    buffer_load_dwordx4 v2, s[16:19], s37 offen offset:0 lds
    v_mfma_f32_16x16x32_bf16 v[220:223], a[16:19], a[120:123], v[220:223]
    v_mfma_f32_16x16x32_bf16 a[208:211], a[128:131], a[16:19], a[208:211]
    v_mfma_f32_16x16x32_bf16 a[208:211], a[132:135], a[20:23], a[208:211]
    s_add_u32 m0, s41, 28544
    v_mfma_f32_16x16x32_bf16 a[212:215], a[140:143], a[20:23], a[212:215]
    buffer_load_dwordx4 v2, s[16:19], s37 offen offset:128 lds
    v_mfma_f32_16x16x32_bf16 a[212:215], a[136:139], a[16:19], a[212:215]
    v_mfma_f32_16x16x32_bf16 a[220:223], a[136:139], a[24:27], a[220:223]
    v_mfma_f32_16x16x32_bf16 a[220:223], a[140:143], a[28:31], a[220:223]
    s_add_u32 m0, s41, 45056
    v_mfma_f32_16x16x32_bf16 a[216:219], a[132:135], a[28:31], a[216:219]
    buffer_load_dwordx4 v2, s[20:23], s37 offen offset:0 lds
    v_mfma_f32_16x16x32_bf16 a[216:219], a[128:131], a[24:27], a[216:219]
    v_mfma_f32_16x16x32_bf16 v[236:239], a[24:27], a[120:123], v[236:239]
    v_mfma_f32_16x16x32_bf16 v[236:239], a[28:31], a[124:127], v[236:239]
    s_add_u32 m0, s41, 61312
    v_mfma_f32_16x16x32_bf16 v[232:235], a[28:31], a[116:119], v[232:235]
    buffer_load_dwordx4 v2, s[20:23], s37 offen offset:128 lds
    v_mfma_f32_16x16x32_bf16 v[232:235], a[24:27], a[112:115], v[232:235]
    v_mfma_f32_16x16x32_bf16 v[228:231], a[24:27], a[104:107], v[228:231]
    v_mfma_f32_16x16x32_bf16 v[228:231], a[28:31], a[108:111], v[228:231]
    s_add_u32 m0, s41, 77824
    v_mfma_f32_16x16x32_bf16 v[224:227], a[28:31], a[100:103], v[224:227]
    buffer_load_dwordx4 v3, s[24:27], s38 offen offset:0 lds
    v_mfma_f32_16x16x32_bf16 v[224:227], a[24:27], a[96:99], v[224:227]
    s_add_u32 s37, s37, s39
    v_mfma_f32_16x16x32_bf16 v[108:111], a[24:27], a[88:91], v[108:111]
    s_add_u32 s38, s38, 196608
    v_mfma_f32_16x16x32_bf16 v[108:111], a[28:31], a[92:95], v[108:111]
    v_mfma_f32_16x16x32_bf16 v[104:107], a[28:31], a[84:87], v[104:107]
    s_add_u32 m0, s40, 32768
    v_mfma_f32_16x16x32_bf16 v[104:107], a[24:27], a[80:83], v[104:107]
    buffer_load_dwordx4 v1, s[12:15], s36 offen offset:0 sc1 lds
    v_mfma_f32_16x16x32_bf16 v[100:103], a[24:27], a[72:75], v[100:103]
    v_mfma_f32_16x16x32_bf16 v[100:103], a[28:31], a[76:79], v[100:103]
    v_mfma_f32_16x16x32_bf16 v[96:99], a[28:31], a[68:71], v[96:99]
    v_mfma_f32_16x16x32_bf16 v[96:99], a[24:27], a[64:67], v[96:99]
    buffer_load_dwordx4 v17, s[12:15], s36 offen offset:1024 sc1 lds
    v_mfma_f32_16x16x32_bf16 v[112:115], a[32:35], a[64:67], v[112:115]
    v_mfma_f32_16x16x32_bf16 v[112:115], a[36:39], a[68:71], v[112:115]
    v_mfma_f32_16x16x32_bf16 v[116:119], a[36:39], a[76:79], v[116:119]
    v_mfma_f32_16x16x32_bf16 v[116:119], a[32:35], a[72:75], v[116:119]
    buffer_load_dwordx4 v18, s[12:15], s36 offen offset:2048 sc1 lds
    v_mfma_f32_16x16x32_bf16 v[120:123], a[32:35], a[80:83], v[120:123]
    v_mfma_f32_16x16x32_bf16 v[120:123], a[36:39], a[84:87], v[120:123]
    v_mfma_f32_16x16x32_bf16 v[124:127], a[36:39], a[92:95], v[124:127]
    v_mfma_f32_16x16x32_bf16 v[124:127], a[32:35], a[88:91], v[124:127]
    buffer_load_dwordx4 v19, s[12:15], s36 offen offset:3072 sc1 lds
    v_mfma_f32_16x16x32_bf16 v[240:243], a[32:35], a[96:99], v[240:243]
    s_add_u32 s36, s36, 0x80
    v_mfma_f32_16x16x32_bf16 v[240:243], a[36:39], a[100:103], v[240:243]
    v_mfma_f32_16x16x32_bf16 v[244:247], a[36:39], a[108:111], v[244:247]
    s_add_u32 m0, s40, 49152
    v_mfma_f32_16x16x32_bf16 v[244:247], a[32:35], a[104:107], v[244:247]
    buffer_load_dwordx4 v1, s[12:15], s36 offen offset:0 sc1 lds
    v_mfma_f32_16x16x32_bf16 v[248:251], a[32:35], a[112:115], v[248:251]
    v_mfma_f32_16x16x32_bf16 v[248:251], a[36:39], a[116:119], v[248:251]
    v_mfma_f32_16x16x32_bf16 v[252:255], a[36:39], a[124:127], v[252:255]
    v_mfma_f32_16x16x32_bf16 v[252:255], a[32:35], a[120:123], v[252:255]
    buffer_load_dwordx4 v17, s[12:15], s36 offen offset:1024 sc1 lds
    v_mfma_f32_16x16x32_bf16 a[224:227], a[128:131], a[32:35], a[224:227]
    v_mfma_f32_16x16x32_bf16 a[224:227], a[132:135], a[36:39], a[224:227]
    v_mfma_f32_16x16x32_bf16 a[228:231], a[140:143], a[36:39], a[228:231]
    v_mfma_f32_16x16x32_bf16 a[228:231], a[136:139], a[32:35], a[228:231]
    buffer_load_dwordx4 v18, s[12:15], s36 offen offset:2048 sc1 lds
    v_mfma_f32_16x16x32_bf16 a[236:239], a[136:139], a[40:43], a[236:239]
    v_mfma_f32_16x16x32_bf16 a[236:239], a[140:143], a[44:47], a[236:239]
    v_mfma_f32_16x16x32_bf16 a[232:235], a[132:135], a[44:47], a[232:235]
    v_mfma_f32_16x16x32_bf16 a[232:235], a[128:131], a[40:43], a[232:235]
    buffer_load_dwordx4 v19, s[12:15], s36 offen offset:3072 sc1 lds
    v_mfma_f32_16x16x32_bf16 a[156:159], a[40:43], a[120:123], a[156:159]
    s_add_u32 s36, s36, 0x80
    v_mfma_f32_16x16x32_bf16 a[156:159], a[44:47], a[124:127], a[156:159]
    v_mfma_f32_16x16x32_bf16 a[152:155], a[44:47], a[116:119], a[152:155]
    v_mfma_f32_16x16x32_bf16 a[152:155], a[40:43], a[112:115], a[152:155]
    v_mfma_f32_16x16x32_bf16 a[148:151], a[40:43], a[104:107], a[148:151]
    s_waitcnt vmcnt(18)
    v_mfma_f32_16x16x32_bf16 a[148:151], a[44:47], a[108:111], a[148:151]
    s_barrier
    ds_read_b128 a[4:7], v4 offset:0
    v_mfma_f32_16x16x32_bf16 a[144:147], a[44:47], a[100:103], a[144:147]
    ds_read_b64_tr_b16 a[0:1], v9 offset:0
    v_mfma_f32_16x16x32_bf16 a[144:147], a[40:43], a[96:99], a[144:147]
    ds_read_b64_tr_b16 a[2:3], v9 offset:512
    v_mfma_f32_16x16x32_bf16 v[140:143], a[40:43], a[88:91], v[140:143]
    ds_read_b128 a[12:15], v4 offset:16384
    v_mfma_f32_16x16x32_bf16 v[140:143], a[44:47], a[92:95], v[140:143]
    ds_read_b64_tr_b16 a[8:9], v9 offset:4096
    v_mfma_f32_16x16x32_bf16 v[136:139], a[44:47], a[84:87], v[136:139]
    ds_read_b64_tr_b16 a[10:11], v9 offset:4608
    v_mfma_f32_16x16x32_bf16 v[136:139], a[40:43], a[80:83], v[136:139]
    ds_read_b64_tr_b16 a[20:21], v10 offset:4096
    v_mfma_f32_16x16x32_bf16 v[132:135], a[40:43], a[72:75], v[132:135]
    ds_read_b64_tr_b16 a[22:23], v10 offset:4608
    v_mfma_f32_16x16x32_bf16 v[132:135], a[44:47], a[76:79], v[132:135]
    ds_read_b64_tr_b16 a[16:17], v10 offset:0
    v_mfma_f32_16x16x32_bf16 v[128:131], a[44:47], a[68:71], v[128:131]
    ds_read_b64_tr_b16 a[18:19], v10 offset:512
    v_mfma_f32_16x16x32_bf16 v[128:131], a[40:43], a[64:67], v[128:131]
    ds_read_b128 a[28:31], v4 offset:1024
    v_mfma_f32_16x16x32_bf16 v[144:147], a[48:51], a[64:67], v[144:147]
    ds_read_b128 a[24:27], v4 offset:17408
    v_mfma_f32_16x16x32_bf16 v[144:147], a[52:55], a[68:71], v[144:147]
    ds_read_b128 a[36:39], v4 offset:2048
    v_mfma_f32_16x16x32_bf16 v[148:151], a[52:55], a[76:79], v[148:151]
    ds_read_b128 a[32:35], v4 offset:18432
    v_mfma_f32_16x16x32_bf16 v[148:151], a[48:51], a[72:75], v[148:151]
    ds_read_b128 a[44:47], v4 offset:3072
    v_mfma_f32_16x16x32_bf16 v[152:155], a[48:51], a[80:83], v[152:155]
    ds_read_b128 a[40:43], v4 offset:19456
    v_mfma_f32_16x16x32_bf16 v[152:155], a[52:55], a[84:87], v[152:155]
    v_mfma_f32_16x16x32_bf16 v[156:159], a[52:55], a[92:95], v[156:159]
    v_mfma_f32_16x16x32_bf16 v[156:159], a[48:51], a[88:91], v[156:159]
    v_mfma_f32_16x16x32_bf16 a[160:163], a[48:51], a[96:99], a[160:163]
    v_mfma_f32_16x16x32_bf16 a[160:163], a[52:55], a[100:103], a[160:163]
    v_mfma_f32_16x16x32_bf16 a[164:167], a[52:55], a[108:111], a[164:167]
    v_mfma_f32_16x16x32_bf16 a[164:167], a[48:51], a[104:107], a[164:167]
    v_mfma_f32_16x16x32_bf16 a[168:171], a[48:51], a[112:115], a[168:171]
    v_mfma_f32_16x16x32_bf16 a[168:171], a[52:55], a[116:119], a[168:171]
    v_mfma_f32_16x16x32_bf16 a[172:175], a[52:55], a[124:127], a[172:175]
    v_mfma_f32_16x16x32_bf16 a[172:175], a[48:51], a[120:123], a[172:175]
    v_mfma_f32_16x16x32_bf16 a[240:243], a[128:131], a[48:51], a[240:243]
    v_mfma_f32_16x16x32_bf16 a[240:243], a[132:135], a[52:55], a[240:243]
    v_mfma_f32_16x16x32_bf16 a[244:247], a[140:143], a[52:55], a[244:247]
L_pw12:
    s_cbranch_execz L_pw_back
    ds_read_b128 a[52:55], v4 offset:4096
    v_mfma_f32_16x16x32_bf16 a[244:247], a[136:139], a[48:51], a[244:247]
    ds_read_b128 a[48:51], v4 offset:20480
    v_mfma_f32_16x16x32_bf16 a[176:179], a[56:59], a[96:99], a[176:179]
    ds_read_b128 a[96:99], v4 offset:5120
    v_mfma_f32_16x16x32_bf16 a[176:179], a[60:63], a[100:103], a[176:179]
    ds_read_b128 a[100:103], v4 offset:21504
    v_mfma_f32_16x16x32_bf16 a[180:183], a[60:63], a[108:111], a[180:183]
    ds_read_b128 a[108:111], v4 offset:6144
    v_mfma_f32_16x16x32_bf16 a[180:183], a[56:59], a[104:107], a[180:183]
    ds_read_b128 a[104:107], v4 offset:22528
    v_mfma_f32_16x16x32_bf16 a[184:187], a[56:59], a[112:115], a[184:187]
    ds_read_b128 a[112:115], v4 offset:7168
    v_mfma_f32_16x16x32_bf16 a[184:187], a[60:63], a[116:119], a[184:187]
    ds_read_b128 a[116:119], v4 offset:23552
    v_mfma_f32_16x16x32_bf16 a[188:191], a[60:63], a[124:127], a[188:191]
    v_mfma_f32_16x16x32_bf16 a[188:191], a[56:59], a[120:123], a[188:191]
    v_mfma_f32_16x16x32_bf16 a[248:251], a[128:131], a[56:59], a[248:251]
    v_mfma_f32_16x16x32_bf16 a[248:251], a[132:135], a[60:63], a[248:251]
    v_mfma_f32_16x16x32_bf16 a[252:255], a[140:143], a[60:63], a[252:255]
    v_mfma_f32_16x16x32_bf16 a[252:255], a[136:139], a[56:59], a[252:255]
    v_mfma_f32_16x16x32_bf16 v[160:163], a[56:59], a[64:67], v[160:163]
    v_mfma_f32_16x16x32_bf16 v[160:163], a[60:63], a[68:71], v[160:163]
    v_mfma_f32_16x16x32_bf16 v[164:167], a[60:63], a[76:79], v[164:167]
    v_mfma_f32_16x16x32_bf16 v[164:167], a[56:59], a[72:75], v[164:167]
    v_mfma_f32_16x16x32_bf16 v[168:171], a[56:59], a[80:83], v[168:171]
    v_mfma_f32_16x16x32_bf16 v[168:171], a[60:63], a[84:87], v[168:171]
    v_mfma_f32_16x16x32_bf16 v[172:175], a[60:63], a[92:95], v[172:175]
    v_mfma_f32_16x16x32_bf16 v[172:175], a[56:59], a[88:91], v[172:175]
    s_waitcnt lgkmcnt(15)
    v_mfma_f32_16x16x32_bf16 a[192:195], a[0:3], a[4:7], a[192:195]
    v_mfma_f32_16x16x32_bf16 a[192:195], a[8:11], a[12:15], a[192:195]
    s_waitcnt lgkmcnt(14)
    v_mfma_f32_16x16x32_bf16 a[196:199], a[20:23], a[12:15], a[196:199]
    v_mfma_f32_16x16x32_bf16 a[196:199], a[16:19], a[4:7], a[196:199]
    s_waitcnt lgkmcnt(12)
    v_mfma_f32_16x16x32_bf16 a[204:207], a[16:19], a[28:31], a[204:207]
    v_mfma_f32_16x16x32_bf16 a[204:207], a[20:23], a[24:27], a[204:207]
    v_mfma_f32_16x16x32_bf16 a[200:203], a[8:11], a[24:27], a[200:203]
    v_mfma_f32_16x16x32_bf16 a[200:203], a[0:3], a[28:31], a[200:203]
    s_waitcnt lgkmcnt(10)
    v_mfma_f32_16x16x32_bf16 a[208:211], a[0:3], a[36:39], a[208:211]
    v_mfma_f32_16x16x32_bf16 a[208:211], a[8:11], a[32:35], a[208:211]
    v_mfma_f32_16x16x32_bf16 a[212:215], a[20:23], a[32:35], a[212:215]
    v_mfma_f32_16x16x32_bf16 a[212:215], a[16:19], a[36:39], a[212:215]
    s_waitcnt lgkmcnt(8)
    v_mfma_f32_16x16x32_bf16 a[220:223], a[16:19], a[44:47], a[220:223]
    s_waitcnt vmcnt(0)
    v_mfma_f32_16x16x32_bf16 a[220:223], a[20:23], a[40:43], a[220:223]
    s_barrier
    ds_read_b128 a[124:127], v4 offset:32768
    v_mfma_f32_16x16x32_bf16 a[216:219], a[8:11], a[40:43], a[216:219]
    ds_read_b64_tr_b16 a[120:121], v9 offset:8192
    v_mfma_f32_16x16x32_bf16 a[216:219], a[0:3], a[44:47], a[216:219]
    s_waitcnt lgkmcnt(8)
    ds_read_b64_tr_b16 a[122:123], v9 offset:8704
    v_mfma_f32_16x16x32_bf16 a[224:227], a[0:3], a[52:55], a[224:227]
    ds_read_b128 a[128:131], v4 offset:49152
    v_mfma_f32_16x16x32_bf16 a[224:227], a[8:11], a[48:51], a[224:227]
    ds_read_b64_tr_b16 a[132:133], v9 offset:12288
    v_mfma_f32_16x16x32_bf16 a[228:231], a[20:23], a[48:51], a[228:231]
    ds_read_b64_tr_b16 a[134:135], v9 offset:12800
    v_mfma_f32_16x16x32_bf16 a[228:231], a[16:19], a[52:55], a[228:231]
    s_waitcnt lgkmcnt(10)
    ds_read_b64_tr_b16 a[140:141], v10 offset:12288
    v_mfma_f32_16x16x32_bf16 a[236:239], a[16:19], a[96:99], a[236:239]
    ds_read_b64_tr_b16 a[142:143], v10 offset:12800
    v_mfma_f32_16x16x32_bf16 a[236:239], a[20:23], a[100:103], a[236:239]
    ds_read_b64_tr_b16 a[136:137], v10 offset:8192
    v_mfma_f32_16x16x32_bf16 a[232:235], a[8:11], a[100:103], a[232:235]
    ds_read_b64_tr_b16 a[138:139], v10 offset:8704
    v_mfma_f32_16x16x32_bf16 a[232:235], a[0:3], a[96:99], a[232:235]
    s_waitcnt lgkmcnt(12)
    ds_read_b128 a[64:67], v4 offset:33792
    v_mfma_f32_16x16x32_bf16 a[240:243], a[0:3], a[108:111], a[240:243]
    ds_read_b128 a[68:71], v4 offset:50176
    v_mfma_f32_16x16x32_bf16 a[240:243], a[8:11], a[104:107], a[240:243]
    ds_read_b128 a[76:79], v4 offset:34816
    v_mfma_f32_16x16x32_bf16 a[244:247], a[20:23], a[104:107], a[244:247]
    ds_read_b128 a[72:75], v4 offset:51200
    v_mfma_f32_16x16x32_bf16 a[244:247], a[16:19], a[108:111], a[244:247]
    s_waitcnt lgkmcnt(14)
    ds_read_b128 a[80:83], v4 offset:35840
    v_mfma_f32_16x16x32_bf16 a[252:255], a[16:19], a[112:115], a[252:255]
    ds_read_b128 a[84:87], v4 offset:52224
    v_mfma_f32_16x16x32_bf16 a[252:255], a[20:23], a[116:119], a[252:255]
    ds_read_b128 a[60:63], v4 offset:36864
    v_mfma_f32_16x16x32_bf16 a[248:251], a[8:11], a[116:119], a[248:251]
    s_and_b32 s44, s2, 7
    ds_read_b128 a[92:95], v4 offset:53248
    v_mfma_f32_16x16x32_bf16 a[248:251], a[0:3], a[112:115], a[248:251]
    s_waitcnt lgkmcnt(12)
    s_lshl_b32 s44, s44, 2
    ds_read_b128 a[56:59], v4 offset:37888
    v_mfma_f32_16x16x32_bf16 a[192:195], a[120:123], a[124:127], a[192:195]
    s_lshr_b32 s44, 0x04621753, s44
    ds_read_b128 a[88:91], v4 offset:54272
    v_mfma_f32_16x16x32_bf16 a[192:195], a[132:135], a[128:131], a[192:195]
    s_waitcnt lgkmcnt(10)
    s_and_b32 s44, s44, 7
    ds_read_b128 a[12:15], v4 offset:38912
    v_mfma_f32_16x16x32_bf16 a[196:199], a[140:143], a[128:131], a[196:199]
    s_lshl_b32 s44, s44, 2
    ds_read_b128 a[4:7], v4 offset:55296
    v_mfma_f32_16x16x32_bf16 a[196:199], a[136:139], a[124:127], a[196:199]
    s_waitcnt lgkmcnt(10)
    s_lshr_b32 s43, s2, 3
    ds_read_b128 a[24:27], v4 offset:39936
    v_mfma_f32_16x16x32_bf16 a[204:207], a[136:139], a[64:67], a[204:207]
    s_lshr_b32 s3, s43, 3
    ds_read_b128 a[28:31], v4 offset:56320
    v_mfma_f32_16x16x32_bf16 a[204:207], a[140:143], a[68:71], a[204:207]
    s_add_u32 s44, s44, s3
    ds_read_b64_tr_b16 a[32:33], v5 offset:0
    v_mfma_f32_16x16x32_bf16 a[200:203], a[132:135], a[68:71], a[200:203]
    s_and_b32 s43, s43, 7
    ds_read_b64_tr_b16 a[34:35], v5 offset:512
    v_mfma_f32_16x16x32_bf16 a[200:203], a[120:123], a[64:67], a[200:203]
    s_waitcnt lgkmcnt(12)
    s_lshl_b32 s36, s45, 12
    ds_read_b64_tr_b16 a[36:37], v5 offset:4096
    v_mfma_f32_16x16x32_bf16 a[208:211], a[120:123], a[76:79], a[208:211]
    s_mov_b32 s37, s36
    ds_read_b64_tr_b16 a[38:39], v5 offset:4608
    v_mfma_f32_16x16x32_bf16 a[208:211], a[132:135], a[72:75], a[208:211]
    s_lshl_b32 s3, s44, 18
    ds_read_b64_tr_b16 a[40:41], v6 offset:4096
    v_mfma_f32_16x16x32_bf16 a[212:215], a[140:143], a[72:75], a[212:215]
    s_add_u32 s3, s3, 0x800000
    ds_read_b64_tr_b16 a[42:43], v6 offset:4608
    v_mfma_f32_16x16x32_bf16 a[212:215], a[136:139], a[76:79], a[212:215]
    s_waitcnt lgkmcnt(14)
    s_add_u32 s12, s4, s3
    s_addc_u32 s13, s5, 0
    ds_read_b64_tr_b16 a[44:45], v6 offset:0
    v_mfma_f32_16x16x32_bf16 a[220:223], a[136:139], a[80:83], a[220:223]
    s_and_b32 s13, s13, 0xffff
    ds_read_b64_tr_b16 a[46:47], v6 offset:512
    v_mfma_f32_16x16x32_bf16 a[220:223], a[140:143], a[84:87], a[220:223]
    s_mov_b32 s14, 0x40000
    ds_read_b64_tr_b16 a[16:17], v5 offset:32768
    v_mfma_f32_16x16x32_bf16 a[216:219], a[132:135], a[84:87], a[216:219]
    s_mov_b32 s15, 0x20000
    ds_read_b64_tr_b16 a[18:19], v5 offset:33280
    v_mfma_f32_16x16x32_bf16 a[216:219], a[120:123], a[80:83], a[216:219]
    s_waitcnt lgkmcnt(15)
    s_lshl_b32 s3, s44, 17
    ds_read_b64_tr_b16 a[20:21], v5 offset:36864
    v_mfma_f32_16x16x32_bf16 a[224:227], a[120:123], a[60:63], a[224:227]
    s_lshl_b32 s6, s43, 14
    ds_read_b64_tr_b16 a[22:23], v5 offset:37376
    v_mfma_f32_16x16x32_bf16 a[224:227], a[132:135], a[92:95], a[224:227]
    s_add_u32 s3, s3, s6
    ds_read_b64_tr_b16 a[8:9], v6 offset:36864
    v_mfma_f32_16x16x32_bf16 a[228:231], a[140:143], a[92:95], a[228:231]
    s_add_u32 s3, s3, s36
    ds_read_b64_tr_b16 a[10:11], v6 offset:37376
    v_mfma_f32_16x16x32_bf16 a[228:231], a[136:139], a[60:63], a[228:231]
    s_waitcnt lgkmcnt(15)
    s_add_u32 s3, s3, 0x400000
    ds_read_b64_tr_b16 a[0:1], v6 offset:32768
    v_mfma_f32_16x16x32_bf16 a[236:239], a[136:139], a[56:59], a[236:239]
    s_add_u32 s16, s4, s3
    s_addc_u32 s17, s5, 0
    ds_read_b64_tr_b16 a[2:3], v6 offset:33280
    v_mfma_f32_16x16x32_bf16 a[236:239], a[140:143], a[88:91], a[236:239]
    s_and_b32 s17, s17, 0xffff
    ds_read_b64_tr_b16 a[128:129], v5 offset:8192
    v_mfma_f32_16x16x32_bf16 a[232:235], a[132:135], a[88:91], a[232:235]
    s_mov_b32 s18, 0x1000
    ds_read_b64_tr_b16 a[130:131], v5 offset:8704
    v_mfma_f32_16x16x32_bf16 a[232:235], a[120:123], a[56:59], a[232:235]
    s_mov_b32 s19, 0x20000
    ds_read_b64_tr_b16 a[124:125], v5 offset:12288
    v_mfma_f32_16x16x32_bf16 a[240:243], a[120:123], a[12:15], a[240:243]
    s_and_b32 s3, s2, 7
    ds_read_b64_tr_b16 a[126:127], v5 offset:12800
    v_mfma_f32_16x16x32_bf16 a[240:243], a[132:135], a[4:7], a[240:243]
    s_lshr_b32 s6, s2, 3
    ds_read_b64_tr_b16 a[68:69], v6 offset:12288
    v_mfma_f32_16x16x32_bf16 a[244:247], a[140:143], a[4:7], a[244:247]
    s_lshr_b32 s46, s3, 1
    ds_read_b64_tr_b16 a[70:71], v6 offset:12800
    v_mfma_f32_16x16x32_bf16 a[244:247], a[136:139], a[12:15], a[244:247]
    s_waitcnt lgkmcnt(15)
    s_lshl_b32 s46, s46, 2
    ds_read_b64_tr_b16 a[64:65], v6 offset:8192
    v_mfma_f32_16x16x32_bf16 a[252:255], a[136:139], a[24:27], a[252:255]
    s_and_b32 s7, s6, 3
    ds_read_b64_tr_b16 a[66:67], v6 offset:8704
    v_mfma_f32_16x16x32_bf16 a[252:255], a[140:143], a[28:31], a[252:255]
    s_add_u32 s46, s46, s7
    ds_read_b64_tr_b16 a[72:73], v5 offset:40960
    v_mfma_f32_16x16x32_bf16 a[248:251], a[132:135], a[28:31], a[248:251]
    s_and_b32 s47, s3, 1
    ds_read_b64_tr_b16 a[74:75], v5 offset:41472
    v_mfma_f32_16x16x32_bf16 a[248:251], a[120:123], a[24:27], a[248:251]
    s_lshl_b32 s47, s47, 3
    ds_read_b64_tr_b16 a[76:77], v5 offset:45056
    v_mfma_f32_16x16x32_bf16 v[112:115], a[52:55], a[32:35], v[112:115]
    s_lshr_b32 s7, s6, 2
    ds_read_b64_tr_b16 a[78:79], v5 offset:45568
    v_mfma_f32_16x16x32_bf16 v[112:115], a[48:51], a[36:39], v[112:115]
    s_waitcnt lgkmcnt(15)
    s_add_u32 s47, s47, s7
    ds_read_b64_tr_b16 a[84:85], v6 offset:45056
    v_mfma_f32_16x16x32_bf16 v[116:119], a[48:51], a[40:43], v[116:119]
    s_lshl_b32 s41, s45, 14
    ds_read_b64_tr_b16 a[86:87], v6 offset:45568
    v_mfma_f32_16x16x32_bf16 v[116:119], a[52:55], a[44:47], v[116:119]
    s_add_u32 s41, s41, 0x10000
    ds_read_b64_tr_b16 a[80:81], v6 offset:40960
    v_accvgpr_read_b32 v16, a192
    v_accvgpr_read_b32 v17, a193
    v_mfma_f32_16x16x32_bf16 v[240:243], a[52:55], a[16:19], v[240:243]
    s_mul_i32 s3, s45, 1835008
    ds_read_b64_tr_b16 a[82:83], v6 offset:41472
    v_accvgpr_read_b32 v18, a194
    v_accvgpr_read_b32 v19, a195
    v_mfma_f32_16x16x32_bf16 v[240:243], a[48:51], a[20:23], v[240:243]
    s_waitcnt lgkmcnt(15)
    s_lshl_b32 s6, s47, 7
    ds_read_b64_tr_b16 a[136:137], v7 offset:0
    v_accvgpr_read_b32 v20, a196
    v_accvgpr_read_b32 v21, a197
    v_mfma_f32_16x16x32_bf16 v[244:247], a[48:51], a[8:11], v[244:247]
    s_add_u32 s3, s3, s6
    ds_read_b64_tr_b16 a[138:139], v7 offset:512
    v_accvgpr_read_b32 v22, a198
    v_accvgpr_read_b32 v23, a199
    v_mfma_f32_16x16x32_bf16 v[244:247], a[52:55], a[0:3], v[244:247]
    s_sub_u32 s7, 1835008, s6
    ds_read_b64_tr_b16 a[140:141], v7 offset:4096
    v_mul_f32 v16, s56, v16
    v_mul_f32 v17, s56, v17
    v_mfma_f32_16x16x32_bf16 a[148:151], a[96:99], a[0:3], a[148:151]
    s_add_u32 s64, s60, s3
    s_addc_u32 s65, s61, 0
    ds_read_b64_tr_b16 a[142:143], v7 offset:4608
    v_mul_f32 v18, s56, v18
    v_mul_f32 v19, s56, v19
    v_mfma_f32_16x16x32_bf16 a[148:151], a[100:103], a[8:11], a[148:151]
    s_and_b32 s65, s65, 0xffff
    ds_read_b64_tr_b16 a[132:133], v8 offset:4096
    v_mul_f32 v20, s56, v20
    v_mul_f32 v21, s56, v21
    v_mfma_f32_16x16x32_bf16 a[144:147], a[100:103], a[20:23], a[144:147]
    s_mov_b32 s66, s7
    ds_read_b64_tr_b16 a[134:135], v8 offset:4608
    v_mul_f32 v22, s56, v22
    v_mul_f32 v23, s56, v23
    v_mfma_f32_16x16x32_bf16 a[144:147], a[96:99], a[16:19], a[144:147]
    s_mov_b32 s67, 0x20000
    ds_read_b64_tr_b16 a[120:121], v8 offset:0
    v_cvt_pk_bf16_f32 v24, v16, v17
    v_cvt_pk_bf16_f32 v25, v18, v19
    v_mfma_f32_16x16x32_bf16 v[132:135], a[96:99], a[44:47], v[132:135]
    s_mov_b32 s39, 0
    ds_read_b64_tr_b16 a[122:123], v8 offset:512
    v_cvt_pk_bf16_f32 v26, v20, v21
    v_cvt_pk_bf16_f32 v27, v22, v23
    v_mfma_f32_16x16x32_bf16 v[132:135], a[100:103], a[40:43], v[132:135]
    s_mov_b32 s40, 0
    buffer_store_dwordx4 v[24:27], v13, s[32:35], s52 offen sc1
    v_accvgpr_read_b32 v32, a200
    v_mfma_f32_16x16x32_bf16 v[128:131], a[100:103], a[36:39], v[128:131]
    s_mul_i32 s3, s46, 917504
    v_accvgpr_read_b32 v33, a201
    v_accvgpr_read_b32 v34, a202
    v_mfma_f32_16x16x32_bf16 v[128:131], a[96:99], a[32:35], v[128:131]
    s_mul_i32 s6, s45, 229376
    v_accvgpr_read_b32 v35, a203
    v_accvgpr_read_b32 v36, a204
    v_mfma_f32_16x16x32_bf16 v[144:147], a[108:111], a[32:35], v[144:147]
    s_add_u32 s3, s3, s6
    v_accvgpr_read_b32 v37, a205
    v_mfma_f32_16x16x32_bf16 v[144:147], a[104:107], a[36:39], v[144:147]
    s_add_u32 s3, s3, 0x1000000
    v_accvgpr_read_b32 v38, a206
    v_accvgpr_read_b32 v39, a207
    v_mfma_f32_16x16x32_bf16 v[148:151], a[104:107], a[40:43], v[148:151]
    s_add_u32 s24, s4, s3
    s_addc_u32 s25, s5, 0
    v_mul_f32 v32, s56, v32
    v_mul_f32 v33, s56, v33
    v_mfma_f32_16x16x32_bf16 v[148:151], a[108:111], a[44:47], v[148:151]
    s_and_b32 s25, s25, 0xffff
    v_mul_f32 v34, s56, v34
    v_mul_f32 v35, s56, v35
    v_mfma_f32_16x16x32_bf16 a[160:163], a[108:111], a[16:19], a[160:163]
    s_mov_b32 s26, 0x38000
    v_mul_f32 v36, s56, v36
    v_mul_f32 v37, s56, v37
    v_mfma_f32_16x16x32_bf16 a[160:163], a[104:107], a[20:23], a[160:163]
    s_mov_b32 s27, 0x20000
    v_mul_f32 v38, s56, v38
    v_mul_f32 v39, s56, v39
    v_mfma_f32_16x16x32_bf16 a[164:167], a[104:107], a[8:11], a[164:167]
    s_lshl_b32 s3, s43, 2
    v_cvt_pk_bf16_f32 v40, v32, v33
    v_cvt_pk_bf16_f32 v41, v34, v35
    v_mfma_f32_16x16x32_bf16 a[164:167], a[108:111], a[0:3], a[164:167]
    s_add_u32 s3, s3, s45
    v_cvt_pk_bf16_f32 v42, v36, v37
    v_cvt_pk_bf16_f32 v43, v38, v39
    v_mfma_f32_16x16x32_bf16 a[180:183], a[112:115], a[0:3], a[180:183]
    s_mul_i32 s3, s3, 139776
    ds_read_b64_tr_b16 a[0:1], v7 offset:32768
    buffer_store_dwordx4 v[40:43], v14, s[32:35], s52 offen sc1
    v_accvgpr_read_b32 v16, a208
    v_mfma_f32_16x16x32_bf16 a[180:183], a[116:119], a[8:11], a[180:183]
    s_lshl_b32 s6, s44, 11
    ds_read_b64_tr_b16 a[2:3], v7 offset:33280
    v_accvgpr_read_b32 v17, a209
    v_accvgpr_read_b32 v18, a210
    v_mfma_f32_16x16x32_bf16 a[176:179], a[116:119], a[20:23], a[176:179]
    s_add_u32 s3, s3, s6
    ds_read_b64_tr_b16 a[8:9], v7 offset:36864
    v_accvgpr_read_b32 v19, a211
    v_accvgpr_read_b32 v20, a212
    v_mfma_f32_16x16x32_bf16 a[176:179], a[112:115], a[16:19], a[176:179]
    s_add_u32 s3, s3, 0x2000000
    ds_read_b64_tr_b16 a[10:11], v7 offset:37376
    v_accvgpr_read_b32 v21, a213
    v_accvgpr_read_b32 v22, a214
    v_mfma_f32_16x16x32_bf16 v[164:167], a[112:115], a[44:47], v[164:167]
    s_add_u32 s20, s4, s3
    s_addc_u32 s21, s5, 0
    ds_read_b64_tr_b16 a[20:21], v8 offset:36864
    v_accvgpr_read_b32 v23, a215
    v_mul_f32 v16, s56, v16
    v_mfma_f32_16x16x32_bf16 v[164:167], a[116:119], a[40:43], v[164:167]
    s_and_b32 s21, s21, 0xffff
    ds_read_b64_tr_b16 a[22:23], v8 offset:37376
    v_mul_f32 v17, s56, v17
    v_mul_f32 v18, s56, v18
    v_mfma_f32_16x16x32_bf16 v[160:163], a[116:119], a[36:39], v[160:163]
    s_mov_b32 s22, 0x11900
    ds_read_b64_tr_b16 a[16:17], v8 offset:32768
    v_mul_f32 v19, s56, v19
    v_mul_f32 v20, s56, v20
    v_mfma_f32_16x16x32_bf16 v[160:163], a[112:115], a[32:35], v[160:163]
    s_waitcnt lgkmcnt(15)
    s_mov_b32 s23, 0x20000
    ds_read_b64_tr_b16 a[18:19], v8 offset:33280
    v_mul_f32 v21, s56, v21
    v_mul_f32 v22, s56, v22
    v_mfma_f32_16x16x32_bf16 v[112:115], a[60:63], a[128:131], v[112:115]
    s_mov_b32 s50, 69888
    ds_read_b64_tr_b16 a[44:45], v7 offset:8192
    v_mul_f32 v23, s56, v23
    v_cvt_pk_bf16_f32 v24, v16, v17
    v_mfma_f32_16x16x32_bf16 v[112:115], a[92:95], a[124:127], v[112:115]
    s_mov_b32 s38, 0x4000
    ds_read_b64_tr_b16 a[46:47], v7 offset:8704
    v_cvt_pk_bf16_f32 v25, v18, v19
    v_cvt_pk_bf16_f32 v26, v20, v21
    v_mfma_f32_16x16x32_bf16 v[116:119], a[92:95], a[68:71], v[116:119]
    s_lshl_b32 s68, s45, 16
    ds_read_b64_tr_b16 a[40:41], v7 offset:12288
    v_cvt_pk_bf16_f32 v27, v22, v23
    buffer_store_dwordx4 v[24:27], v13, s[32:35], s53 offen sc1
    v_mfma_f32_16x16x32_bf16 v[116:119], a[60:63], a[64:67], v[116:119]
    s_lshl_b32 s49, s45, 12
    ds_read_b64_tr_b16 a[42:43], v7 offset:12800
    v_accvgpr_read_b32 v32, a216
    v_accvgpr_read_b32 v33, a217
    v_mfma_f32_16x16x32_bf16 v[240:243], a[60:63], a[72:75], v[240:243]
    s_lshr_b32 s69, s46, 1
    ds_read_b64_tr_b16 a[36:37], v8 offset:12288
    v_accvgpr_read_b32 v34, a218
    v_accvgpr_read_b32 v35, a219
    v_mfma_f32_16x16x32_bf16 v[240:243], a[92:95], a[76:79], v[240:243]
    s_mov_b32 s42, 13
    ds_read_b64_tr_b16 a[38:39], v8 offset:12800
    v_accvgpr_read_b32 v36, a220
    v_accvgpr_read_b32 v37, a221
    v_mfma_f32_16x16x32_bf16 v[244:247], a[92:95], a[84:87], v[244:247]
    ds_read_b64_tr_b16 a[32:33], v8 offset:8192
    v_accvgpr_read_b32 v38, a222
    v_accvgpr_read_b32 v39, a223
    v_mfma_f32_16x16x32_bf16 v[244:247], a[60:63], a[80:83], v[244:247]
    ds_read_b64_tr_b16 a[34:35], v8 offset:8704
    v_mul_f32 v32, s56, v32
    v_mul_f32 v33, s56, v33
    v_mfma_f32_16x16x32_bf16 a[148:151], a[56:59], a[80:83], a[148:151]
    v_mul_f32 v34, s56, v34
    v_mul_f32 v35, s56, v35
    v_mfma_f32_16x16x32_bf16 a[148:151], a[88:91], a[84:87], a[148:151]
    v_mul_f32 v36, s56, v36
    v_mul_f32 v37, s56, v37
    v_mfma_f32_16x16x32_bf16 a[144:147], a[88:91], a[76:79], a[144:147]
    v_mul_f32 v38, s56, v38
    v_mul_f32 v39, s56, v39
    v_mfma_f32_16x16x32_bf16 a[144:147], a[56:59], a[72:75], a[144:147]
    v_cvt_pk_bf16_f32 v40, v32, v33
    v_cvt_pk_bf16_f32 v41, v34, v35
    v_mfma_f32_16x16x32_bf16 v[132:135], a[56:59], a[64:67], v[132:135]
    v_cvt_pk_bf16_f32 v42, v36, v37
    v_mfma_f32_16x16x32_bf16 v[132:135], a[88:91], a[68:71], v[132:135]
    v_cvt_pk_bf16_f32 v43, v38, v39
    buffer_store_dwordx4 v[40:43], v14, s[32:35], s53 offen sc1
    v_mfma_f32_16x16x32_bf16 v[128:131], a[88:91], a[124:127], v[128:131]
    v_accvgpr_read_b32 v16, a224
    v_accvgpr_read_b32 v17, a225
    v_mfma_f32_16x16x32_bf16 v[128:131], a[56:59], a[128:131], v[128:131]
    v_accvgpr_read_b32 v18, a226
    v_accvgpr_read_b32 v19, a227
    v_mfma_f32_16x16x32_bf16 v[144:147], a[12:15], a[128:131], v[144:147]
    v_accvgpr_read_b32 v20, a228
    v_accvgpr_read_b32 v21, a229
    v_mfma_f32_16x16x32_bf16 v[144:147], a[4:7], a[124:127], v[144:147]
    v_accvgpr_read_b32 v22, a230
    v_accvgpr_read_b32 v23, a231
    v_mfma_f32_16x16x32_bf16 v[148:151], a[4:7], a[68:71], v[148:151]
    v_mul_f32 v16, s56, v16
    v_mul_f32 v17, s56, v17
    v_mfma_f32_16x16x32_bf16 v[148:151], a[12:15], a[64:67], v[148:151]
    v_mul_f32 v18, s56, v18
    v_mul_f32 v19, s56, v19
    v_mfma_f32_16x16x32_bf16 a[160:163], a[12:15], a[72:75], a[160:163]
    v_mul_f32 v20, s56, v20
    v_mul_f32 v21, s56, v21
    v_mfma_f32_16x16x32_bf16 a[160:163], a[4:7], a[76:79], a[160:163]
    v_mul_f32 v22, s56, v22
    v_mul_f32 v23, s56, v23
    v_mfma_f32_16x16x32_bf16 a[164:167], a[4:7], a[84:87], a[164:167]
    v_cvt_pk_bf16_f32 v24, v16, v17
    v_cvt_pk_bf16_f32 v25, v18, v19
    v_mfma_f32_16x16x32_bf16 a[164:167], a[12:15], a[80:83], a[164:167]
    v_cvt_pk_bf16_f32 v26, v20, v21
    v_cvt_pk_bf16_f32 v27, v22, v23
    v_mfma_f32_16x16x32_bf16 a[180:183], a[24:27], a[80:83], a[180:183]
    ds_read_b64_tr_b16 a[80:81], v7 offset:40960
    buffer_store_dwordx4 v[24:27], v13, s[32:35], s54 offen sc1
    v_accvgpr_read_b32 v32, a232
    v_mfma_f32_16x16x32_bf16 a[180:183], a[28:31], a[84:87], a[180:183]
    ds_read_b64_tr_b16 a[82:83], v7 offset:41472
    v_accvgpr_read_b32 v33, a233
    v_accvgpr_read_b32 v34, a234
    v_mfma_f32_16x16x32_bf16 a[176:179], a[28:31], a[76:79], a[176:179]
    ds_read_b64_tr_b16 a[84:85], v7 offset:45056
    v_accvgpr_read_b32 v35, a235
    v_accvgpr_read_b32 v36, a236
    v_mfma_f32_16x16x32_bf16 a[176:179], a[24:27], a[72:75], a[176:179]
    ds_read_b64_tr_b16 a[86:87], v7 offset:45568
    v_accvgpr_read_b32 v37, a237
    v_accvgpr_read_b32 v38, a238
    v_mfma_f32_16x16x32_bf16 v[164:167], a[24:27], a[64:67], v[164:167]
    ds_read_b64_tr_b16 a[76:77], v8 offset:45056
    v_accvgpr_read_b32 v39, a239
    v_mul_f32 v32, s56, v32
    v_mfma_f32_16x16x32_bf16 v[164:167], a[28:31], a[68:71], v[164:167]
    ds_read_b64_tr_b16 a[78:79], v8 offset:45568
    v_mul_f32 v33, s56, v33
    v_mul_f32 v34, s56, v34
    v_mfma_f32_16x16x32_bf16 v[160:163], a[28:31], a[124:127], v[160:163]
    ds_read_b64_tr_b16 a[72:73], v8 offset:40960
    v_mul_f32 v35, s56, v35
    v_mul_f32 v36, s56, v36
    v_mfma_f32_16x16x32_bf16 v[160:163], a[24:27], a[128:131], v[160:163]
    s_waitcnt lgkmcnt(15)
    ds_read_b64_tr_b16 a[74:75], v8 offset:41472
    v_mul_f32 v37, s56, v37
    v_mul_f32 v38, s56, v38
    v_mfma_f32_16x16x32_bf16 v[120:123], a[52:55], a[136:139], v[120:123]
    ds_read_b128 a[64:67], v4 offset:0
    v_mul_f32 v39, s56, v39
    v_cvt_pk_bf16_f32 v40, v32, v33
    v_mfma_f32_16x16x32_bf16 v[120:123], a[48:51], a[140:143], v[120:123]
    ds_read_b128 a[68:71], v4 offset:16384
    v_cvt_pk_bf16_f32 v41, v34, v35
    v_cvt_pk_bf16_f32 v42, v36, v37
    v_mfma_f32_16x16x32_bf16 v[124:127], a[48:51], a[132:135], v[124:127]
    ds_read_b128 a[124:127], v4 offset:1024
    v_cvt_pk_bf16_f32 v43, v38, v39
    buffer_store_dwordx4 v[40:43], v14, s[32:35], s54 offen sc1
    v_mfma_f32_16x16x32_bf16 v[124:127], a[52:55], a[120:123], v[124:127]
    ds_read_b128 a[128:131], v4 offset:17408
    v_accvgpr_read_b32 v16, a240
    v_accvgpr_read_b32 v17, a241
    v_mfma_f32_16x16x32_bf16 v[248:251], a[52:55], a[0:3], v[248:251]
    v_accvgpr_read_b32 v18, a242
    v_accvgpr_read_b32 v19, a243
    v_mfma_f32_16x16x32_bf16 v[248:251], a[48:51], a[8:11], v[248:251]
    v_accvgpr_read_b32 v20, a244
    v_accvgpr_read_b32 v21, a245
    v_mfma_f32_16x16x32_bf16 v[252:255], a[48:51], a[20:23], v[252:255]
    v_accvgpr_read_b32 v22, a246
    v_accvgpr_read_b32 v23, a247
    v_mfma_f32_16x16x32_bf16 v[252:255], a[52:55], a[16:19], v[252:255]
    v_mul_f32 v16, s56, v16
    v_mfma_f32_16x16x32_bf16 a[156:159], a[96:99], a[16:19], a[156:159]
    ds_read_b128 a[48:51], v4 offset:2048
    v_mul_f32 v17, s56, v17
    v_mul_f32 v18, s56, v18
    v_mfma_f32_16x16x32_bf16 a[156:159], a[100:103], a[20:23], a[156:159]
    ds_read_b128 a[52:55], v4 offset:18432
    v_mul_f32 v19, s56, v19
    v_mul_f32 v20, s56, v20
    v_mfma_f32_16x16x32_bf16 a[152:155], a[100:103], a[8:11], a[152:155]
    v_mul_f32 v21, s56, v21
    v_mul_f32 v22, s56, v22
    v_mfma_f32_16x16x32_bf16 a[152:155], a[96:99], a[0:3], a[152:155]
    v_mul_f32 v23, s56, v23
    v_cvt_pk_bf16_f32 v24, v16, v17
    v_mfma_f32_16x16x32_bf16 v[140:143], a[96:99], a[120:123], v[140:143]
    v_cvt_pk_bf16_f32 v25, v18, v19
    v_cvt_pk_bf16_f32 v26, v20, v21
    v_mfma_f32_16x16x32_bf16 v[140:143], a[100:103], a[132:135], v[140:143]
    v_cvt_pk_bf16_f32 v27, v22, v23
    buffer_store_dwordx4 v[24:27], v13, s[32:35], s55 offen sc1
    v_mfma_f32_16x16x32_bf16 v[136:139], a[100:103], a[140:143], v[136:139]
    v_accvgpr_read_b32 v32, a248
    v_accvgpr_read_b32 v33, a249
    v_mfma_f32_16x16x32_bf16 v[136:139], a[96:99], a[136:139], v[136:139]
    v_accvgpr_read_b32 v34, a250
    v_accvgpr_read_b32 v35, a251
    v_mfma_f32_16x16x32_bf16 v[152:155], a[108:111], a[136:139], v[152:155]
    ds_read_b128 a[100:103], v4 offset:3072
    v_accvgpr_read_b32 v36, a252
    v_accvgpr_read_b32 v37, a253
    v_mfma_f32_16x16x32_bf16 v[152:155], a[104:107], a[140:143], v[152:155]
    ds_read_b128 a[96:99], v4 offset:19456
    v_accvgpr_read_b32 v38, a254
    v_accvgpr_read_b32 v39, a255
    v_mfma_f32_16x16x32_bf16 v[156:159], a[104:107], a[132:135], v[156:159]
    v_mul_f32 v32, s56, v32
    v_mul_f32 v33, s56, v33
    v_mfma_f32_16x16x32_bf16 v[156:159], a[108:111], a[120:123], v[156:159]
    v_mul_f32 v34, s56, v34
    v_mul_f32 v35, s56, v35
    v_mfma_f32_16x16x32_bf16 a[168:171], a[108:111], a[0:3], a[168:171]
    v_mul_f32 v36, s56, v36
    v_mul_f32 v37, s56, v37
    v_mfma_f32_16x16x32_bf16 a[168:171], a[104:107], a[8:11], a[168:171]
    v_mul_f32 v38, s56, v38
    v_mul_f32 v39, s56, v39
    v_mfma_f32_16x16x32_bf16 a[172:175], a[104:107], a[20:23], a[172:175]
    v_cvt_pk_bf16_f32 v40, v32, v33
    v_cvt_pk_bf16_f32 v41, v34, v35
    v_mfma_f32_16x16x32_bf16 a[172:175], a[108:111], a[16:19], a[172:175]
    v_cvt_pk_bf16_f32 v42, v36, v37
    v_cvt_pk_bf16_f32 v43, v38, v39
    v_mfma_f32_16x16x32_bf16 a[188:191], a[112:115], a[16:19], a[188:191]
    ds_read_b128 a[104:107], v4 offset:32768
    buffer_store_dwordx4 v[40:43], v14, s[32:35], s55 offen sc1
    s_mov_b32 s51, 0x2000
    v_mfma_f32_16x16x32_bf16 a[188:191], a[116:119], a[20:23], a[188:191]
    ds_read_b128 a[108:111], v4 offset:49152
    v_cvt_pk_bf16_f32 v24, v112, v113
    v_cvt_pk_bf16_f32 v25, v114, v115
    v_mfma_f32_16x16x32_bf16 a[184:187], a[116:119], a[8:11], a[184:187]
    v_cvt_pk_bf16_f32 v26, v128, v129
    v_cvt_pk_bf16_f32 v27, v130, v131
    v_mfma_f32_16x16x32_bf16 a[184:187], a[112:115], a[0:3], a[184:187]
    v_mfma_f32_16x16x32_bf16 v[172:175], a[112:115], a[120:123], v[172:175]
    buffer_store_dwordx4 v[24:27], v12, s[28:31], s51 offen offset:0 sc1
    v_mfma_f32_16x16x32_bf16 v[172:175], a[116:119], a[132:135], v[172:175]
    s_mov_b32 s51, 0x2000
    v_cvt_pk_bf16_f32 v40, v116, v117
    v_mfma_f32_16x16x32_bf16 v[168:171], a[116:119], a[140:143], v[168:171]
    v_cvt_pk_bf16_f32 v41, v118, v119
    v_cvt_pk_bf16_f32 v42, v132, v133
    v_mfma_f32_16x16x32_bf16 v[168:171], a[112:115], a[136:139], v[168:171]
    s_waitcnt lgkmcnt(15)
    v_cvt_pk_bf16_f32 v43, v134, v135
    v_mfma_f32_16x16x32_bf16 v[120:123], a[60:63], a[44:47], v[120:123]
    ds_read_b128 a[116:119], v4 offset:33792
    buffer_store_dwordx4 v[40:43], v12, s[28:31], s51 offen offset:1024 sc1
    v_mfma_f32_16x16x32_bf16 v[120:123], a[92:95], a[40:43], v[120:123]
    ds_read_b128 a[112:115], v4 offset:50176
    v_accvgpr_read_b32 v20, a144
    v_mfma_f32_16x16x32_bf16 v[124:127], a[92:95], a[36:39], v[124:127]
    v_accvgpr_read_b32 v21, a145
    v_accvgpr_read_b32 v22, a146
    v_mfma_f32_16x16x32_bf16 v[124:127], a[60:63], a[32:35], v[124:127]
    s_waitcnt lgkmcnt(15)
    v_accvgpr_read_b32 v23, a147
    v_mfma_f32_16x16x32_bf16 v[248:251], a[60:63], a[80:83], v[248:251]
    s_mov_b32 s51, 0x102000
L_pw13:
    s_cbranch_execz L_pw_back
    v_cvt_pk_bf16_f32 v24, v240, v241
    v_mfma_f32_16x16x32_bf16 v[248:251], a[92:95], a[84:87], v[248:251]
    s_waitcnt lgkmcnt(12)
    v_cvt_pk_bf16_f32 v25, v242, v243
    v_cvt_pk_bf16_f32 v26, v20, v21
    v_mfma_f32_16x16x32_bf16 v[252:255], a[92:95], a[76:79], v[252:255]
    v_cvt_pk_bf16_f32 v27, v22, v23
    v_mfma_f32_16x16x32_bf16 v[252:255], a[60:63], a[72:75], v[252:255]
    buffer_store_dwordx4 v[24:27], v12, s[28:31], s51 offen offset:0 sc1
    v_mfma_f32_16x16x32_bf16 a[156:159], a[56:59], a[72:75], a[156:159]
    ds_read_b128 a[92:95], v4 offset:34816
    v_accvgpr_read_b32 v36, a148
    v_mfma_f32_16x16x32_bf16 a[156:159], a[88:91], a[76:79], a[156:159]
    ds_read_b128 a[60:63], v4 offset:51200
    v_accvgpr_read_b32 v37, a149
    v_accvgpr_read_b32 v38, a150
    v_mfma_f32_16x16x32_bf16 a[152:155], a[88:91], a[84:87], a[152:155]
    v_accvgpr_read_b32 v39, a151
    s_mov_b32 s51, 0x102000
    v_mfma_f32_16x16x32_bf16 a[152:155], a[56:59], a[80:83], a[152:155]
    v_cvt_pk_bf16_f32 v40, v244, v245
    v_cvt_pk_bf16_f32 v41, v246, v247
    v_mfma_f32_16x16x32_bf16 v[140:143], a[56:59], a[32:35], v[140:143]
    v_cvt_pk_bf16_f32 v42, v36, v37
    v_cvt_pk_bf16_f32 v43, v38, v39
    v_mfma_f32_16x16x32_bf16 v[140:143], a[88:91], a[36:39], v[140:143]
    buffer_store_dwordx4 v[40:43], v12, s[28:31], s51 offen offset:1024 sc1
    v_mfma_f32_16x16x32_bf16 v[136:139], a[88:91], a[40:43], v[136:139]
    s_lshl_b32 s6, s47, 7
    v_mfma_f32_16x16x32_bf16 v[136:139], a[56:59], a[44:47], v[136:139]
    s_sub_u32 s7, 2097152, s6
    s_mov_b32 s51, 0x3000
    v_cvt_pk_bf16_f32 v24, v144, v145
    v_mfma_f32_16x16x32_bf16 v[152:155], a[12:15], a[44:47], v[152:155]
    s_add_u32 s32, s8, s6
    s_addc_u32 s33, s9, 0
    ds_read_b128 a[88:91], v4 offset:35840
    v_cvt_pk_bf16_f32 v25, v146, v147
    v_cvt_pk_bf16_f32 v26, v160, v161
    v_mfma_f32_16x16x32_bf16 v[152:155], a[4:7], a[40:43], v[152:155]
    s_and_b32 s33, s33, 0xffff
    ds_read_b128 a[56:59], v4 offset:52224
    v_cvt_pk_bf16_f32 v27, v162, v163
    v_mfma_f32_16x16x32_bf16 v[156:159], a[4:7], a[36:39], v[156:159]
    s_mov_b32 s34, s7
    buffer_store_dwordx4 v[24:27], v12, s[28:31], s51 offen offset:0 sc1
    v_mfma_f32_16x16x32_bf16 v[156:159], a[12:15], a[32:35], v[156:159]
    s_mov_b32 s35, 0x20000
    s_mov_b32 s51, 0x3000
    v_mfma_f32_16x16x32_bf16 a[168:171], a[12:15], a[80:83], a[168:171]
    s_add_u32 s52, s45, 0
    v_cvt_pk_bf16_f32 v40, v148, v149
    v_cvt_pk_bf16_f32 v41, v150, v151
    v_mfma_f32_16x16x32_bf16 a[168:171], a[4:7], a[84:87], a[168:171]
    s_and_b32 s52, s52, 3
    v_cvt_pk_bf16_f32 v42, v164, v165
    v_cvt_pk_bf16_f32 v43, v166, v167
    v_mfma_f32_16x16x32_bf16 a[172:175], a[4:7], a[76:79], a[172:175]
    s_lshl_b32 s52, s52, 11
    v_mfma_f32_16x16x32_bf16 a[172:175], a[12:15], a[72:75], a[172:175]
    s_add_u32 s53, s45, 1
    buffer_store_dwordx4 v[40:43], v12, s[28:31], s51 offen offset:1024 sc1
    v_mfma_f32_16x16x32_bf16 a[188:191], a[24:27], a[72:75], a[188:191]
    s_and_b32 s53, s53, 3
    ds_read_b64_tr_b16 a[4:5], v5 offset:0
    v_accvgpr_read_b32 v16, a160
    v_accvgpr_read_b32 v17, a161
    v_mfma_f32_16x16x32_bf16 a[188:191], a[28:31], a[76:79], a[188:191]
    s_lshl_b32 s53, s53, 11
    ds_read_b64_tr_b16 a[6:7], v5 offset:512
    v_accvgpr_read_b32 v18, a162
    v_accvgpr_read_b32 v19, a163
    v_mfma_f32_16x16x32_bf16 a[184:187], a[28:31], a[84:87], a[184:187]
    s_add_u32 s54, s45, 2
    ds_read_b64_tr_b16 a[12:13], v5 offset:4096
    v_accvgpr_read_b32 v20, a176
    v_accvgpr_read_b32 v21, a177
    v_mfma_f32_16x16x32_bf16 a[184:187], a[24:27], a[80:83], a[184:187]
    s_and_b32 s54, s54, 3
    ds_read_b64_tr_b16 a[14:15], v5 offset:4608
    v_accvgpr_read_b32 v22, a178
    v_accvgpr_read_b32 v23, a179
    v_mfma_f32_16x16x32_bf16 v[172:175], a[24:27], a[32:35], v[172:175]
    s_lshl_b32 s54, s54, 11
    s_mov_b32 s51, 0x103000
    v_cvt_pk_bf16_f32 v24, v16, v17
    v_mfma_f32_16x16x32_bf16 v[172:175], a[28:31], a[36:39], v[172:175]
    s_add_u32 s55, s45, 3
    v_cvt_pk_bf16_f32 v25, v18, v19
    v_cvt_pk_bf16_f32 v26, v20, v21
    v_mfma_f32_16x16x32_bf16 v[168:171], a[28:31], a[40:43], v[168:171]
    s_and_b32 s55, s55, 3
    ds_read_b64_tr_b16 a[28:29], v6 offset:4096
    v_cvt_pk_bf16_f32 v27, v22, v23
    v_mfma_f32_16x16x32_bf16 v[168:171], a[24:27], a[44:47], v[168:171]
    s_waitcnt lgkmcnt(15)
    s_lshl_b32 s55, s55, 11
    ds_read_b64_tr_b16 a[30:31], v6 offset:4608
    buffer_store_dwordx4 v[24:27], v12, s[28:31], s51 offen offset:0 sc1
    v_mfma_f32_16x16x32_bf16 v[56:59], a[64:67], a[136:139], v[56:59]
    ds_read_b64_tr_b16 a[24:25], v6 offset:0
    v_mfma_f32_16x16x32_bf16 v[56:59], a[68:71], a[140:143], v[56:59]
    ds_read_b64_tr_b16 a[26:27], v6 offset:512
    v_accvgpr_read_b32 v32, a164
    v_accvgpr_read_b32 v33, a165
    v_mfma_f32_16x16x32_bf16 v[60:63], a[68:71], a[132:135], v[60:63]
    v_accvgpr_read_b32 v34, a166
    v_accvgpr_read_b32 v35, a167
    v_mfma_f32_16x16x32_bf16 v[60:63], a[64:67], a[120:123], v[60:63]
    v_accvgpr_read_b32 v36, a180
    v_accvgpr_read_b32 v37, a181
    v_mfma_f32_16x16x32_bf16 v[184:187], a[64:67], a[0:3], v[184:187]
    v_accvgpr_read_b32 v38, a182
    v_accvgpr_read_b32 v39, a183
    v_mfma_f32_16x16x32_bf16 v[184:187], a[68:71], a[8:11], v[184:187]
    s_mov_b32 s51, 0x103000
    v_cvt_pk_bf16_f32 v40, v32, v33
    v_mfma_f32_16x16x32_bf16 v[188:191], a[68:71], a[20:23], v[188:191]
    v_cvt_pk_bf16_f32 v41, v34, v35
    v_cvt_pk_bf16_f32 v42, v36, v37
    v_mfma_f32_16x16x32_bf16 v[188:191], a[64:67], a[16:19], v[188:191]
    v_cvt_pk_bf16_f32 v43, v38, v39
    v_mfma_f32_16x16x32_bf16 v[204:207], a[124:127], a[16:19], v[204:207]
    buffer_store_dwordx4 v[40:43], v12, s[28:31], s51 offen offset:1024 sc1
    v_mfma_f32_16x16x32_bf16 v[204:207], a[128:131], a[20:23], v[204:207]
    s_mov_b32 s51, 0x42000
    v_mfma_f32_16x16x32_bf16 v[200:203], a[128:131], a[8:11], v[200:203]
    v_cvt_pk_bf16_f32 v24, v120, v121
    v_cvt_pk_bf16_f32 v25, v122, v123
    v_mfma_f32_16x16x32_bf16 v[200:203], a[124:127], a[0:3], v[200:203]
    v_cvt_pk_bf16_f32 v26, v136, v137
    v_cvt_pk_bf16_f32 v27, v138, v139
    v_mfma_f32_16x16x32_bf16 v[76:79], a[124:127], a[120:123], v[76:79]
    v_mfma_f32_16x16x32_bf16 v[76:79], a[128:131], a[132:135], v[76:79]
    buffer_store_dwordx4 v[24:27], v12, s[28:31], s51 offen offset:0 sc1
    v_mfma_f32_16x16x32_bf16 v[72:75], a[128:131], a[140:143], v[72:75]
    s_mov_b32 s51, 0x42000
    v_cvt_pk_bf16_f32 v40, v124, v125
    v_mfma_f32_16x16x32_bf16 v[72:75], a[124:127], a[136:139], v[72:75]
    v_cvt_pk_bf16_f32 v41, v126, v127
    v_cvt_pk_bf16_f32 v42, v140, v141
    v_mfma_f32_16x16x32_bf16 v[88:91], a[48:51], a[136:139], v[88:91]
    v_cvt_pk_bf16_f32 v43, v142, v143
    v_mfma_f32_16x16x32_bf16 v[88:91], a[52:55], a[140:143], v[88:91]
    buffer_store_dwordx4 v[40:43], v12, s[28:31], s51 offen offset:1024 sc1
    v_mfma_f32_16x16x32_bf16 v[92:95], a[52:55], a[132:135], v[92:95]
    v_accvgpr_read_b32 v20, a152
    v_mfma_f32_16x16x32_bf16 v[92:95], a[48:51], a[120:123], v[92:95]
    v_accvgpr_read_b32 v21, a153
    v_accvgpr_read_b32 v22, a154
    v_mfma_f32_16x16x32_bf16 v[216:219], a[48:51], a[0:3], v[216:219]
    v_accvgpr_read_b32 v23, a155
    s_mov_b32 s51, 0x142000
    v_mfma_f32_16x16x32_bf16 v[216:219], a[52:55], a[8:11], v[216:219]
    v_cvt_pk_bf16_f32 v24, v248, v249
    v_cvt_pk_bf16_f32 v25, v250, v251
    v_mfma_f32_16x16x32_bf16 v[220:223], a[52:55], a[20:23], v[220:223]
    v_cvt_pk_bf16_f32 v26, v20, v21
    v_cvt_pk_bf16_f32 v27, v22, v23
    v_mfma_f32_16x16x32_bf16 v[220:223], a[48:51], a[16:19], v[220:223]
    s_waitcnt lgkmcnt(15)
    v_mfma_f32_16x16x32_bf16 v[236:239], a[100:103], a[16:19], v[236:239]
    ds_read_b64_tr_b16 a[16:17], v5 offset:32768
    buffer_store_dwordx4 v[24:27], v12, s[28:31], s51 offen offset:0 sc1
    v_mfma_f32_16x16x32_bf16 v[236:239], a[96:99], a[20:23], v[236:239]
    ds_read_b64_tr_b16 a[18:19], v5 offset:33280
    v_accvgpr_read_b32 v36, a156
    v_accvgpr_read_b32 v37, a157
    v_mfma_f32_16x16x32_bf16 v[232:235], a[96:99], a[8:11], v[232:235]
    ds_read_b64_tr_b16 a[20:21], v5 offset:36864
    v_accvgpr_read_b32 v38, a158
    v_mfma_f32_16x16x32_bf16 v[232:235], a[100:103], a[0:3], v[232:235]
    ds_read_b64_tr_b16 a[22:23], v5 offset:37376
    v_accvgpr_read_b32 v39, a159
    s_mov_b32 s51, 0x142000
    v_mfma_f32_16x16x32_bf16 v[108:111], a[100:103], a[120:123], v[108:111]
    ds_read_b64_tr_b16 a[8:9], v6 offset:36864
    v_cvt_pk_bf16_f32 v40, v252, v253
    v_cvt_pk_bf16_f32 v41, v254, v255
    v_mfma_f32_16x16x32_bf16 v[108:111], a[96:99], a[132:135], v[108:111]
    ds_read_b64_tr_b16 a[10:11], v6 offset:37376
    v_cvt_pk_bf16_f32 v42, v36, v37
    v_cvt_pk_bf16_f32 v43, v38, v39
    v_mfma_f32_16x16x32_bf16 v[104:107], a[96:99], a[140:143], v[104:107]
    ds_read_b64_tr_b16 a[0:1], v6 offset:32768
    buffer_store_dwordx4 v[40:43], v12, s[28:31], s51 offen offset:1024 sc1
    v_mfma_f32_16x16x32_bf16 v[104:107], a[100:103], a[136:139], v[104:107]
    s_waitcnt lgkmcnt(15)
    ds_read_b64_tr_b16 a[2:3], v6 offset:33280
    v_mfma_f32_16x16x32_bf16 v[56:59], a[104:107], a[44:47], v[56:59]
    ds_read_b64_tr_b16 a[120:121], v5 offset:8192
    s_mov_b32 s51, 0x43000
    v_cvt_pk_bf16_f32 v24, v152, v153
    v_mfma_f32_16x16x32_bf16 v[56:59], a[108:111], a[40:43], v[56:59]
    ds_read_b64_tr_b16 a[122:123], v5 offset:8704
    v_cvt_pk_bf16_f32 v25, v154, v155
    v_cvt_pk_bf16_f32 v26, v168, v169
    v_mfma_f32_16x16x32_bf16 v[60:63], a[108:111], a[36:39], v[60:63]
    ds_read_b64_tr_b16 a[132:133], v5 offset:12288
    v_cvt_pk_bf16_f32 v27, v170, v171
    v_mfma_f32_16x16x32_bf16 v[60:63], a[104:107], a[32:35], v[60:63]
    ds_read_b64_tr_b16 a[134:135], v5 offset:12800
    buffer_store_dwordx4 v[24:27], v12, s[28:31], s51 offen offset:0 sc1
    v_mfma_f32_16x16x32_bf16 v[184:187], a[104:107], a[80:83], v[184:187]
    ds_read_b64_tr_b16 a[140:141], v6 offset:12288
    s_mov_b32 s51, 0x43000
    v_mfma_f32_16x16x32_bf16 v[184:187], a[108:111], a[84:87], v[184:187]
    ds_read_b64_tr_b16 a[142:143], v6 offset:12800
    v_cvt_pk_bf16_f32 v40, v156, v157
    v_cvt_pk_bf16_f32 v41, v158, v159
    v_mfma_f32_16x16x32_bf16 v[188:191], a[108:111], a[76:79], v[188:191]
    ds_read_b64_tr_b16 a[136:137], v6 offset:8192
    v_cvt_pk_bf16_f32 v42, v172, v173
    v_cvt_pk_bf16_f32 v43, v174, v175
    v_mfma_f32_16x16x32_bf16 v[188:191], a[104:107], a[72:75], v[188:191]
    ds_read_b64_tr_b16 a[138:139], v6 offset:8704
    v_mfma_f32_16x16x32_bf16 v[204:207], a[116:119], a[72:75], v[204:207]
    buffer_store_dwordx4 v[40:43], v12, s[28:31], s51 offen offset:1024 sc1
    v_mfma_f32_16x16x32_bf16 v[204:207], a[112:115], a[76:79], v[204:207]
    v_accvgpr_read_b32 v16, a168
    v_accvgpr_read_b32 v17, a169
    v_mfma_f32_16x16x32_bf16 v[200:203], a[112:115], a[84:87], v[200:203]
    v_accvgpr_read_b32 v18, a170
    v_accvgpr_read_b32 v19, a171
    v_mfma_f32_16x16x32_bf16 v[200:203], a[116:119], a[80:83], v[200:203]
    v_accvgpr_read_b32 v20, a184
    v_accvgpr_read_b32 v21, a185
    v_mfma_f32_16x16x32_bf16 v[76:79], a[116:119], a[32:35], v[76:79]
    v_accvgpr_read_b32 v22, a186
    v_accvgpr_read_b32 v23, a187
    v_mfma_f32_16x16x32_bf16 v[76:79], a[112:115], a[36:39], v[76:79]
    s_mov_b32 s51, 0x143000
    v_cvt_pk_bf16_f32 v24, v16, v17
    v_mfma_f32_16x16x32_bf16 v[72:75], a[112:115], a[40:43], v[72:75]
    v_cvt_pk_bf16_f32 v25, v18, v19
    v_cvt_pk_bf16_f32 v26, v20, v21
    v_mfma_f32_16x16x32_bf16 v[72:75], a[116:119], a[44:47], v[72:75]
    v_cvt_pk_bf16_f32 v27, v22, v23
    v_mfma_f32_16x16x32_bf16 v[88:91], a[92:95], a[44:47], v[88:91]
    buffer_store_dwordx4 v[24:27], v12, s[28:31], s51 offen offset:0 sc1
    v_mfma_f32_16x16x32_bf16 v[88:91], a[60:63], a[40:43], v[88:91]
    v_accvgpr_read_b32 v32, a172
    v_mfma_f32_16x16x32_bf16 v[92:95], a[60:63], a[36:39], v[92:95]
    v_accvgpr_read_b32 v33, a173
    v_accvgpr_read_b32 v34, a174
    v_mfma_f32_16x16x32_bf16 v[92:95], a[92:95], a[32:35], v[92:95]
    v_accvgpr_read_b32 v35, a175
    v_accvgpr_read_b32 v36, a188
    v_mfma_f32_16x16x32_bf16 v[216:219], a[92:95], a[80:83], v[216:219]
    v_accvgpr_read_b32 v37, a189
    v_accvgpr_read_b32 v38, a190
    v_mfma_f32_16x16x32_bf16 v[216:219], a[60:63], a[84:87], v[216:219]
    v_accvgpr_read_b32 v39, a191
    v_mfma_f32_16x16x32_bf16 v[220:223], a[60:63], a[76:79], v[220:223]
    s_mov_b32 s51, 0x143000
    v_cvt_pk_bf16_f32 v40, v32, v33
    v_mfma_f32_16x16x32_bf16 v[220:223], a[92:95], a[72:75], v[220:223]
    v_cvt_pk_bf16_f32 v41, v34, v35
    v_cvt_pk_bf16_f32 v42, v36, v37
    v_mfma_f32_16x16x32_bf16 v[236:239], a[88:91], a[72:75], v[236:239]
    ds_read_b64_tr_b16 a[72:73], v5 offset:40960
    v_cvt_pk_bf16_f32 v43, v38, v39
    v_mfma_f32_16x16x32_bf16 v[236:239], a[56:59], a[76:79], v[236:239]
    ds_read_b64_tr_b16 a[74:75], v5 offset:41472
    buffer_store_dwordx4 v[40:43], v12, s[28:31], s51 offen offset:1024 sc1
    v_mfma_f32_16x16x32_bf16 v[232:235], a[56:59], a[84:87], v[232:235]
    ds_read_b64_tr_b16 a[76:77], v5 offset:45056
    v_mfma_f32_16x16x32_bf16 v[232:235], a[88:91], a[80:83], v[232:235]
    ds_read_b64_tr_b16 a[78:79], v5 offset:45568
    v_mfma_f32_16x16x32_bf16 v[108:111], a[88:91], a[32:35], v[108:111]
    ds_read_b64_tr_b16 a[84:85], v6 offset:45056
    v_mfma_f32_16x16x32_bf16 v[108:111], a[56:59], a[36:39], v[108:111]
    ds_read_b64_tr_b16 a[86:87], v6 offset:45568
    v_mfma_f32_16x16x32_bf16 v[104:107], a[56:59], a[40:43], v[104:107]
    ds_read_b64_tr_b16 a[80:81], v6 offset:40960
    v_mfma_f32_16x16x32_bf16 v[104:107], a[88:91], a[44:47], v[104:107]
    s_waitcnt lgkmcnt(15)
    ds_read_b64_tr_b16 a[82:83], v6 offset:41472
    v_mfma_f32_16x16x32_bf16 v[48:51], a[64:67], a[4:7], v[48:51]
    v_mfma_f32_16x16x32_bf16 v[48:51], a[68:71], a[12:15], v[48:51]
    v_mfma_f32_16x16x32_bf16 v[52:55], a[68:71], a[28:31], v[52:55]
    v_mfma_f32_16x16x32_bf16 v[52:55], a[64:67], a[24:27], v[52:55]
    s_mov_b32 s51, 0x40000
    v_cvt_pk_bf16_f32 v24, v56, v57
    v_mfma_f32_16x16x32_bf16 v[176:179], a[64:67], a[16:19], v[176:179]
    v_cvt_pk_bf16_f32 v25, v58, v59
    v_cvt_pk_bf16_f32 v26, v72, v73
    v_mfma_f32_16x16x32_bf16 v[176:179], a[68:71], a[20:23], v[176:179]
    v_cvt_pk_bf16_f32 v27, v74, v75
    v_mfma_f32_16x16x32_bf16 v[180:183], a[68:71], a[8:11], v[180:183]
    buffer_store_dwordx4 v[24:27], v12, s[28:31], s51 offen offset:0 sc1
    v_mfma_f32_16x16x32_bf16 v[180:183], a[64:67], a[0:3], v[180:183]
    s_mov_b32 s51, 0x40000
    v_mfma_f32_16x16x32_bf16 v[196:199], a[124:127], a[0:3], v[196:199]
    v_cvt_pk_bf16_f32 v40, v60, v61
    v_cvt_pk_bf16_f32 v41, v62, v63
    v_mfma_f32_16x16x32_bf16 v[196:199], a[128:131], a[8:11], v[196:199]
    v_cvt_pk_bf16_f32 v42, v76, v77
    v_cvt_pk_bf16_f32 v43, v78, v79
    v_mfma_f32_16x16x32_bf16 v[192:195], a[128:131], a[20:23], v[192:195]
    v_mfma_f32_16x16x32_bf16 v[192:195], a[124:127], a[16:19], v[192:195]
    buffer_store_dwordx4 v[40:43], v12, s[28:31], s51 offen offset:1024 sc1
    v_mfma_f32_16x16x32_bf16 v[68:71], a[124:127], a[24:27], v[68:71]
    s_mov_b32 s51, 0x140000
    v_cvt_pk_bf16_f32 v24, v184, v185
    v_mfma_f32_16x16x32_bf16 v[68:71], a[128:131], a[28:31], v[68:71]
    v_cvt_pk_bf16_f32 v25, v186, v187
    v_cvt_pk_bf16_f32 v26, v200, v201
    v_mfma_f32_16x16x32_bf16 v[64:67], a[128:131], a[12:15], v[64:67]
    v_cvt_pk_bf16_f32 v27, v202, v203
    v_mfma_f32_16x16x32_bf16 v[64:67], a[124:127], a[4:7], v[64:67]
    buffer_store_dwordx4 v[24:27], v12, s[28:31], s51 offen offset:0 sc1
    v_mfma_f32_16x16x32_bf16 v[80:83], a[48:51], a[4:7], v[80:83]
    v_mfma_f32_16x16x32_bf16 v[80:83], a[52:55], a[12:15], v[80:83]
    s_mov_b32 s51, 0x140000
    v_cvt_pk_bf16_f32 v40, v188, v189
    v_mfma_f32_16x16x32_bf16 v[84:87], a[52:55], a[28:31], v[84:87]
    v_cvt_pk_bf16_f32 v41, v190, v191
    v_cvt_pk_bf16_f32 v42, v204, v205
    v_mfma_f32_16x16x32_bf16 v[84:87], a[48:51], a[24:27], v[84:87]
    v_cvt_pk_bf16_f32 v43, v206, v207
    v_mfma_f32_16x16x32_bf16 v[208:211], a[48:51], a[16:19], v[208:211]
    buffer_store_dwordx4 v[40:43], v12, s[28:31], s51 offen offset:1024 sc1
    v_mfma_f32_16x16x32_bf16 v[208:211], a[52:55], a[20:23], v[208:211]
    s_mov_b32 s51, 0x41000
    v_mfma_f32_16x16x32_bf16 v[212:215], a[52:55], a[8:11], v[212:215]
    v_cvt_pk_bf16_f32 v24, v88, v89
    v_cvt_pk_bf16_f32 v25, v90, v91
    v_mfma_f32_16x16x32_bf16 v[212:215], a[48:51], a[0:3], v[212:215]
    v_cvt_pk_bf16_f32 v26, v104, v105
    v_cvt_pk_bf16_f32 v27, v106, v107
    v_mfma_f32_16x16x32_bf16 v[228:231], a[100:103], a[0:3], v[228:231]
    buffer_store_dwordx4 v[24:27], v12, s[28:31], s51 offen offset:0 sc1
    v_mfma_f32_16x16x32_bf16 v[228:231], a[96:99], a[8:11], v[228:231]
    v_mfma_f32_16x16x32_bf16 v[224:227], a[96:99], a[20:23], v[224:227]
    s_mov_b32 s51, 0x41000
    v_cvt_pk_bf16_f32 v40, v92, v93
    v_mfma_f32_16x16x32_bf16 v[224:227], a[100:103], a[16:19], v[224:227]
    v_cvt_pk_bf16_f32 v41, v94, v95
    v_cvt_pk_bf16_f32 v42, v108, v109
    v_mfma_f32_16x16x32_bf16 v[100:103], a[100:103], a[24:27], v[100:103]
    v_cvt_pk_bf16_f32 v43, v110, v111
    v_mfma_f32_16x16x32_bf16 v[100:103], a[96:99], a[28:31], v[100:103]
    buffer_store_dwordx4 v[40:43], v12, s[28:31], s51 offen offset:1024 sc1
    v_mfma_f32_16x16x32_bf16 v[96:99], a[96:99], a[12:15], v[96:99]
    s_mov_b32 s51, 0x141000
    v_mfma_f32_16x16x32_bf16 v[96:99], a[100:103], a[4:7], v[96:99]
    s_waitcnt lgkmcnt(12)
    v_cvt_pk_bf16_f32 v24, v216, v217
    v_cvt_pk_bf16_f32 v25, v218, v219
    v_mfma_f32_16x16x32_bf16 v[48:51], a[104:107], a[120:123], v[48:51]
    v_cvt_pk_bf16_f32 v26, v232, v233
    v_cvt_pk_bf16_f32 v27, v234, v235
    v_mfma_f32_16x16x32_bf16 v[48:51], a[108:111], a[132:135], v[48:51]
    s_waitcnt lgkmcnt(8)
    v_mfma_f32_16x16x32_bf16 v[52:55], a[108:111], a[140:143], v[52:55]
    buffer_store_dwordx4 v[24:27], v12, s[28:31], s51 offen offset:0 sc1
    v_mfma_f32_16x16x32_bf16 v[52:55], a[104:107], a[136:139], v[52:55]
    s_waitcnt lgkmcnt(4)
    s_mov_b32 s51, 0x141000
    v_cvt_pk_bf16_f32 v40, v220, v221
    v_mfma_f32_16x16x32_bf16 v[176:179], a[104:107], a[72:75], v[176:179]
    v_cvt_pk_bf16_f32 v41, v222, v223
    v_cvt_pk_bf16_f32 v42, v236, v237
    v_mfma_f32_16x16x32_bf16 v[176:179], a[108:111], a[76:79], v[176:179]
    s_waitcnt lgkmcnt(0)
    v_cvt_pk_bf16_f32 v43, v238, v239
    v_mfma_f32_16x16x32_bf16 v[180:183], a[108:111], a[84:87], v[180:183]
    buffer_store_dwordx4 v[40:43], v12, s[28:31], s51 offen offset:1024 sc1
    v_mfma_f32_16x16x32_bf16 v[180:183], a[104:107], a[80:83], v[180:183]
    v_mfma_f32_16x16x32_bf16 v[196:199], a[116:119], a[80:83], v[196:199]
    v_mfma_f32_16x16x32_bf16 v[196:199], a[112:115], a[84:87], v[196:199]
    v_mfma_f32_16x16x32_bf16 v[192:195], a[112:115], a[76:79], v[192:195]
    v_mfma_f32_16x16x32_bf16 v[192:195], a[116:119], a[72:75], v[192:195]
    v_mfma_f32_16x16x32_bf16 v[68:71], a[116:119], a[136:139], v[68:71]
    v_mfma_f32_16x16x32_bf16 v[68:71], a[112:115], a[140:143], v[68:71]
    v_mfma_f32_16x16x32_bf16 v[64:67], a[112:115], a[132:135], v[64:67]
    v_mfma_f32_16x16x32_bf16 v[64:67], a[116:119], a[120:123], v[64:67]
    v_mfma_f32_16x16x32_bf16 v[80:83], a[92:95], a[120:123], v[80:83]
    v_mfma_f32_16x16x32_bf16 v[80:83], a[60:63], a[132:135], v[80:83]
    v_mfma_f32_16x16x32_bf16 v[84:87], a[60:63], a[140:143], v[84:87]
    v_mfma_f32_16x16x32_bf16 v[84:87], a[92:95], a[136:139], v[84:87]
    v_mfma_f32_16x16x32_bf16 v[208:211], a[92:95], a[72:75], v[208:211]
    v_mfma_f32_16x16x32_bf16 v[208:211], a[60:63], a[76:79], v[208:211]
    v_mfma_f32_16x16x32_bf16 v[212:215], a[60:63], a[84:87], v[212:215]
    v_mfma_f32_16x16x32_bf16 v[212:215], a[92:95], a[80:83], v[212:215]
    v_mfma_f32_16x16x32_bf16 v[228:231], a[88:91], a[80:83], v[228:231]
    v_mfma_f32_16x16x32_bf16 v[228:231], a[56:59], a[84:87], v[228:231]
    v_mfma_f32_16x16x32_bf16 v[224:227], a[56:59], a[76:79], v[224:227]
    v_mfma_f32_16x16x32_bf16 v[224:227], a[88:91], a[72:75], v[224:227]
    v_mfma_f32_16x16x32_bf16 v[100:103], a[88:91], a[136:139], v[100:103]
    v_mfma_f32_16x16x32_bf16 v[100:103], a[56:59], a[140:143], v[100:103]
    v_mfma_f32_16x16x32_bf16 v[96:99], a[56:59], a[132:135], v[96:99]
    v_mfma_f32_16x16x32_bf16 v[96:99], a[88:91], a[120:123], v[96:99]
    v_lshlrev_b32 v1, 4, v0
    v_lshrrev_b32 v6, 3, v0
    v_lshrrev_b32 v7, 4, v0
    v_and_b32 v8, 7, v0
    v_lshlrev_b32 v9, 1, v7
    v_xor_b32 v8, v8, v9
    v_lshlrev_b32 v8, 4, v8
    v_lshl_add_u32 v116, v6, 11, v8
    v_add_u32 v117, 0x3c00, v116
    v_add_u32 v118, 0x7800, v116
    v_add_u32 v119, 0xb400, v116
    s_mov_b32 s72, 0
    s_barrier
    s_mov_b32 s51, 0x0
    v_cvt_pk_bf16_f32 v24, v48, v49
    v_cvt_pk_bf16_f32 v25, v50, v51
    v_cvt_pk_bf16_f32 v26, v64, v65
    v_cvt_pk_bf16_f32 v27, v66, v67
    buffer_store_dwordx4 v[24:27], v12, s[28:31], s51 offen offset:0 sc1
    s_mov_b32 s51, 0x0
    v_cvt_pk_bf16_f32 v40, v52, v53
    v_cvt_pk_bf16_f32 v41, v54, v55
    v_cvt_pk_bf16_f32 v42, v68, v69
    v_cvt_pk_bf16_f32 v43, v70, v71
    buffer_store_dwordx4 v[40:43], v12, s[28:31], s51 offen offset:1024 sc1
    s_mov_b32 s51, 0x100000
    v_cvt_pk_bf16_f32 v24, v176, v177
    v_cvt_pk_bf16_f32 v25, v178, v179
    v_cvt_pk_bf16_f32 v26, v192, v193
    v_cvt_pk_bf16_f32 v27, v194, v195
    buffer_store_dwordx4 v[24:27], v12, s[28:31], s51 offen offset:0 sc1
    s_mov_b32 s51, 0x100000
    v_cvt_pk_bf16_f32 v40, v180, v181
    v_cvt_pk_bf16_f32 v41, v182, v183
    v_cvt_pk_bf16_f32 v42, v196, v197
    v_cvt_pk_bf16_f32 v43, v198, v199
    buffer_store_dwordx4 v[40:43], v12, s[28:31], s51 offen offset:1024 sc1
    s_mov_b32 s51, 0x1000
    v_cvt_pk_bf16_f32 v24, v80, v81
    v_cvt_pk_bf16_f32 v25, v82, v83
    v_cvt_pk_bf16_f32 v26, v96, v97
    v_cvt_pk_bf16_f32 v27, v98, v99
    buffer_store_dwordx4 v[24:27], v12, s[28:31], s51 offen offset:0 sc1
    s_mov_b32 s51, 0x1000
    v_cvt_pk_bf16_f32 v40, v84, v85
    v_cvt_pk_bf16_f32 v41, v86, v87
    v_cvt_pk_bf16_f32 v42, v100, v101
    v_cvt_pk_bf16_f32 v43, v102, v103
    buffer_store_dwordx4 v[40:43], v12, s[28:31], s51 offen offset:1024 sc1
    s_mov_b32 s51, 0x101000
    v_cvt_pk_bf16_f32 v24, v208, v209
    v_cvt_pk_bf16_f32 v25, v210, v211
    v_cvt_pk_bf16_f32 v26, v224, v225
    v_cvt_pk_bf16_f32 v27, v226, v227
    buffer_store_dwordx4 v[24:27], v12, s[28:31], s51 offen offset:0 sc1
    buffer_load_dword v47, v15, s[76:79], 0 offen sc1
    s_mov_b32 s51, 0x101000
    v_cvt_pk_bf16_f32 v40, v212, v213
    v_cvt_pk_bf16_f32 v41, v214, v215
    v_cvt_pk_bf16_f32 v42, v228, v229
    v_cvt_pk_bf16_f32 v43, v230, v231
    buffer_store_dwordx4 v[40:43], v12, s[28:31], s51 offen offset:1024 sc1
    s_waitcnt vmcnt(0)
    s_barrier
    s_cmp_lg_u32 s45, 0
    s_cbranch_scc1 L_v3_ns
    v_mov_b32 v6, 3
    v_mov_b32 v7, 0
    s_mov_b64 exec, 1
    buffer_store_dword v6, v7, s[76:79], s73 offen sc1
    s_mov_b64 exec, -1
L_v3_ns:
    s_branch L_p2
L_code_end:

L_all_end:
    s_endpgm
.section .rodata,"a"
.p2align 6
.amdhsa_kernel recurrent_scan__softmax_full_mha__glu_gated_glu__prompt_kernel
  .amdhsa_next_free_vgpr 512
  .amdhsa_next_free_sgpr 102
  .amdhsa_accum_offset 256
  .amdhsa_group_segment_fixed_size 0
  .amdhsa_kernarg_size 80
  .amdhsa_user_sgpr_count 2
  .amdhsa_user_sgpr_kernarg_segment_ptr 1
  .amdhsa_system_sgpr_workgroup_id_x 1
  .amdhsa_float_denorm_mode_32 3
  .amdhsa_float_denorm_mode_16_64 3
.end_amdhsa_kernel
```
